```python
import torch

def _softmax(x, axis=-1):
    return torch.softmax(x, dim=axis)
def _gelu(x):
    return torch.nn.functional.gelu(x, approximate="tanh")
def _silu(x):
    return torch.nn.functional.silu(x)
def _sigmoid(x):
    return torch.sigmoid(x)
def _layernorm(x, axis=-1, eps=1e-5):
    m = x.mean(dim=axis, keepdim=True)
    v = x.var(dim=axis, keepdim=True, unbiased=False)
    return (x - m) / torch.sqrt(v + eps)
def _scatter_add(tgt, idx, src, axis=0):
    return tgt.clone().index_add_(axis, idx, src)
def _segment_sum(src, seg, n):
    out = torch.zeros((n,) + src.shape[1:], dtype=src.dtype)
    return out.index_add_(0, seg, src)
def _pad(x, pw):
    flat = tuple(v for pair in reversed(pw) for v in pair)
    return torch.nn.functional.pad(x, flat)

kernel_name = 'recurrent_scan__grouped_kv_mqa__dense_activation_relu__prompt'

def setup_inputs():

    _w = (lambda a: (lambda t: t.to(torch.bfloat16) if t.is_floating_point() else t)(torch.as_tensor(a)))
    def _A_setup():
        B, S, D, H = 1, 2048, 640, 32
        Dh = D // H
        return {
            "x": _w((lambda *s: torch.randn(*s, dtype=torch.bfloat16) * 0.05)(B, S, D)),
            "wq": _w((lambda *s: torch.randn(*s, dtype=torch.bfloat16) * 0.05)(D, H * Dh)),
            "wk": _w((lambda *s: torch.randn(*s, dtype=torch.bfloat16) * 0.05)(D, Dh)),
            "wv": _w((lambda *s: torch.randn(*s, dtype=torch.bfloat16) * 0.05)(D, Dh)),
            "wo": _w((lambda *s: torch.randn(*s, dtype=torch.bfloat16) * 0.05)(H * Dh, D)),
        }
    _A_in = _A_setup()

    def _B_setup():
        B, S, D, Dff = 1, 2048, 640, 1728
        return {
            "x": _w((lambda *s: torch.randn(*s, dtype=torch.bfloat16) * 0.05)(B, S, D)),
            "w1": _w((lambda *s: torch.randn(*s, dtype=torch.bfloat16) * 0.05)(D, Dff)),
            "w2": _w((lambda *s: torch.randn(*s, dtype=torch.bfloat16) * 0.05)(Dff, D)),
        }
    _B_in = _B_setup()

    return {
        "A_x": _A_in["x"],
        "A_wq": _A_in["wq"],
        "A_wk": _A_in["wk"],
        "A_wv": _A_in["wv"],
        "A_wo": _A_in["wo"],
        "B_x": _B_in["x"],
        "B_w1": _B_in["w1"],
        "B_w2": _B_in["w2"],
    }

def reference(A_x, A_wq, A_wk, A_wv, A_wo, B_x, B_w1, B_w2):
    def _A_ref(x, wq, wk, wv, wo):
        B, S, D = x.shape
        H = 32
        Dh = D // H
        q = (lambda x, *d: x.permute(*d))((x @ wq).reshape(B, S, H, Dh), 0, 2, 1, 3)
        k = x @ wk
        v = x @ wv
        scores = torch.einsum("bhqd,bkd->bhqk", q, k) * (Dh ** -0.5)
        p = _softmax(scores, axis=-1)
        o = torch.einsum("bhqk,bkd->bhqd", p, v)
        return (lambda x, *d: x.permute(*d))(o, 0, 2, 1, 3).reshape(B, S, H * Dh) @ wo

    def _B_ref(x, w1, w2):
        h = torch.einsum("bsd,df->bsf", x, w1)
        zero = torch.zeros_like(h)
        h = torch.maximum(h, zero)
        return torch.einsum("bsf,fd->bsd", h, w2)

    x = A_x
    xn = _layernorm(x, axis=-1)
    s = _A_ref(xn, A_wq, A_wk, A_wv, A_wo)
    g = _silu(_B_ref(xn, B_w1, B_w2))
    return x + s * g
```

```asm
; @launch kernel=k1_proj_kernel grid=(256,1,1) block=(320,1,1) lds=163840
; @launch kernel=k2_attn_out_kernel grid=(256,1,1) block=(256,1,1) lds=163840
.amdgcn_target "amdgcn-amd-amdhsa--gfx950"
.text
.globl k1_proj_kernel
.p2align 8
.type k1_proj_kernel,@function
k1_proj_kernel:
    s_cmp_ge_u32 s2, 256
    s_cbranch_scc1 K1_END
    s_load_dwordx16 s[44:59], s[0:1], 0
    s_load_dwordx4 s[60:63], s[0:1], 64
    s_load_dwordx2 s[64:65], s[0:1], 80
    v_and_b32 v1, 63, v0
    v_lshrrev_b32 v18, 6, v0
    v_and_b32 v2, 15, v0
    v_readfirstlane_b32 s18, v18
    v_bfe_u32 v3, v0, 4, 2
    s_and_b32 s24, s2, 7
    s_lshr_b32 s25, s2, 3
    s_lshr_b32 s26, s24, 2
    s_lshl_b32 s26, s26, 4
    s_lshr_b32 s27, s25, 1
    s_add_u32 s16, s26, s27
    s_and_b32 s26, s24, 3
    s_lshl_b32 s26, s26, 1
    s_and_b32 s27, s25, 1
    s_add_u32 s17, s26, s27
    s_lshl_b32 s19, s17, 2
    s_add_u32 s19, s19, s18
    s_cmp_eq_u32 s18, 4
    s_cbranch_scc1 K1_HELPER
    s_lshl_b32 s24, s16, 6
    s_lshl_b32 s25, s18, 4
    s_add_u32 s24, s24, s25
    v_add_u32 v18, s24, v3
    v_mul_u32_u24 v18, 1280, v18
    v_lshl_add_u32 v18, v2, 4, v18
    v_add_u32 v208, 0, v18
    v_add_u32 v209, 5120, v18
    v_add_u32 v210, 10240, v18
    v_add_u32 v211, 15360, v18
    s_cmp_eq_u32 s17, 7
    s_cbranch_scc1 K1_SRC_PRIV
    s_cmp_lt_u32 s17, 2
    s_cselect_b32 s30, 0, 1
    s_mov_b32 s26, 819200
    s_cselect_b32 s26, s26, 2211840
    s_mov_b32 s27, 1280
    s_cselect_b32 s27, s27, 3456
    s_cselect_b32 s28, 0, 2
    s_sub_u32 s28, s17, s28
    s_mul_i32 s28, s28, 640
    s_mul_i32 s29, s18, 320
    v_add_u32 v19, s29, v1
    v_mul_u32_u24 v20, 1639, v19
    v_lshrrev_b32 v20, 16, v20
    v_mul_u32_u24 v21, 40, v20
    v_sub_u32 v21, v19, v21
    v_bfe_u32 v22, v20, 1, 2
    v_lshlrev_b32 v22, 1, v22
    v_xor_b32 v21, v21, v22
    v_bfe_u32 v22, v20, 2, 2
    v_lshlrev_b32 v22, 3, v22
    v_and_b32 v19, 3, v20
    v_add_u32 v22, v22, v19
    v_lshrrev_b32 v20, 4, v20
    v_lshl_add_u32 v22, v20, 2, v22
    v_mul_lo_u32 v22, v22, s27
    v_lshl_add_u32 v22, v21, 4, v22
    v_add_u32 v4, s28, v22
    v_add_u32 v19, s29, v1
    v_add_u32 v19, 64, v19
    v_mul_u32_u24 v20, 1639, v19
    v_lshrrev_b32 v20, 16, v20
    v_mul_u32_u24 v21, 40, v20
    v_sub_u32 v21, v19, v21
    v_bfe_u32 v22, v20, 1, 2
    v_lshlrev_b32 v22, 1, v22
    v_xor_b32 v21, v21, v22
    v_bfe_u32 v22, v20, 2, 2
    v_lshlrev_b32 v22, 3, v22
    v_and_b32 v19, 3, v20
    v_add_u32 v22, v22, v19
    v_lshrrev_b32 v20, 4, v20
    v_lshl_add_u32 v22, v20, 2, v22
    v_mul_lo_u32 v22, v22, s27
    v_lshl_add_u32 v22, v21, 4, v22
    v_add_u32 v5, s28, v22
    v_add_u32 v19, s29, v1
    v_add_u32 v19, 128, v19
    v_mul_u32_u24 v20, 1639, v19
    v_lshrrev_b32 v20, 16, v20
    v_mul_u32_u24 v21, 40, v20
    v_sub_u32 v21, v19, v21
    v_bfe_u32 v22, v20, 1, 2
    v_lshlrev_b32 v22, 1, v22
    v_xor_b32 v21, v21, v22
    v_bfe_u32 v22, v20, 2, 2
    v_lshlrev_b32 v22, 3, v22
    v_and_b32 v19, 3, v20
    v_add_u32 v22, v22, v19
    v_lshrrev_b32 v20, 4, v20
    v_lshl_add_u32 v22, v20, 2, v22
    v_mul_lo_u32 v22, v22, s27
    v_lshl_add_u32 v22, v21, 4, v22
    v_add_u32 v6, s28, v22
    v_add_u32 v19, s29, v1
    v_add_u32 v19, 192, v19
    v_mul_u32_u24 v20, 1639, v19
    v_lshrrev_b32 v20, 16, v20
    v_mul_u32_u24 v21, 40, v20
    v_sub_u32 v21, v19, v21
    v_bfe_u32 v22, v20, 1, 2
    v_lshlrev_b32 v22, 1, v22
    v_xor_b32 v21, v21, v22
    v_bfe_u32 v22, v20, 2, 2
    v_lshlrev_b32 v22, 3, v22
    v_and_b32 v19, 3, v20
    v_add_u32 v22, v22, v19
    v_lshrrev_b32 v20, 4, v20
    v_lshl_add_u32 v22, v20, 2, v22
    v_mul_lo_u32 v22, v22, s27
    v_lshl_add_u32 v22, v21, 4, v22
    v_add_u32 v7, s28, v22
    v_add_u32 v19, s29, v1
    v_add_u32 v19, 256, v19
    v_mul_u32_u24 v20, 1639, v19
    v_lshrrev_b32 v20, 16, v20
    v_mul_u32_u24 v21, 40, v20
    v_sub_u32 v21, v19, v21
    v_bfe_u32 v22, v20, 1, 2
    v_lshlrev_b32 v22, 1, v22
    v_xor_b32 v21, v21, v22
    v_bfe_u32 v22, v20, 2, 2
    v_lshlrev_b32 v22, 3, v22
    v_and_b32 v19, 3, v20
    v_add_u32 v22, v22, v19
    v_lshrrev_b32 v20, 4, v20
    v_lshl_add_u32 v22, v20, 2, v22
    v_mul_lo_u32 v22, v22, s27
    v_lshl_add_u32 v22, v21, 4, v22
    v_add_u32 v8, s28, v22
    v_lshrrev_b32 v19, 2, v2
    v_lshl_add_u32 v19, v3, 2, v19
    v_bfe_u32 v20, v19, 1, 2
    v_lshlrev_b32 v20, 1, v20
    v_mul_u32_u24 v19, 640, v19
    v_and_b32 v21, 1, v2
    v_lshl_add_u32 v19, v21, 3, v19
    v_add_u32 v19, 81920, v19
    v_bfe_u32 v21, v2, 1, 1
    s_mul_i32 s29, s18, 10
    v_add_u32 v22, s29, v21
    v_xor_b32 v22, v22, v20
    v_lshl_add_u32 v224, v22, 4, v19
    v_add_u32 v225, 10240, v224
    v_add_u32 v22, s29, v21
    v_add_u32 v22, 2, v22
    v_xor_b32 v22, v22, v20
    v_lshl_add_u32 v226, v22, 4, v19
    v_add_u32 v227, 10240, v226
    v_add_u32 v22, s29, v21
    v_add_u32 v22, 4, v22
    v_xor_b32 v22, v22, v20
    v_lshl_add_u32 v228, v22, 4, v19
    v_add_u32 v229, 10240, v228
    v_add_u32 v22, s29, v21
    v_add_u32 v22, 6, v22
    v_xor_b32 v22, v22, v20
    v_lshl_add_u32 v230, v22, 4, v19
    v_add_u32 v231, 10240, v230
    v_add_u32 v22, s29, v21
    v_add_u32 v22, 8, v22
    v_xor_b32 v22, v22, v20
    v_lshl_add_u32 v232, v22, 4, v19
    v_add_u32 v233, 10240, v232
    s_branch K1_SRC_DONE
K1_SRC_PRIV:
    s_cmp_lt_u32 s18, 2
    s_cbranch_scc1 K1_SRC_PH
    s_cmp_eq_u32 s18, 2
    s_cselect_b32 s30, 2, 3
    s_mov_b32 s26, 25600
    s_mov_b32 s27, 40
    s_mov_b32 s28, 0
    s_mov_b32 s29, 2
    s_branch K1_SRC_P2
K1_SRC_PH:
    s_mov_b32 s30, 1
    s_mov_b32 s26, 2211840
    s_mov_b32 s27, 3456
    s_mul_i32 s28, s18, 160
    s_add_u32 s28, s28, 3200
    s_mov_b32 s29, 9
K1_SRC_P2:
    v_add_u32 v19, 0, v1
    v_mul_u32_u24 v20, 6554, v19
    v_lshrrev_b32 v20, 16, v20
    v_mul_u32_u24 v21, 10, v20
    v_sub_u32 v21, v19, v21
    v_min_u32 v21, s29, v21
    v_bfe_u32 v22, v20, 2, 2
    v_lshlrev_b32 v22, 3, v22
    v_and_b32 v19, 3, v20
    v_add_u32 v22, v22, v19
    v_lshrrev_b32 v20, 4, v20
    v_lshl_add_u32 v22, v20, 2, v22
    v_mul_lo_u32 v22, v22, s27
    v_lshl_add_u32 v22, v21, 4, v22
    v_add_u32 v4, s28, v22
    v_add_u32 v19, 64, v1
    v_mul_u32_u24 v20, 6554, v19
    v_lshrrev_b32 v20, 16, v20
    v_mul_u32_u24 v21, 10, v20
    v_sub_u32 v21, v19, v21
    v_min_u32 v21, s29, v21
    v_bfe_u32 v22, v20, 2, 2
    v_lshlrev_b32 v22, 3, v22
    v_and_b32 v19, 3, v20
    v_add_u32 v22, v22, v19
    v_lshrrev_b32 v20, 4, v20
    v_lshl_add_u32 v22, v20, 2, v22
    v_mul_lo_u32 v22, v22, s27
    v_lshl_add_u32 v22, v21, 4, v22
    v_add_u32 v5, s28, v22
    v_add_u32 v19, 128, v1
    v_mul_u32_u24 v20, 6554, v19
    v_lshrrev_b32 v20, 16, v20
    v_mul_u32_u24 v21, 10, v20
    v_sub_u32 v21, v19, v21
    v_min_u32 v21, s29, v21
    v_bfe_u32 v22, v20, 2, 2
    v_lshlrev_b32 v22, 3, v22
    v_and_b32 v19, 3, v20
    v_add_u32 v22, v22, v19
    v_lshrrev_b32 v20, 4, v20
    v_lshl_add_u32 v22, v20, 2, v22
    v_mul_lo_u32 v22, v22, s27
    v_lshl_add_u32 v22, v21, 4, v22
    v_add_u32 v6, s28, v22
    v_add_u32 v19, 192, v1
    v_mul_u32_u24 v20, 6554, v19
    v_lshrrev_b32 v20, 16, v20
    v_mul_u32_u24 v21, 10, v20
    v_sub_u32 v21, v19, v21
    v_min_u32 v21, s29, v21
    v_bfe_u32 v22, v20, 2, 2
    v_lshlrev_b32 v22, 3, v22
    v_and_b32 v19, 3, v20
    v_add_u32 v22, v22, v19
    v_lshrrev_b32 v20, 4, v20
    v_lshl_add_u32 v22, v20, 2, v22
    v_mul_lo_u32 v22, v22, s27
    v_lshl_add_u32 v22, v21, 4, v22
    v_add_u32 v7, s28, v22
    v_add_u32 v19, 256, v1
    v_mul_u32_u24 v20, 6554, v19
    v_lshrrev_b32 v20, 16, v20
    v_mul_u32_u24 v21, 10, v20
    v_sub_u32 v21, v19, v21
    v_min_u32 v21, s29, v21
    v_bfe_u32 v22, v20, 2, 2
    v_lshlrev_b32 v22, 3, v22
    v_and_b32 v19, 3, v20
    v_add_u32 v22, v22, v19
    v_lshrrev_b32 v20, 4, v20
    v_lshl_add_u32 v22, v20, 2, v22
    v_mul_lo_u32 v22, v22, s27
    v_lshl_add_u32 v22, v21, 4, v22
    v_add_u32 v8, s28, v22
    v_lshrrev_b32 v19, 2, v2
    v_lshl_add_u32 v19, v3, 2, v19
    v_mul_u32_u24 v19, 160, v19
    v_and_b32 v21, 3, v2
    v_lshl_add_u32 v19, v21, 3, v19
    s_mul_i32 s29, s18, 5120
    s_add_u32 s29, s29, 81920
    v_add_u32 v19, s29, v19
    v_add_u32 v224, 0, v19
    v_add_u32 v225, 2560, v19
    v_add_u32 v226, 32, v19
    v_add_u32 v227, 2592, v19
    v_add_u32 v228, 64, v19
    v_add_u32 v229, 2624, v19
    v_add_u32 v230, 96, v19
    v_add_u32 v231, 2656, v19
    v_add_u32 v232, 128, v19
    v_add_u32 v233, 2688, v19
K1_SRC_DONE:
    s_waitcnt lgkmcnt(0)
    s_mov_b32 s4, s44
    s_and_b32 s5, s45, 0xffff
    s_mov_b32 s6, 2621440
    s_mov_b32 s7, 0x00020000
    buffer_load_dwordx4 v[32:35], v208, s[4:7], 0 offen offset:0
    v_add_u32 v19, 0, v3
    v_xor_b32 v19, v19, v2
    v_lshlrev_b32 v19, 4, v19
    v_mul_u32_u24 v20, 1280, v2
    v_add_u32 v10, v19, v20
    v_add_u32 v19, 4, v3
    v_xor_b32 v19, v19, v2
    v_lshlrev_b32 v19, 4, v19
    v_mul_u32_u24 v20, 1280, v2
    v_add_u32 v11, v19, v20
    v_add_u32 v19, 8, v3
    v_xor_b32 v19, v19, v2
    v_lshlrev_b32 v19, 4, v19
    v_mul_u32_u24 v20, 1280, v2
    v_add_u32 v12, v19, v20
    v_add_u32 v19, 12, v3
    buffer_load_dwordx4 v[36:39], v208, s[4:7], 0 offen offset:256
    v_xor_b32 v19, v19, v2
    v_lshlrev_b32 v19, 4, v19
    v_mul_u32_u24 v20, 1280, v2
    v_add_u32 v13, v19, v20
    v_mov_b32 v112, 0
    v_mov_b32 v113, 0
    v_mov_b32 v114, 0
    v_mov_b32 v115, 0
    v_mov_b32 v116, 0
    v_mov_b32 v117, 0
    v_mov_b32 v118, 0
    v_mov_b32 v119, 0
    v_mov_b32 v120, 0
    v_mov_b32 v121, 0
    v_mov_b32 v122, 0
    v_mov_b32 v123, 0
    buffer_load_dwordx4 v[40:43], v208, s[4:7], 0 offen offset:512
    v_mov_b32 v124, 0
    v_mov_b32 v125, 0
    v_mov_b32 v126, 0
    v_mov_b32 v127, 0
    v_mov_b32 v128, 0
    v_mov_b32 v129, 0
    v_mov_b32 v130, 0
    v_mov_b32 v131, 0
    v_mov_b32 v132, 0
    v_mov_b32 v133, 0
    v_mov_b32 v134, 0
    v_mov_b32 v135, 0
    v_mov_b32 v136, 0
    v_mov_b32 v137, 0
    v_mov_b32 v138, 0
    v_mov_b32 v139, 0
    buffer_load_dwordx4 v[44:47], v208, s[4:7], 0 offen offset:768
    v_mov_b32 v140, 0
    v_mov_b32 v141, 0
    v_mov_b32 v142, 0
    v_mov_b32 v143, 0
    v_mov_b32 v144, 0
    v_mov_b32 v145, 0
    v_mov_b32 v146, 0
    v_mov_b32 v147, 0
    v_mov_b32 v148, 0
    v_mov_b32 v149, 0
    v_mov_b32 v150, 0
    v_mov_b32 v151, 0
    v_mov_b32 v152, 0
    v_mov_b32 v153, 0
    v_mov_b32 v154, 0
    v_mov_b32 v155, 0
    buffer_load_dwordx4 v[48:51], v208, s[4:7], 0 offen offset:1024
    v_mov_b32 v156, 0
    v_mov_b32 v157, 0
    v_mov_b32 v158, 0
    v_mov_b32 v159, 0
    v_mov_b32 v160, 0
    v_mov_b32 v161, 0
    v_mov_b32 v162, 0
    v_mov_b32 v163, 0
    v_mov_b32 v164, 0
    v_mov_b32 v165, 0
    v_mov_b32 v166, 0
    v_mov_b32 v167, 0
    v_mov_b32 v168, 0
    v_mov_b32 v169, 0
    v_mov_b32 v170, 0
    v_mov_b32 v171, 0
    buffer_load_dwordx4 v[52:55], v209, s[4:7], 0 offen offset:0
    v_mov_b32 v172, 0
    v_mov_b32 v173, 0
    v_mov_b32 v174, 0
    v_mov_b32 v175, 0
    v_mov_b32 v176, 0
    v_mov_b32 v177, 0
    v_mov_b32 v178, 0
    v_mov_b32 v179, 0
    v_mov_b32 v180, 0
    v_mov_b32 v181, 0
    v_mov_b32 v182, 0
    v_mov_b32 v183, 0
    v_mov_b32 v184, 0
    v_mov_b32 v185, 0
    v_mov_b32 v186, 0
    v_mov_b32 v187, 0
    buffer_load_dwordx4 v[56:59], v209, s[4:7], 0 offen offset:256
    v_mov_b32 v188, 0
    v_mov_b32 v189, 0
    v_mov_b32 v190, 0
    v_mov_b32 v191, 0
    s_mov_b32 s40, 0x3f803f80
    s_mov_b32 s41, 0x00003f80
    s_mov_b32 s42, 0x3f800000
    s_lshl_b32 s32, s18, 4
    v_add_u32 v220, 0, v3
    v_xor_b32 v216, v220, v2
    v_lshlrev_b32 v216, 4, v216
    v_add_u32 v220, s32, v220
    v_mul_u32_u24 v19, 1280, v220
    v_add_u32 v216, v216, v19
    v_lshlrev_b32 v220, 2, v220
    v_add_u32 v220, 143360, v220
    buffer_load_dwordx4 v[60:63], v209, s[4:7], 0 offen offset:512
    v_add_u32 v221, 4, v3
    v_xor_b32 v217, v221, v2
    v_lshlrev_b32 v217, 4, v217
    v_add_u32 v221, s32, v221
    v_mul_u32_u24 v19, 1280, v221
    v_add_u32 v217, v217, v19
    v_lshlrev_b32 v221, 2, v221
    v_add_u32 v221, 143360, v221
    v_add_u32 v222, 8, v3
    v_xor_b32 v218, v222, v2
    v_lshlrev_b32 v218, 4, v218
    v_add_u32 v222, s32, v222
    v_mul_u32_u24 v19, 1280, v222
    v_add_u32 v218, v218, v19
    v_lshlrev_b32 v222, 2, v222
    v_add_u32 v222, 143360, v222
    buffer_load_dwordx4 v[64:67], v209, s[4:7], 0 offen offset:768
    v_add_u32 v223, 12, v3
    v_xor_b32 v219, v223, v2
    v_lshlrev_b32 v219, 4, v219
    v_add_u32 v223, s32, v223
    v_mul_u32_u24 v19, 1280, v223
    v_add_u32 v219, v219, v19
    v_lshlrev_b32 v223, 2, v223
    v_add_u32 v223, 143360, v223
    s_cmp_eq_u32 s30, 0
    s_cselect_b32 s24, s46, s56
    s_cselect_b32 s25, s47, s57
    s_cmp_eq_u32 s30, 2
    s_cselect_b32 s24, s48, s24
    s_cselect_b32 s25, s49, s25
    s_cmp_eq_u32 s30, 3
    s_cselect_b32 s24, s50, s24
    buffer_load_dwordx4 v[68:71], v209, s[4:7], 0 offen offset:1024
    s_cselect_b32 s25, s51, s25
    s_mov_b32 s8, s24
    s_and_b32 s9, s25, 0xffff
    s_mov_b32 s10, s26
    s_mov_b32 s11, 0x00020000
    s_lshl_b32 s20, s27, 5
    s_mul_i32 s22, s18, 5120
    s_add_u32 s22, s22, 81920
    s_mov_b32 s21, 0
    s_mov_b32 s12, s64
    s_and_b32 s13, s65, 0xffff
    s_mov_b32 s14, 16777216
    s_mov_b32 s15, 0x00020000
    s_waitcnt vmcnt(5)
    v_dot2_f32_bf16 v192, v32, s40, 0
    v_dot2_f32_bf16 v194, v32, v32, 0
    v_dot2_f32_bf16 v193, v33, s40, 0
    v_dot2_f32_bf16 v195, v33, v33, 0
    v_dot2_f32_bf16 v192, v34, s40, v192
    v_dot2_f32_bf16 v194, v34, v34, v194
    v_dot2_f32_bf16 v193, v35, s40, v193
    v_dot2_f32_bf16 v195, v35, v35, v195
    buffer_load_dwordx4 v[72:75], v210, s[4:7], 0 offen offset:0
    v_dot2_f32_bf16 v192, v36, s40, v192
    v_dot2_f32_bf16 v194, v36, v36, v194
    v_dot2_f32_bf16 v193, v37, s40, v193
    v_dot2_f32_bf16 v195, v37, v37, v195
    v_dot2_f32_bf16 v192, v38, s40, v192
    v_dot2_f32_bf16 v194, v38, v38, v194
    v_dot2_f32_bf16 v193, v39, s40, v193
    v_dot2_f32_bf16 v195, v39, v39, v195
    buffer_load_dwordx4 v[76:79], v210, s[4:7], 0 offen offset:256
    v_dot2_f32_bf16 v192, v40, s40, v192
    v_dot2_f32_bf16 v194, v40, v40, v194
    v_dot2_f32_bf16 v193, v41, s40, v193
    v_dot2_f32_bf16 v195, v41, v41, v195
    v_dot2_f32_bf16 v192, v42, s40, v192
    v_dot2_f32_bf16 v194, v42, v42, v194
    v_dot2_f32_bf16 v193, v43, s40, v193
    v_dot2_f32_bf16 v195, v43, v43, v195
    buffer_load_dwordx4 v[80:83], v210, s[4:7], 0 offen offset:512
    v_dot2_f32_bf16 v192, v44, s40, v192
    v_dot2_f32_bf16 v194, v44, v44, v194
    v_dot2_f32_bf16 v193, v45, s40, v193
    v_dot2_f32_bf16 v195, v45, v45, v195
    v_dot2_f32_bf16 v192, v46, s40, v192
    v_dot2_f32_bf16 v194, v46, v46, v194
    v_dot2_f32_bf16 v193, v47, s40, v193
    v_dot2_f32_bf16 v195, v47, v47, v195
    buffer_load_dwordx4 v[84:87], v210, s[4:7], 0 offen offset:768
    v_dot2_f32_bf16 v192, v48, s40, v192
    v_dot2_f32_bf16 v194, v48, v48, v194
    v_dot2_f32_bf16 v193, v49, s40, v193
    v_dot2_f32_bf16 v195, v49, v49, v195
    v_dot2_f32_bf16 v192, v50, s40, v192
    v_dot2_f32_bf16 v194, v50, v50, v194
    v_dot2_f32_bf16 v193, v51, s40, v193
    v_dot2_f32_bf16 v195, v51, v51, v195
    buffer_load_dwordx4 v[88:91], v210, s[4:7], 0 offen offset:1024
    s_nop 2
    v_add_f32 v192, v192, v193
    v_add_f32 v194, v194, v195
    s_nop 0
    v_add_f32_dpp v192, v192, v192 row_ror:8 row_mask:0xf bank_mask:0xf
    v_add_f32_dpp v194, v194, v194 row_ror:8 row_mask:0xf bank_mask:0xf
    s_nop 0
    v_add_f32_dpp v192, v192, v192 row_ror:4 row_mask:0xf bank_mask:0xf
    v_add_f32_dpp v194, v194, v194 row_ror:4 row_mask:0xf bank_mask:0xf
    s_nop 0
    v_add_f32_dpp v192, v192, v192 row_ror:2 row_mask:0xf bank_mask:0xf
    v_add_f32_dpp v194, v194, v194 row_ror:2 row_mask:0xf bank_mask:0xf
    s_nop 0
    v_add_f32_dpp v192, v192, v192 row_ror:1 row_mask:0xf bank_mask:0xf
    v_add_f32_dpp v194, v194, v194 row_ror:1 row_mask:0xf bank_mask:0xf
    v_mul_f32 v196, 0x3acccccd, v192
    v_mul_f32 v194, 0x3acccccd, v194
    v_fma_f32 v194, -v196, v196, v194
    v_max_f32 v194, 0, v194
    v_add_f32 v194, 0x3727c5ac, v194
    v_rsq_f32 v197, v194
    v_sub_f32 v196, 0, v196
    v_dot2_f32_bf16 v200, v32, s41, v196
    v_dot2_f32_bf16 v201, v32, s42, v196
    v_dot2_f32_bf16 v202, v33, s41, v196
    v_dot2_f32_bf16 v203, v33, s42, v196
    v_dot2_f32_bf16 v204, v34, s41, v196
    v_dot2_f32_bf16 v205, v34, s42, v196
    v_dot2_f32_bf16 v206, v35, s41, v196
    v_dot2_f32_bf16 v207, v35, s42, v196
    s_nop 0
    v_cvt_pk_bf16_f32 v32, v200, v201
    v_cvt_pk_bf16_f32 v33, v202, v203
    v_cvt_pk_bf16_f32 v34, v204, v205
    v_cvt_pk_bf16_f32 v35, v206, v207
    ds_write_b128 v216, v[32:35] offset:0
    buffer_load_dwordx4 v[92:95], v211, s[4:7], 0 offen offset:0
    v_dot2_f32_bf16 v200, v36, s41, v196
    v_dot2_f32_bf16 v201, v36, s42, v196
    v_dot2_f32_bf16 v202, v37, s41, v196
    v_dot2_f32_bf16 v203, v37, s42, v196
    v_dot2_f32_bf16 v204, v38, s41, v196
    v_dot2_f32_bf16 v205, v38, s42, v196
    v_dot2_f32_bf16 v206, v39, s41, v196
    v_dot2_f32_bf16 v207, v39, s42, v196
    s_nop 0
    v_cvt_pk_bf16_f32 v36, v200, v201
    v_cvt_pk_bf16_f32 v37, v202, v203
    v_cvt_pk_bf16_f32 v38, v204, v205
    v_cvt_pk_bf16_f32 v39, v206, v207
    ds_write_b128 v216, v[36:39] offset:256
    buffer_load_dwordx4 v[96:99], v211, s[4:7], 0 offen offset:256
    v_dot2_f32_bf16 v200, v40, s41, v196
    v_dot2_f32_bf16 v201, v40, s42, v196
    v_dot2_f32_bf16 v202, v41, s41, v196
    v_dot2_f32_bf16 v203, v41, s42, v196
    v_dot2_f32_bf16 v204, v42, s41, v196
    v_dot2_f32_bf16 v205, v42, s42, v196
    v_dot2_f32_bf16 v206, v43, s41, v196
    v_dot2_f32_bf16 v207, v43, s42, v196
    s_nop 0
    v_cvt_pk_bf16_f32 v40, v200, v201
    v_cvt_pk_bf16_f32 v41, v202, v203
    v_cvt_pk_bf16_f32 v42, v204, v205
    v_cvt_pk_bf16_f32 v43, v206, v207
    ds_write_b128 v216, v[40:43] offset:512
    buffer_load_dwordx4 v[100:103], v211, s[4:7], 0 offen offset:512
    v_dot2_f32_bf16 v200, v44, s41, v196
    v_dot2_f32_bf16 v201, v44, s42, v196
    v_dot2_f32_bf16 v202, v45, s41, v196
    v_dot2_f32_bf16 v203, v45, s42, v196
    v_dot2_f32_bf16 v204, v46, s41, v196
    v_dot2_f32_bf16 v205, v46, s42, v196
    v_dot2_f32_bf16 v206, v47, s41, v196
    v_dot2_f32_bf16 v207, v47, s42, v196
    s_nop 0
    v_cvt_pk_bf16_f32 v44, v200, v201
    v_cvt_pk_bf16_f32 v45, v202, v203
    v_cvt_pk_bf16_f32 v46, v204, v205
    v_cvt_pk_bf16_f32 v47, v206, v207
    ds_write_b128 v216, v[44:47] offset:768
    buffer_load_dwordx4 v[104:107], v211, s[4:7], 0 offen offset:768
    v_dot2_f32_bf16 v200, v48, s41, v196
    v_dot2_f32_bf16 v201, v48, s42, v196
    v_dot2_f32_bf16 v202, v49, s41, v196
    v_dot2_f32_bf16 v203, v49, s42, v196
    v_dot2_f32_bf16 v204, v50, s41, v196
    v_dot2_f32_bf16 v205, v50, s42, v196
    v_dot2_f32_bf16 v206, v51, s41, v196
    v_dot2_f32_bf16 v207, v51, s42, v196
    s_nop 0
    v_cvt_pk_bf16_f32 v48, v200, v201
    v_cvt_pk_bf16_f32 v49, v202, v203
    v_cvt_pk_bf16_f32 v50, v204, v205
    v_cvt_pk_bf16_f32 v51, v206, v207
    ds_write_b128 v216, v[48:51] offset:1024
    buffer_load_dwordx4 v[108:111], v211, s[4:7], 0 offen offset:1024
    ds_write_b32 v220, v197
    s_waitcnt vmcnt(10)
    v_dot2_f32_bf16 v192, v52, s40, 0
    v_dot2_f32_bf16 v194, v52, v52, 0
    v_dot2_f32_bf16 v193, v53, s40, 0
    v_dot2_f32_bf16 v195, v53, v53, 0
    v_dot2_f32_bf16 v192, v54, s40, v192
    v_dot2_f32_bf16 v194, v54, v54, v194
    v_dot2_f32_bf16 v193, v55, s40, v193
    v_dot2_f32_bf16 v195, v55, v55, v195
    v_dot2_f32_bf16 v192, v56, s40, v192
    v_dot2_f32_bf16 v194, v56, v56, v194
    v_dot2_f32_bf16 v193, v57, s40, v193
    v_dot2_f32_bf16 v195, v57, v57, v195
    v_dot2_f32_bf16 v192, v58, s40, v192
    v_dot2_f32_bf16 v194, v58, v58, v194
    v_dot2_f32_bf16 v193, v59, s40, v193
    v_dot2_f32_bf16 v195, v59, v59, v195
    v_dot2_f32_bf16 v192, v60, s40, v192
    v_dot2_f32_bf16 v194, v60, v60, v194
    v_dot2_f32_bf16 v193, v61, s40, v193
    v_dot2_f32_bf16 v195, v61, v61, v195
    v_dot2_f32_bf16 v192, v62, s40, v192
    v_dot2_f32_bf16 v194, v62, v62, v194
    v_dot2_f32_bf16 v193, v63, s40, v193
    v_dot2_f32_bf16 v195, v63, v63, v195
    v_dot2_f32_bf16 v192, v64, s40, v192
    v_dot2_f32_bf16 v194, v64, v64, v194
    v_dot2_f32_bf16 v193, v65, s40, v193
    v_dot2_f32_bf16 v195, v65, v65, v195
    v_dot2_f32_bf16 v192, v66, s40, v192
    v_dot2_f32_bf16 v194, v66, v66, v194
    v_dot2_f32_bf16 v193, v67, s40, v193
    v_dot2_f32_bf16 v195, v67, v67, v195
    v_dot2_f32_bf16 v192, v68, s40, v192
    v_dot2_f32_bf16 v194, v68, v68, v194
    v_dot2_f32_bf16 v193, v69, s40, v193
    v_dot2_f32_bf16 v195, v69, v69, v195
    v_dot2_f32_bf16 v192, v70, s40, v192
    v_dot2_f32_bf16 v194, v70, v70, v194
    v_dot2_f32_bf16 v193, v71, s40, v193
    v_dot2_f32_bf16 v195, v71, v71, v195
    s_nop 2
    v_add_f32 v192, v192, v193
    v_add_f32 v194, v194, v195
    s_nop 0
    v_add_f32_dpp v192, v192, v192 row_ror:8 row_mask:0xf bank_mask:0xf
    v_add_f32_dpp v194, v194, v194 row_ror:8 row_mask:0xf bank_mask:0xf
    s_nop 0
    v_add_f32_dpp v192, v192, v192 row_ror:4 row_mask:0xf bank_mask:0xf
    v_add_f32_dpp v194, v194, v194 row_ror:4 row_mask:0xf bank_mask:0xf
    s_nop 0
    v_add_f32_dpp v192, v192, v192 row_ror:2 row_mask:0xf bank_mask:0xf
    v_add_f32_dpp v194, v194, v194 row_ror:2 row_mask:0xf bank_mask:0xf
    s_nop 0
    v_add_f32_dpp v192, v192, v192 row_ror:1 row_mask:0xf bank_mask:0xf
    v_add_f32_dpp v194, v194, v194 row_ror:1 row_mask:0xf bank_mask:0xf
    v_mul_f32 v196, 0x3acccccd, v192
    v_mul_f32 v194, 0x3acccccd, v194
    v_fma_f32 v194, -v196, v196, v194
    v_max_f32 v194, 0, v194
    v_add_f32 v194, 0x3727c5ac, v194
    v_rsq_f32 v197, v194
    v_sub_f32 v196, 0, v196
    v_dot2_f32_bf16 v200, v52, s41, v196
    v_dot2_f32_bf16 v201, v52, s42, v196
    v_dot2_f32_bf16 v202, v53, s41, v196
    v_dot2_f32_bf16 v203, v53, s42, v196
    v_dot2_f32_bf16 v204, v54, s41, v196
    v_dot2_f32_bf16 v205, v54, s42, v196
    v_dot2_f32_bf16 v206, v55, s41, v196
    v_dot2_f32_bf16 v207, v55, s42, v196
    s_nop 0
    v_cvt_pk_bf16_f32 v52, v200, v201
    v_cvt_pk_bf16_f32 v53, v202, v203
    v_cvt_pk_bf16_f32 v54, v204, v205
    v_cvt_pk_bf16_f32 v55, v206, v207
    s_add_u32 m0, s22, 0
    ds_write_b128 v217, v[52:55] offset:0
    buffer_load_dwordx4 v4, s[8:11], s21 offen lds
    v_dot2_f32_bf16 v200, v56, s41, v196
    v_dot2_f32_bf16 v201, v56, s42, v196
    v_dot2_f32_bf16 v202, v57, s41, v196
    v_dot2_f32_bf16 v203, v57, s42, v196
    v_dot2_f32_bf16 v204, v58, s41, v196
    v_dot2_f32_bf16 v205, v58, s42, v196
    v_dot2_f32_bf16 v206, v59, s41, v196
    v_dot2_f32_bf16 v207, v59, s42, v196
    s_nop 0
    v_cvt_pk_bf16_f32 v56, v200, v201
    v_cvt_pk_bf16_f32 v57, v202, v203
    v_cvt_pk_bf16_f32 v58, v204, v205
    v_cvt_pk_bf16_f32 v59, v206, v207
    s_add_u32 m0, s22, 1024
    ds_write_b128 v217, v[56:59] offset:256
    buffer_load_dwordx4 v5, s[8:11], s21 offen lds
    v_dot2_f32_bf16 v200, v60, s41, v196
    v_dot2_f32_bf16 v201, v60, s42, v196
    v_dot2_f32_bf16 v202, v61, s41, v196
    v_dot2_f32_bf16 v203, v61, s42, v196
    v_dot2_f32_bf16 v204, v62, s41, v196
    v_dot2_f32_bf16 v205, v62, s42, v196
    v_dot2_f32_bf16 v206, v63, s41, v196
    v_dot2_f32_bf16 v207, v63, s42, v196
    s_nop 0
    v_cvt_pk_bf16_f32 v60, v200, v201
    v_cvt_pk_bf16_f32 v61, v202, v203
    v_cvt_pk_bf16_f32 v62, v204, v205
    v_cvt_pk_bf16_f32 v63, v206, v207
    s_add_u32 m0, s22, 2048
    ds_write_b128 v217, v[60:63] offset:512
    buffer_load_dwordx4 v6, s[8:11], s21 offen lds
    v_dot2_f32_bf16 v200, v64, s41, v196
    v_dot2_f32_bf16 v201, v64, s42, v196
    v_dot2_f32_bf16 v202, v65, s41, v196
    v_dot2_f32_bf16 v203, v65, s42, v196
    v_dot2_f32_bf16 v204, v66, s41, v196
    v_dot2_f32_bf16 v205, v66, s42, v196
    v_dot2_f32_bf16 v206, v67, s41, v196
    v_dot2_f32_bf16 v207, v67, s42, v196
    s_nop 0
    v_cvt_pk_bf16_f32 v64, v200, v201
    v_cvt_pk_bf16_f32 v65, v202, v203
    v_cvt_pk_bf16_f32 v66, v204, v205
    v_cvt_pk_bf16_f32 v67, v206, v207
    s_add_u32 m0, s22, 3072
    ds_write_b128 v217, v[64:67] offset:768
    buffer_load_dwordx4 v7, s[8:11], s21 offen lds
    v_dot2_f32_bf16 v200, v68, s41, v196
    v_dot2_f32_bf16 v201, v68, s42, v196
    v_dot2_f32_bf16 v202, v69, s41, v196
    v_dot2_f32_bf16 v203, v69, s42, v196
    v_dot2_f32_bf16 v204, v70, s41, v196
    v_dot2_f32_bf16 v205, v70, s42, v196
    v_dot2_f32_bf16 v206, v71, s41, v196
    v_dot2_f32_bf16 v207, v71, s42, v196
    s_nop 0
    v_cvt_pk_bf16_f32 v68, v200, v201
    v_cvt_pk_bf16_f32 v69, v202, v203
    v_cvt_pk_bf16_f32 v70, v204, v205
    v_cvt_pk_bf16_f32 v71, v206, v207
    s_add_u32 m0, s22, 4096
    ds_write_b128 v217, v[68:71] offset:1024
    buffer_load_dwordx4 v8, s[8:11], s21 offen lds
    ds_write_b32 v221, v197
    s_add_u32 s21, s21, s20
    s_waitcnt vmcnt(10)
    v_dot2_f32_bf16 v192, v72, s40, 0
    v_dot2_f32_bf16 v194, v72, v72, 0
    v_dot2_f32_bf16 v193, v73, s40, 0
    v_dot2_f32_bf16 v195, v73, v73, 0
    v_dot2_f32_bf16 v192, v74, s40, v192
    v_dot2_f32_bf16 v194, v74, v74, v194
    v_dot2_f32_bf16 v193, v75, s40, v193
    v_dot2_f32_bf16 v195, v75, v75, v195
    v_dot2_f32_bf16 v192, v76, s40, v192
    v_dot2_f32_bf16 v194, v76, v76, v194
    v_dot2_f32_bf16 v193, v77, s40, v193
    v_dot2_f32_bf16 v195, v77, v77, v195
    v_dot2_f32_bf16 v192, v78, s40, v192
    v_dot2_f32_bf16 v194, v78, v78, v194
    v_dot2_f32_bf16 v193, v79, s40, v193
    v_dot2_f32_bf16 v195, v79, v79, v195
    v_dot2_f32_bf16 v192, v80, s40, v192
    v_dot2_f32_bf16 v194, v80, v80, v194
    v_dot2_f32_bf16 v193, v81, s40, v193
    v_dot2_f32_bf16 v195, v81, v81, v195
    v_dot2_f32_bf16 v192, v82, s40, v192
    v_dot2_f32_bf16 v194, v82, v82, v194
    v_dot2_f32_bf16 v193, v83, s40, v193
    v_dot2_f32_bf16 v195, v83, v83, v195
    v_dot2_f32_bf16 v192, v84, s40, v192
    v_dot2_f32_bf16 v194, v84, v84, v194
    v_dot2_f32_bf16 v193, v85, s40, v193
    v_dot2_f32_bf16 v195, v85, v85, v195
    v_dot2_f32_bf16 v192, v86, s40, v192
    v_dot2_f32_bf16 v194, v86, v86, v194
    v_dot2_f32_bf16 v193, v87, s40, v193
    v_dot2_f32_bf16 v195, v87, v87, v195
    v_dot2_f32_bf16 v192, v88, s40, v192
    v_dot2_f32_bf16 v194, v88, v88, v194
    v_dot2_f32_bf16 v193, v89, s40, v193
    v_dot2_f32_bf16 v195, v89, v89, v195
    v_dot2_f32_bf16 v192, v90, s40, v192
    v_dot2_f32_bf16 v194, v90, v90, v194
    v_dot2_f32_bf16 v193, v91, s40, v193
    v_dot2_f32_bf16 v195, v91, v91, v195
    s_nop 2
    v_add_f32 v192, v192, v193
    v_add_f32 v194, v194, v195
    s_nop 0
    v_add_f32_dpp v192, v192, v192 row_ror:8 row_mask:0xf bank_mask:0xf
    v_add_f32_dpp v194, v194, v194 row_ror:8 row_mask:0xf bank_mask:0xf
    s_nop 0
    v_add_f32_dpp v192, v192, v192 row_ror:4 row_mask:0xf bank_mask:0xf
    v_add_f32_dpp v194, v194, v194 row_ror:4 row_mask:0xf bank_mask:0xf
    s_nop 0
    v_add_f32_dpp v192, v192, v192 row_ror:2 row_mask:0xf bank_mask:0xf
    v_add_f32_dpp v194, v194, v194 row_ror:2 row_mask:0xf bank_mask:0xf
    s_nop 0
    v_add_f32_dpp v192, v192, v192 row_ror:1 row_mask:0xf bank_mask:0xf
    v_add_f32_dpp v194, v194, v194 row_ror:1 row_mask:0xf bank_mask:0xf
    v_mul_f32 v196, 0x3acccccd, v192
    v_mul_f32 v194, 0x3acccccd, v194
    v_fma_f32 v194, -v196, v196, v194
    v_max_f32 v194, 0, v194
    v_add_f32 v194, 0x3727c5ac, v194
    v_rsq_f32 v197, v194
    v_sub_f32 v196, 0, v196
    v_dot2_f32_bf16 v200, v72, s41, v196
    v_dot2_f32_bf16 v201, v72, s42, v196
    v_dot2_f32_bf16 v202, v73, s41, v196
    v_dot2_f32_bf16 v203, v73, s42, v196
    v_dot2_f32_bf16 v204, v74, s41, v196
    v_dot2_f32_bf16 v205, v74, s42, v196
    v_dot2_f32_bf16 v206, v75, s41, v196
    v_dot2_f32_bf16 v207, v75, s42, v196
    s_nop 0
    v_cvt_pk_bf16_f32 v72, v200, v201
    v_cvt_pk_bf16_f32 v73, v202, v203
    v_cvt_pk_bf16_f32 v74, v204, v205
    v_cvt_pk_bf16_f32 v75, v206, v207
    s_add_u32 m0, s22, 20480
    ds_write_b128 v218, v[72:75] offset:0
    buffer_load_dwordx4 v4, s[8:11], s21 offen lds
    v_dot2_f32_bf16 v200, v76, s41, v196
    v_dot2_f32_bf16 v201, v76, s42, v196
    v_dot2_f32_bf16 v202, v77, s41, v196
    v_dot2_f32_bf16 v203, v77, s42, v196
    v_dot2_f32_bf16 v204, v78, s41, v196
    v_dot2_f32_bf16 v205, v78, s42, v196
    v_dot2_f32_bf16 v206, v79, s41, v196
    v_dot2_f32_bf16 v207, v79, s42, v196
    s_nop 0
    v_cvt_pk_bf16_f32 v76, v200, v201
    v_cvt_pk_bf16_f32 v77, v202, v203
    v_cvt_pk_bf16_f32 v78, v204, v205
    v_cvt_pk_bf16_f32 v79, v206, v207
    s_add_u32 m0, s22, 21504
    ds_write_b128 v218, v[76:79] offset:256
    buffer_load_dwordx4 v5, s[8:11], s21 offen lds
    v_dot2_f32_bf16 v200, v80, s41, v196
    v_dot2_f32_bf16 v201, v80, s42, v196
    v_dot2_f32_bf16 v202, v81, s41, v196
    v_dot2_f32_bf16 v203, v81, s42, v196
    v_dot2_f32_bf16 v204, v82, s41, v196
    v_dot2_f32_bf16 v205, v82, s42, v196
    v_dot2_f32_bf16 v206, v83, s41, v196
    v_dot2_f32_bf16 v207, v83, s42, v196
    s_nop 0
    v_cvt_pk_bf16_f32 v80, v200, v201
    v_cvt_pk_bf16_f32 v81, v202, v203
    v_cvt_pk_bf16_f32 v82, v204, v205
    v_cvt_pk_bf16_f32 v83, v206, v207
    s_add_u32 m0, s22, 22528
    ds_write_b128 v218, v[80:83] offset:512
    buffer_load_dwordx4 v6, s[8:11], s21 offen lds
    v_dot2_f32_bf16 v200, v84, s41, v196
    v_dot2_f32_bf16 v201, v84, s42, v196
    v_dot2_f32_bf16 v202, v85, s41, v196
    v_dot2_f32_bf16 v203, v85, s42, v196
    v_dot2_f32_bf16 v204, v86, s41, v196
    v_dot2_f32_bf16 v205, v86, s42, v196
    v_dot2_f32_bf16 v206, v87, s41, v196
    v_dot2_f32_bf16 v207, v87, s42, v196
    s_nop 0
    v_cvt_pk_bf16_f32 v84, v200, v201
    v_cvt_pk_bf16_f32 v85, v202, v203
    v_cvt_pk_bf16_f32 v86, v204, v205
    v_cvt_pk_bf16_f32 v87, v206, v207
    s_add_u32 m0, s22, 23552
    ds_write_b128 v218, v[84:87] offset:768
    buffer_load_dwordx4 v7, s[8:11], s21 offen lds
    v_dot2_f32_bf16 v200, v88, s41, v196
    v_dot2_f32_bf16 v201, v88, s42, v196
    v_dot2_f32_bf16 v202, v89, s41, v196
    v_dot2_f32_bf16 v203, v89, s42, v196
    v_dot2_f32_bf16 v204, v90, s41, v196
    v_dot2_f32_bf16 v205, v90, s42, v196
    v_dot2_f32_bf16 v206, v91, s41, v196
    v_dot2_f32_bf16 v207, v91, s42, v196
    s_nop 0
    v_cvt_pk_bf16_f32 v88, v200, v201
    v_cvt_pk_bf16_f32 v89, v202, v203
    v_cvt_pk_bf16_f32 v90, v204, v205
    v_cvt_pk_bf16_f32 v91, v206, v207
    s_add_u32 m0, s22, 24576
    ds_write_b128 v218, v[88:91] offset:1024
    buffer_load_dwordx4 v8, s[8:11], s21 offen lds
    ds_write_b32 v222, v197
    s_add_u32 s21, s21, s20
    s_waitcnt vmcnt(10)
    v_dot2_f32_bf16 v192, v92, s40, 0
    v_dot2_f32_bf16 v194, v92, v92, 0
    v_dot2_f32_bf16 v193, v93, s40, 0
    v_dot2_f32_bf16 v195, v93, v93, 0
    v_dot2_f32_bf16 v192, v94, s40, v192
    v_dot2_f32_bf16 v194, v94, v94, v194
    v_dot2_f32_bf16 v193, v95, s40, v193
    v_dot2_f32_bf16 v195, v95, v95, v195
    v_dot2_f32_bf16 v192, v96, s40, v192
    v_dot2_f32_bf16 v194, v96, v96, v194
    v_dot2_f32_bf16 v193, v97, s40, v193
    v_dot2_f32_bf16 v195, v97, v97, v195
    v_dot2_f32_bf16 v192, v98, s40, v192
    v_dot2_f32_bf16 v194, v98, v98, v194
    v_dot2_f32_bf16 v193, v99, s40, v193
    v_dot2_f32_bf16 v195, v99, v99, v195
    v_dot2_f32_bf16 v192, v100, s40, v192
    v_dot2_f32_bf16 v194, v100, v100, v194
    v_dot2_f32_bf16 v193, v101, s40, v193
    v_dot2_f32_bf16 v195, v101, v101, v195
    v_dot2_f32_bf16 v192, v102, s40, v192
    v_dot2_f32_bf16 v194, v102, v102, v194
    v_dot2_f32_bf16 v193, v103, s40, v193
    v_dot2_f32_bf16 v195, v103, v103, v195
    v_dot2_f32_bf16 v192, v104, s40, v192
    v_dot2_f32_bf16 v194, v104, v104, v194
    v_dot2_f32_bf16 v193, v105, s40, v193
    v_dot2_f32_bf16 v195, v105, v105, v195
    v_dot2_f32_bf16 v192, v106, s40, v192
    v_dot2_f32_bf16 v194, v106, v106, v194
    v_dot2_f32_bf16 v193, v107, s40, v193
    v_dot2_f32_bf16 v195, v107, v107, v195
    v_dot2_f32_bf16 v192, v108, s40, v192
    v_dot2_f32_bf16 v194, v108, v108, v194
    v_dot2_f32_bf16 v193, v109, s40, v193
    v_dot2_f32_bf16 v195, v109, v109, v195
    v_dot2_f32_bf16 v192, v110, s40, v192
    v_dot2_f32_bf16 v194, v110, v110, v194
    v_dot2_f32_bf16 v193, v111, s40, v193
    v_dot2_f32_bf16 v195, v111, v111, v195
    s_nop 2
    v_add_f32 v192, v192, v193
    v_add_f32 v194, v194, v195
    s_nop 0
    v_add_f32_dpp v192, v192, v192 row_ror:8 row_mask:0xf bank_mask:0xf
    v_add_f32_dpp v194, v194, v194 row_ror:8 row_mask:0xf bank_mask:0xf
    s_nop 0
    v_add_f32_dpp v192, v192, v192 row_ror:4 row_mask:0xf bank_mask:0xf
    v_add_f32_dpp v194, v194, v194 row_ror:4 row_mask:0xf bank_mask:0xf
    s_nop 0
    v_add_f32_dpp v192, v192, v192 row_ror:2 row_mask:0xf bank_mask:0xf
    v_add_f32_dpp v194, v194, v194 row_ror:2 row_mask:0xf bank_mask:0xf
    s_nop 0
    v_add_f32_dpp v192, v192, v192 row_ror:1 row_mask:0xf bank_mask:0xf
    v_add_f32_dpp v194, v194, v194 row_ror:1 row_mask:0xf bank_mask:0xf
    v_mul_f32 v196, 0x3acccccd, v192
    v_mul_f32 v194, 0x3acccccd, v194
    v_fma_f32 v194, -v196, v196, v194
    v_max_f32 v194, 0, v194
    v_add_f32 v194, 0x3727c5ac, v194
    v_rsq_f32 v197, v194
    v_sub_f32 v196, 0, v196
    v_dot2_f32_bf16 v200, v92, s41, v196
    v_dot2_f32_bf16 v201, v92, s42, v196
    v_dot2_f32_bf16 v202, v93, s41, v196
    v_dot2_f32_bf16 v203, v93, s42, v196
    v_dot2_f32_bf16 v204, v94, s41, v196
    v_dot2_f32_bf16 v205, v94, s42, v196
    v_dot2_f32_bf16 v206, v95, s41, v196
    v_dot2_f32_bf16 v207, v95, s42, v196
    s_nop 0
    v_cvt_pk_bf16_f32 v92, v200, v201
    v_cvt_pk_bf16_f32 v93, v202, v203
    v_cvt_pk_bf16_f32 v94, v204, v205
    v_cvt_pk_bf16_f32 v95, v206, v207
    s_add_u32 m0, s22, 40960
    ds_write_b128 v219, v[92:95] offset:0
    buffer_load_dwordx4 v4, s[8:11], s21 offen lds
    v_dot2_f32_bf16 v200, v96, s41, v196
    v_dot2_f32_bf16 v201, v96, s42, v196
    v_dot2_f32_bf16 v202, v97, s41, v196
    v_dot2_f32_bf16 v203, v97, s42, v196
    v_dot2_f32_bf16 v204, v98, s41, v196
    v_dot2_f32_bf16 v205, v98, s42, v196
    v_dot2_f32_bf16 v206, v99, s41, v196
    v_dot2_f32_bf16 v207, v99, s42, v196
    s_nop 0
    v_cvt_pk_bf16_f32 v96, v200, v201
    v_cvt_pk_bf16_f32 v97, v202, v203
    v_cvt_pk_bf16_f32 v98, v204, v205
    v_cvt_pk_bf16_f32 v99, v206, v207
    s_add_u32 m0, s22, 41984
    ds_write_b128 v219, v[96:99] offset:256
    buffer_load_dwordx4 v5, s[8:11], s21 offen lds
    v_dot2_f32_bf16 v200, v100, s41, v196
    v_dot2_f32_bf16 v201, v100, s42, v196
    v_dot2_f32_bf16 v202, v101, s41, v196
    v_dot2_f32_bf16 v203, v101, s42, v196
    v_dot2_f32_bf16 v204, v102, s41, v196
    v_dot2_f32_bf16 v205, v102, s42, v196
    v_dot2_f32_bf16 v206, v103, s41, v196
    v_dot2_f32_bf16 v207, v103, s42, v196
    s_nop 0
    v_cvt_pk_bf16_f32 v100, v200, v201
    v_cvt_pk_bf16_f32 v101, v202, v203
    v_cvt_pk_bf16_f32 v102, v204, v205
    v_cvt_pk_bf16_f32 v103, v206, v207
    s_add_u32 m0, s22, 43008
    ds_write_b128 v219, v[100:103] offset:512
    buffer_load_dwordx4 v6, s[8:11], s21 offen lds
    v_dot2_f32_bf16 v200, v104, s41, v196
    v_dot2_f32_bf16 v201, v104, s42, v196
    v_dot2_f32_bf16 v202, v105, s41, v196
    v_dot2_f32_bf16 v203, v105, s42, v196
    v_dot2_f32_bf16 v204, v106, s41, v196
    v_dot2_f32_bf16 v205, v106, s42, v196
    v_dot2_f32_bf16 v206, v107, s41, v196
    v_dot2_f32_bf16 v207, v107, s42, v196
    s_nop 0
    v_cvt_pk_bf16_f32 v104, v200, v201
    v_cvt_pk_bf16_f32 v105, v202, v203
    v_cvt_pk_bf16_f32 v106, v204, v205
    v_cvt_pk_bf16_f32 v107, v206, v207
    s_add_u32 m0, s22, 44032
    ds_write_b128 v219, v[104:107] offset:768
    buffer_load_dwordx4 v7, s[8:11], s21 offen lds
    v_dot2_f32_bf16 v200, v108, s41, v196
    v_dot2_f32_bf16 v201, v108, s42, v196
    v_dot2_f32_bf16 v202, v109, s41, v196
    v_dot2_f32_bf16 v203, v109, s42, v196
    v_dot2_f32_bf16 v204, v110, s41, v196
    v_dot2_f32_bf16 v205, v110, s42, v196
    v_dot2_f32_bf16 v206, v111, s41, v196
    v_dot2_f32_bf16 v207, v111, s42, v196
    s_nop 0
    v_cvt_pk_bf16_f32 v108, v200, v201
    v_cvt_pk_bf16_f32 v109, v202, v203
    v_cvt_pk_bf16_f32 v110, v204, v205
    v_cvt_pk_bf16_f32 v111, v206, v207
    s_add_u32 m0, s22, 45056
    ds_write_b128 v219, v[108:111] offset:1024
    buffer_load_dwordx4 v8, s[8:11], s21 offen lds
    ds_write_b32 v223, v197
    s_add_u32 s21, s21, s20
    s_waitcnt vmcnt(10) lgkmcnt(0)
    s_barrier
    v_lshlrev_b32 v23, 2, v2
    v_add_u32 v23, 143360, v23
    ds_read_b32 v14, v23 offset:0
    ds_read_b32 v15, v23 offset:64
    ds_read_b32 v16, v23 offset:128
    ds_read_b32 v17, v23 offset:192
    ds_read_b128 v[72:75], v10 offset:0
    ds_read_b128 v[76:79], v10 offset:20480
    ds_read_b128 v[80:83], v10 offset:40960
    ds_read_b128 v[84:87], v10 offset:61440
    ds_read_b64_tr_b16 v[32:33], v224 offset:0
    ds_read_b64_tr_b16 v[34:35], v225 offset:0
    ds_read_b64_tr_b16 v[36:37], v226 offset:0
    ds_read_b64_tr_b16 v[38:39], v227 offset:0
    ds_read_b64_tr_b16 v[40:41], v228 offset:0
    ds_read_b64_tr_b16 v[42:43], v229 offset:0
    ds_read_b64_tr_b16 v[44:45], v230 offset:0
    ds_read_b64_tr_b16 v[46:47], v231 offset:0
    ds_read_b64_tr_b16 v[48:49], v232 offset:0
    ds_read_b64_tr_b16 v[50:51], v233 offset:0
    s_waitcnt lgkmcnt(0)
    s_barrier
    s_add_u32 m0, s22, 61440
    s_nop 0
    buffer_load_dwordx4 v4, s[8:11], s21 offen lds
    s_add_u32 m0, s22, 62464
    s_nop 0
    buffer_load_dwordx4 v5, s[8:11], s21 offen lds
    s_add_u32 m0, s22, 63488
    s_nop 0
    buffer_load_dwordx4 v6, s[8:11], s21 offen lds
    s_add_u32 m0, s22, 64512
    s_nop 0
    buffer_load_dwordx4 v7, s[8:11], s21 offen lds
    s_add_u32 m0, s22, 65536
    s_nop 0
    buffer_load_dwordx4 v8, s[8:11], s21 offen lds
    s_add_u32 s21, s21, s20
    s_mov_b32 s23, 5
.p2align 6
K1_LOOP:
    s_waitcnt vmcnt(10) lgkmcnt(0)
    s_barrier
    v_mfma_f32_16x16x32_bf16 v[112:115], v[32:35], v[72:75], v[112:115]
    ds_read_b128 v[88:91], v11 offset:0
    v_mfma_f32_16x16x32_bf16 v[116:119], v[32:35], v[76:79], v[116:119]
    ds_read_b128 v[92:95], v11 offset:20480
    s_add_u32 m0, s22, 0
    v_mfma_f32_16x16x32_bf16 v[120:123], v[32:35], v[80:83], v[120:123]
    buffer_load_dwordx4 v4, s[8:11], s21 offen lds
    ds_read_b128 v[96:99], v11 offset:40960
    v_mfma_f32_16x16x32_bf16 v[124:127], v[32:35], v[84:87], v[124:127]
    ds_read_b128 v[100:103], v11 offset:61440
    v_mfma_f32_16x16x32_bf16 v[128:131], v[36:39], v[72:75], v[128:131]
    ds_read_b64_tr_b16 v[52:53], v224 offset:20480
    v_mfma_f32_16x16x32_bf16 v[132:135], v[36:39], v[76:79], v[132:135]
    ds_read_b64_tr_b16 v[54:55], v225 offset:20480
    s_add_u32 m0, s22, 1024
    v_mfma_f32_16x16x32_bf16 v[136:139], v[36:39], v[80:83], v[136:139]
    buffer_load_dwordx4 v5, s[8:11], s21 offen lds
    ds_read_b64_tr_b16 v[56:57], v226 offset:20480
    v_mfma_f32_16x16x32_bf16 v[140:143], v[36:39], v[84:87], v[140:143]
    ds_read_b64_tr_b16 v[58:59], v227 offset:20480
    v_mfma_f32_16x16x32_bf16 v[144:147], v[40:43], v[72:75], v[144:147]
    ds_read_b64_tr_b16 v[60:61], v228 offset:20480
    v_mfma_f32_16x16x32_bf16 v[148:151], v[40:43], v[76:79], v[148:151]
    ds_read_b64_tr_b16 v[62:63], v229 offset:20480
    s_add_u32 m0, s22, 2048
    v_mfma_f32_16x16x32_bf16 v[152:155], v[40:43], v[80:83], v[152:155]
    buffer_load_dwordx4 v6, s[8:11], s21 offen lds
    ds_read_b64_tr_b16 v[64:65], v230 offset:20480
    v_mfma_f32_16x16x32_bf16 v[156:159], v[40:43], v[84:87], v[156:159]
    ds_read_b64_tr_b16 v[66:67], v231 offset:20480
    v_mfma_f32_16x16x32_bf16 v[160:163], v[44:47], v[72:75], v[160:163]
    ds_read_b64_tr_b16 v[68:69], v232 offset:20480
    v_mfma_f32_16x16x32_bf16 v[164:167], v[44:47], v[76:79], v[164:167]
    ds_read_b64_tr_b16 v[70:71], v233 offset:20480
    s_add_u32 m0, s22, 3072
    v_mfma_f32_16x16x32_bf16 v[168:171], v[44:47], v[80:83], v[168:171]
    buffer_load_dwordx4 v7, s[8:11], s21 offen lds
    v_mfma_f32_16x16x32_bf16 v[172:175], v[44:47], v[84:87], v[172:175]
    v_mfma_f32_16x16x32_bf16 v[176:179], v[48:51], v[72:75], v[176:179]
    v_mfma_f32_16x16x32_bf16 v[180:183], v[48:51], v[76:79], v[180:183]
    s_add_u32 m0, s22, 4096
    v_mfma_f32_16x16x32_bf16 v[184:187], v[48:51], v[80:83], v[184:187]
    buffer_load_dwordx4 v8, s[8:11], s21 offen lds
    v_mfma_f32_16x16x32_bf16 v[188:191], v[48:51], v[84:87], v[188:191]
    s_add_u32 s21, s21, s20
    s_waitcnt vmcnt(10) lgkmcnt(0)
    s_barrier
    v_mfma_f32_16x16x32_bf16 v[112:115], v[52:55], v[88:91], v[112:115]
    ds_read_b128 v[72:75], v12 offset:0
    v_mfma_f32_16x16x32_bf16 v[116:119], v[52:55], v[92:95], v[116:119]
    ds_read_b128 v[76:79], v12 offset:20480
    s_add_u32 m0, s22, 20480
    v_mfma_f32_16x16x32_bf16 v[120:123], v[52:55], v[96:99], v[120:123]
    buffer_load_dwordx4 v4, s[8:11], s21 offen lds
    ds_read_b128 v[80:83], v12 offset:40960
    v_mfma_f32_16x16x32_bf16 v[124:127], v[52:55], v[100:103], v[124:127]
    ds_read_b128 v[84:87], v12 offset:61440
    v_mfma_f32_16x16x32_bf16 v[128:131], v[56:59], v[88:91], v[128:131]
    ds_read_b64_tr_b16 v[32:33], v224 offset:40960
    v_mfma_f32_16x16x32_bf16 v[132:135], v[56:59], v[92:95], v[132:135]
    ds_read_b64_tr_b16 v[34:35], v225 offset:40960
    s_add_u32 m0, s22, 21504
    v_mfma_f32_16x16x32_bf16 v[136:139], v[56:59], v[96:99], v[136:139]
    buffer_load_dwordx4 v5, s[8:11], s21 offen lds
    ds_read_b64_tr_b16 v[36:37], v226 offset:40960
    v_mfma_f32_16x16x32_bf16 v[140:143], v[56:59], v[100:103], v[140:143]
    ds_read_b64_tr_b16 v[38:39], v227 offset:40960
    v_mfma_f32_16x16x32_bf16 v[144:147], v[60:63], v[88:91], v[144:147]
    ds_read_b64_tr_b16 v[40:41], v228 offset:40960
    v_mfma_f32_16x16x32_bf16 v[148:151], v[60:63], v[92:95], v[148:151]
    ds_read_b64_tr_b16 v[42:43], v229 offset:40960
    s_add_u32 m0, s22, 22528
    v_mfma_f32_16x16x32_bf16 v[152:155], v[60:63], v[96:99], v[152:155]
    buffer_load_dwordx4 v6, s[8:11], s21 offen lds
    ds_read_b64_tr_b16 v[44:45], v230 offset:40960
    v_mfma_f32_16x16x32_bf16 v[156:159], v[60:63], v[100:103], v[156:159]
    ds_read_b64_tr_b16 v[46:47], v231 offset:40960
    v_mfma_f32_16x16x32_bf16 v[160:163], v[64:67], v[88:91], v[160:163]
    ds_read_b64_tr_b16 v[48:49], v232 offset:40960
    v_mfma_f32_16x16x32_bf16 v[164:167], v[64:67], v[92:95], v[164:167]
    ds_read_b64_tr_b16 v[50:51], v233 offset:40960
    s_add_u32 m0, s22, 23552
    v_mfma_f32_16x16x32_bf16 v[168:171], v[64:67], v[96:99], v[168:171]
    buffer_load_dwordx4 v7, s[8:11], s21 offen lds
    v_mfma_f32_16x16x32_bf16 v[172:175], v[64:67], v[100:103], v[172:175]
    v_mfma_f32_16x16x32_bf16 v[176:179], v[68:71], v[88:91], v[176:179]
    v_mfma_f32_16x16x32_bf16 v[180:183], v[68:71], v[92:95], v[180:183]
    s_add_u32 m0, s22, 24576
    v_mfma_f32_16x16x32_bf16 v[184:187], v[68:71], v[96:99], v[184:187]
    buffer_load_dwordx4 v8, s[8:11], s21 offen lds
    v_mfma_f32_16x16x32_bf16 v[188:191], v[68:71], v[100:103], v[188:191]
    s_add_u32 s21, s21, s20
    s_waitcnt vmcnt(10) lgkmcnt(0)
    s_barrier
    v_mfma_f32_16x16x32_bf16 v[112:115], v[32:35], v[72:75], v[112:115]
    ds_read_b128 v[88:91], v13 offset:0
    v_mfma_f32_16x16x32_bf16 v[116:119], v[32:35], v[76:79], v[116:119]
    ds_read_b128 v[92:95], v13 offset:20480
    s_add_u32 m0, s22, 40960
    v_mfma_f32_16x16x32_bf16 v[120:123], v[32:35], v[80:83], v[120:123]
    buffer_load_dwordx4 v4, s[8:11], s21 offen lds
    ds_read_b128 v[96:99], v13 offset:40960
    v_mfma_f32_16x16x32_bf16 v[124:127], v[32:35], v[84:87], v[124:127]
    ds_read_b128 v[100:103], v13 offset:61440
    v_mfma_f32_16x16x32_bf16 v[128:131], v[36:39], v[72:75], v[128:131]
    ds_read_b64_tr_b16 v[52:53], v224 offset:61440
    v_mfma_f32_16x16x32_bf16 v[132:135], v[36:39], v[76:79], v[132:135]
    ds_read_b64_tr_b16 v[54:55], v225 offset:61440
    s_add_u32 m0, s22, 41984
    v_mfma_f32_16x16x32_bf16 v[136:139], v[36:39], v[80:83], v[136:139]
    buffer_load_dwordx4 v5, s[8:11], s21 offen lds
    ds_read_b64_tr_b16 v[56:57], v226 offset:61440
    v_mfma_f32_16x16x32_bf16 v[140:143], v[36:39], v[84:87], v[140:143]
    ds_read_b64_tr_b16 v[58:59], v227 offset:61440
    v_mfma_f32_16x16x32_bf16 v[144:147], v[40:43], v[72:75], v[144:147]
    ds_read_b64_tr_b16 v[60:61], v228 offset:61440
    v_mfma_f32_16x16x32_bf16 v[148:151], v[40:43], v[76:79], v[148:151]
    ds_read_b64_tr_b16 v[62:63], v229 offset:61440
    s_add_u32 m0, s22, 43008
    v_mfma_f32_16x16x32_bf16 v[152:155], v[40:43], v[80:83], v[152:155]
    buffer_load_dwordx4 v6, s[8:11], s21 offen lds
    ds_read_b64_tr_b16 v[64:65], v230 offset:61440
    v_mfma_f32_16x16x32_bf16 v[156:159], v[40:43], v[84:87], v[156:159]
    ds_read_b64_tr_b16 v[66:67], v231 offset:61440
    v_mfma_f32_16x16x32_bf16 v[160:163], v[44:47], v[72:75], v[160:163]
    ds_read_b64_tr_b16 v[68:69], v232 offset:61440
    v_mfma_f32_16x16x32_bf16 v[164:167], v[44:47], v[76:79], v[164:167]
    ds_read_b64_tr_b16 v[70:71], v233 offset:61440
    s_add_u32 m0, s22, 44032
    v_mfma_f32_16x16x32_bf16 v[168:171], v[44:47], v[80:83], v[168:171]
    buffer_load_dwordx4 v7, s[8:11], s21 offen lds
    v_mfma_f32_16x16x32_bf16 v[172:175], v[44:47], v[84:87], v[172:175]
    v_mfma_f32_16x16x32_bf16 v[176:179], v[48:51], v[72:75], v[176:179]
    v_mfma_f32_16x16x32_bf16 v[180:183], v[48:51], v[76:79], v[180:183]
    s_add_u32 m0, s22, 45056
    v_mfma_f32_16x16x32_bf16 v[184:187], v[48:51], v[80:83], v[184:187]
    buffer_load_dwordx4 v8, s[8:11], s21 offen lds
    v_mfma_f32_16x16x32_bf16 v[188:191], v[48:51], v[84:87], v[188:191]
    s_add_u32 s21, s21, s20
    s_waitcnt vmcnt(10) lgkmcnt(0)
    s_barrier
    v_mfma_f32_16x16x32_bf16 v[112:115], v[52:55], v[88:91], v[112:115]
    ds_read_b128 v[72:75], v10 offset:256
    v_mfma_f32_16x16x32_bf16 v[116:119], v[52:55], v[92:95], v[116:119]
    ds_read_b128 v[76:79], v10 offset:20736
    s_add_u32 m0, s22, 61440
    v_mfma_f32_16x16x32_bf16 v[120:123], v[52:55], v[96:99], v[120:123]
    buffer_load_dwordx4 v4, s[8:11], s21 offen lds
    ds_read_b128 v[80:83], v10 offset:41216
    v_mfma_f32_16x16x32_bf16 v[124:127], v[52:55], v[100:103], v[124:127]
    ds_read_b128 v[84:87], v10 offset:61696
    v_mfma_f32_16x16x32_bf16 v[128:131], v[56:59], v[88:91], v[128:131]
    ds_read_b64_tr_b16 v[32:33], v224 offset:0
    v_mfma_f32_16x16x32_bf16 v[132:135], v[56:59], v[92:95], v[132:135]
    ds_read_b64_tr_b16 v[34:35], v225 offset:0
    s_add_u32 m0, s22, 62464
    v_mfma_f32_16x16x32_bf16 v[136:139], v[56:59], v[96:99], v[136:139]
    buffer_load_dwordx4 v5, s[8:11], s21 offen lds
    ds_read_b64_tr_b16 v[36:37], v226 offset:0
    v_mfma_f32_16x16x32_bf16 v[140:143], v[56:59], v[100:103], v[140:143]
    ds_read_b64_tr_b16 v[38:39], v227 offset:0
    v_mfma_f32_16x16x32_bf16 v[144:147], v[60:63], v[88:91], v[144:147]
    ds_read_b64_tr_b16 v[40:41], v228 offset:0
    v_mfma_f32_16x16x32_bf16 v[148:151], v[60:63], v[92:95], v[148:151]
    ds_read_b64_tr_b16 v[42:43], v229 offset:0
    s_add_u32 m0, s22, 63488
    v_mfma_f32_16x16x32_bf16 v[152:155], v[60:63], v[96:99], v[152:155]
    buffer_load_dwordx4 v6, s[8:11], s21 offen lds
    ds_read_b64_tr_b16 v[44:45], v230 offset:0
    v_mfma_f32_16x16x32_bf16 v[156:159], v[60:63], v[100:103], v[156:159]
    ds_read_b64_tr_b16 v[46:47], v231 offset:0
    v_mfma_f32_16x16x32_bf16 v[160:163], v[64:67], v[88:91], v[160:163]
    ds_read_b64_tr_b16 v[48:49], v232 offset:0
    v_mfma_f32_16x16x32_bf16 v[164:167], v[64:67], v[92:95], v[164:167]
    ds_read_b64_tr_b16 v[50:51], v233 offset:0
    s_add_u32 m0, s22, 64512
    v_mfma_f32_16x16x32_bf16 v[168:171], v[64:67], v[96:99], v[168:171]
    buffer_load_dwordx4 v7, s[8:11], s21 offen lds
    v_mfma_f32_16x16x32_bf16 v[172:175], v[64:67], v[100:103], v[172:175]
    v_mfma_f32_16x16x32_bf16 v[176:179], v[68:71], v[88:91], v[176:179]
    v_mfma_f32_16x16x32_bf16 v[180:183], v[68:71], v[92:95], v[180:183]
    s_add_u32 m0, s22, 65536
    v_mfma_f32_16x16x32_bf16 v[184:187], v[68:71], v[96:99], v[184:187]
    buffer_load_dwordx4 v8, s[8:11], s21 offen lds
    v_mfma_f32_16x16x32_bf16 v[188:191], v[68:71], v[100:103], v[188:191]
    s_add_u32 s21, s21, s20
    v_add_u32 v10, 256, v10
    v_add_u32 v11, 256, v11
    v_add_u32 v12, 256, v12
    v_add_u32 v13, 256, v13
    s_sub_u32 s23, s23, 1
    s_cmp_lg_u32 s23, 0
    s_cbranch_scc1 K1_LOOP
    s_waitcnt vmcnt(0) lgkmcnt(0)
    s_barrier
    s_cmp_lt_u32 s19, 8
    s_cbranch_scc1 K1_EPI_Q
    s_cmp_lt_u32 s19, 30
    s_cbranch_scc1 K1_EPI_H
    s_cmp_eq_u32 s19, 30
    s_cbranch_scc1 K1_EPI_K
    s_branch K1_EPI_V
K1_EPI_H:
    s_sub_u32 s24, s19, 8
    s_mul_i32 s24, s24, 5
    s_lshl_b32 s25, s16, 2
    s_mul_i32 s25, s25, 75776
    s_add_u32 s25, s25, 2883584
    s_lshr_b32 s26, s24, 1
    s_lshl_b32 s26, s26, 10
    s_add_u32 s25, s25, s26
    v_lshlrev_b32 v18, 4, v1
    s_lshr_b32 s29, s18, 1
    s_lshl_b32 s29, s29, 11
    s_add_u32 s29, s29, 40960
    v_lshl_add_u32 v19, v1, 3, s29
    s_and_b32 s27, s24, 1
    s_cmp_eq_u32 s27, 1
    s_cbranch_scc1 K1_EPI_H_ODD
    v_mul_f32 v176, v176, v14
    v_mul_f32 v177, v177, v14
    v_mul_f32 v178, v178, v14
    v_mul_f32 v179, v179, v14
    v_cvt_pk_bf16_f32 v32, v176, v177
    v_cvt_pk_bf16_f32 v33, v178, v179
    v_pk_max_i16 v32, v32, 0
    v_pk_max_i16 v33, v33, 0
    ds_write_b64 v19, v[32:33] offset:0
    v_mul_f32 v180, v180, v15
    v_mul_f32 v181, v181, v15
    v_mul_f32 v182, v182, v15
    v_mul_f32 v183, v183, v15
    v_cvt_pk_bf16_f32 v34, v180, v181
    v_cvt_pk_bf16_f32 v35, v182, v183
    v_pk_max_i16 v34, v34, 0
    v_pk_max_i16 v35, v35, 0
    ds_write_b64 v19, v[34:35] offset:512
    v_mul_f32 v184, v184, v16
    v_mul_f32 v185, v185, v16
    v_mul_f32 v186, v186, v16
    v_mul_f32 v187, v187, v16
    v_cvt_pk_bf16_f32 v36, v184, v185
    v_cvt_pk_bf16_f32 v37, v186, v187
    v_pk_max_i16 v36, v36, 0
    v_pk_max_i16 v37, v37, 0
    ds_write_b64 v19, v[36:37] offset:1024
    v_mul_f32 v188, v188, v17
    v_mul_f32 v189, v189, v17
    v_mul_f32 v190, v190, v17
    v_mul_f32 v191, v191, v17
    v_cvt_pk_bf16_f32 v38, v188, v189
    v_cvt_pk_bf16_f32 v39, v190, v191
    v_pk_max_i16 v38, v38, 0
    v_pk_max_i16 v39, v39, 0
    ds_write_b64 v19, v[38:39] offset:1536
    s_add_u32 s28, s25, 0
    v_mul_f32 v112, v112, v14
    v_mul_f32 v113, v113, v14
    v_mul_f32 v114, v114, v14
    v_mul_f32 v115, v115, v14
    v_cvt_pk_bf16_f32 v192, v112, v113
    v_cvt_pk_bf16_f32 v193, v114, v115
    v_pk_max_i16 v192, v192, 0
    v_pk_max_i16 v193, v193, 0
    v_mul_f32 v128, v128, v14
    v_mul_f32 v129, v129, v14
    v_mul_f32 v130, v130, v14
    v_mul_f32 v131, v131, v14
    v_cvt_pk_bf16_f32 v194, v128, v129
    v_cvt_pk_bf16_f32 v195, v130, v131
    v_pk_max_i16 v194, v194, 0
    v_pk_max_i16 v195, v195, 0
    buffer_store_dwordx4 v[192:195], v18, s[12:15], s28 offen sc1
    s_add_u32 s28, s25, 75776
    v_mul_f32 v116, v116, v15
    v_mul_f32 v117, v117, v15
    v_mul_f32 v118, v118, v15
    v_mul_f32 v119, v119, v15
    v_cvt_pk_bf16_f32 v196, v116, v117
    v_cvt_pk_bf16_f32 v197, v118, v119
    v_pk_max_i16 v196, v196, 0
    v_pk_max_i16 v197, v197, 0
    v_mul_f32 v132, v132, v15
    v_mul_f32 v133, v133, v15
    v_mul_f32 v134, v134, v15
    v_mul_f32 v135, v135, v15
    v_cvt_pk_bf16_f32 v198, v132, v133
    v_cvt_pk_bf16_f32 v199, v134, v135
    v_pk_max_i16 v198, v198, 0
    v_pk_max_i16 v199, v199, 0
    buffer_store_dwordx4 v[196:199], v18, s[12:15], s28 offen sc1
    s_add_u32 s28, s25, 151552
    v_mul_f32 v120, v120, v16
    v_mul_f32 v121, v121, v16
    v_mul_f32 v122, v122, v16
    v_mul_f32 v123, v123, v16
    v_cvt_pk_bf16_f32 v200, v120, v121
    v_cvt_pk_bf16_f32 v201, v122, v123
    v_pk_max_i16 v200, v200, 0
    v_pk_max_i16 v201, v201, 0
    v_mul_f32 v136, v136, v16
    v_mul_f32 v137, v137, v16
    v_mul_f32 v138, v138, v16
    v_mul_f32 v139, v139, v16
    v_cvt_pk_bf16_f32 v202, v136, v137
    v_cvt_pk_bf16_f32 v203, v138, v139
    v_pk_max_i16 v202, v202, 0
    v_pk_max_i16 v203, v203, 0
    buffer_store_dwordx4 v[200:203], v18, s[12:15], s28 offen sc1
    s_add_u32 s28, s25, 227328
    v_mul_f32 v124, v124, v17
    v_mul_f32 v125, v125, v17
    v_mul_f32 v126, v126, v17
    v_mul_f32 v127, v127, v17
    v_cvt_pk_bf16_f32 v204, v124, v125
    v_cvt_pk_bf16_f32 v205, v126, v127
    v_pk_max_i16 v204, v204, 0
    v_pk_max_i16 v205, v205, 0
    v_mul_f32 v140, v140, v17
    v_mul_f32 v141, v141, v17
    v_mul_f32 v142, v142, v17
    v_mul_f32 v143, v143, v17
    v_cvt_pk_bf16_f32 v206, v140, v141
    v_cvt_pk_bf16_f32 v207, v142, v143
    v_pk_max_i16 v206, v206, 0
    v_pk_max_i16 v207, v207, 0
    buffer_store_dwordx4 v[204:207], v18, s[12:15], s28 offen sc1
    s_waitcnt lgkmcnt(0)
    s_barrier
    s_add_u32 s28, s25, 1024
    v_mul_f32 v144, v144, v14
    v_mul_f32 v145, v145, v14
    v_mul_f32 v146, v146, v14
    v_mul_f32 v147, v147, v14
    v_cvt_pk_bf16_f32 v192, v144, v145
    v_cvt_pk_bf16_f32 v193, v146, v147
    v_pk_max_i16 v192, v192, 0
    v_pk_max_i16 v193, v193, 0
    v_mul_f32 v160, v160, v14
    v_mul_f32 v161, v161, v14
    v_mul_f32 v162, v162, v14
    v_mul_f32 v163, v163, v14
    v_cvt_pk_bf16_f32 v194, v160, v161
    v_cvt_pk_bf16_f32 v195, v162, v163
    v_pk_max_i16 v194, v194, 0
    v_pk_max_i16 v195, v195, 0
    buffer_store_dwordx4 v[192:195], v18, s[12:15], s28 offen sc1
    s_add_u32 s28, s25, 76800
    v_mul_f32 v148, v148, v15
    v_mul_f32 v149, v149, v15
    v_mul_f32 v150, v150, v15
    v_mul_f32 v151, v151, v15
    v_cvt_pk_bf16_f32 v196, v148, v149
    v_cvt_pk_bf16_f32 v197, v150, v151
    v_pk_max_i16 v196, v196, 0
    v_pk_max_i16 v197, v197, 0
    v_mul_f32 v164, v164, v15
    v_mul_f32 v165, v165, v15
    v_mul_f32 v166, v166, v15
    v_mul_f32 v167, v167, v15
    v_cvt_pk_bf16_f32 v198, v164, v165
    v_cvt_pk_bf16_f32 v199, v166, v167
    v_pk_max_i16 v198, v198, 0
    v_pk_max_i16 v199, v199, 0
    buffer_store_dwordx4 v[196:199], v18, s[12:15], s28 offen sc1
    s_add_u32 s28, s25, 152576
    v_mul_f32 v152, v152, v16
    v_mul_f32 v153, v153, v16
    v_mul_f32 v154, v154, v16
    v_mul_f32 v155, v155, v16
    v_cvt_pk_bf16_f32 v200, v152, v153
    v_cvt_pk_bf16_f32 v201, v154, v155
    v_pk_max_i16 v200, v200, 0
    v_pk_max_i16 v201, v201, 0
    v_mul_f32 v168, v168, v16
    v_mul_f32 v169, v169, v16
    v_mul_f32 v170, v170, v16
    v_mul_f32 v171, v171, v16
    v_cvt_pk_bf16_f32 v202, v168, v169
    v_cvt_pk_bf16_f32 v203, v170, v171
    v_pk_max_i16 v202, v202, 0
    v_pk_max_i16 v203, v203, 0
    buffer_store_dwordx4 v[200:203], v18, s[12:15], s28 offen sc1
    s_add_u32 s28, s25, 228352
    v_mul_f32 v156, v156, v17
    v_mul_f32 v157, v157, v17
    v_mul_f32 v158, v158, v17
    v_mul_f32 v159, v159, v17
    v_cvt_pk_bf16_f32 v204, v156, v157
    v_cvt_pk_bf16_f32 v205, v158, v159
    v_pk_max_i16 v204, v204, 0
    v_pk_max_i16 v205, v205, 0
    v_mul_f32 v172, v172, v17
    v_mul_f32 v173, v173, v17
    v_mul_f32 v174, v174, v17
    v_mul_f32 v175, v175, v17
    v_cvt_pk_bf16_f32 v206, v172, v173
    v_cvt_pk_bf16_f32 v207, v174, v175
    v_pk_max_i16 v206, v206, 0
    v_pk_max_i16 v207, v207, 0
    buffer_store_dwordx4 v[204:207], v18, s[12:15], s28 offen sc1
    s_waitcnt vmcnt(8)
    s_branch K1_JOB
K1_EPI_H_ODD:
    v_mul_f32 v112, v112, v14
    v_mul_f32 v113, v113, v14
    v_mul_f32 v114, v114, v14
    v_mul_f32 v115, v115, v14
    v_cvt_pk_bf16_f32 v42, v112, v113
    v_cvt_pk_bf16_f32 v43, v114, v115
    v_pk_max_i16 v42, v42, 0
    v_pk_max_i16 v43, v43, 0
    v_mul_f32 v116, v116, v15
    v_mul_f32 v117, v117, v15
    v_mul_f32 v118, v118, v15
    v_mul_f32 v119, v119, v15
    v_cvt_pk_bf16_f32 v46, v116, v117
    v_cvt_pk_bf16_f32 v47, v118, v119
    v_pk_max_i16 v46, v46, 0
    v_pk_max_i16 v47, v47, 0
    v_mul_f32 v120, v120, v16
    v_mul_f32 v121, v121, v16
    v_mul_f32 v122, v122, v16
    v_mul_f32 v123, v123, v16
    v_cvt_pk_bf16_f32 v50, v120, v121
    v_cvt_pk_bf16_f32 v51, v122, v123
    v_pk_max_i16 v50, v50, 0
    v_pk_max_i16 v51, v51, 0
    v_mul_f32 v124, v124, v17
    v_mul_f32 v125, v125, v17
    v_mul_f32 v126, v126, v17
    v_mul_f32 v127, v127, v17
    v_cvt_pk_bf16_f32 v54, v124, v125
    v_cvt_pk_bf16_f32 v55, v126, v127
    v_pk_max_i16 v54, v54, 0
    v_pk_max_i16 v55, v55, 0
    s_add_u32 s28, s25, 1024
    v_mul_f32 v128, v128, v14
    v_mul_f32 v129, v129, v14
    v_mul_f32 v130, v130, v14
    v_mul_f32 v131, v131, v14
    v_cvt_pk_bf16_f32 v192, v128, v129
    v_cvt_pk_bf16_f32 v193, v130, v131
    v_pk_max_i16 v192, v192, 0
    v_pk_max_i16 v193, v193, 0
    v_mul_f32 v144, v144, v14
    v_mul_f32 v145, v145, v14
    v_mul_f32 v146, v146, v14
    v_mul_f32 v147, v147, v14
    v_cvt_pk_bf16_f32 v194, v144, v145
    v_cvt_pk_bf16_f32 v195, v146, v147
    v_pk_max_i16 v194, v194, 0
    v_pk_max_i16 v195, v195, 0
    buffer_store_dwordx4 v[192:195], v18, s[12:15], s28 offen sc1
    s_add_u32 s28, s25, 76800
    v_mul_f32 v132, v132, v15
    v_mul_f32 v133, v133, v15
    v_mul_f32 v134, v134, v15
    v_mul_f32 v135, v135, v15
    v_cvt_pk_bf16_f32 v196, v132, v133
    v_cvt_pk_bf16_f32 v197, v134, v135
    v_pk_max_i16 v196, v196, 0
    v_pk_max_i16 v197, v197, 0
    v_mul_f32 v148, v148, v15
    v_mul_f32 v149, v149, v15
    v_mul_f32 v150, v150, v15
    v_mul_f32 v151, v151, v15
    v_cvt_pk_bf16_f32 v198, v148, v149
    v_cvt_pk_bf16_f32 v199, v150, v151
    v_pk_max_i16 v198, v198, 0
    v_pk_max_i16 v199, v199, 0
    buffer_store_dwordx4 v[196:199], v18, s[12:15], s28 offen sc1
    s_add_u32 s28, s25, 152576
    v_mul_f32 v136, v136, v16
    v_mul_f32 v137, v137, v16
    v_mul_f32 v138, v138, v16
    v_mul_f32 v139, v139, v16
    v_cvt_pk_bf16_f32 v200, v136, v137
    v_cvt_pk_bf16_f32 v201, v138, v139
    v_pk_max_i16 v200, v200, 0
    v_pk_max_i16 v201, v201, 0
    v_mul_f32 v152, v152, v16
    v_mul_f32 v153, v153, v16
    v_mul_f32 v154, v154, v16
    v_mul_f32 v155, v155, v16
    v_cvt_pk_bf16_f32 v202, v152, v153
    v_cvt_pk_bf16_f32 v203, v154, v155
    v_pk_max_i16 v202, v202, 0
    v_pk_max_i16 v203, v203, 0
    buffer_store_dwordx4 v[200:203], v18, s[12:15], s28 offen sc1
    s_add_u32 s28, s25, 228352
    v_mul_f32 v140, v140, v17
    v_mul_f32 v141, v141, v17
    v_mul_f32 v142, v142, v17
    v_mul_f32 v143, v143, v17
    v_cvt_pk_bf16_f32 v204, v140, v141
    v_cvt_pk_bf16_f32 v205, v142, v143
    v_pk_max_i16 v204, v204, 0
    v_pk_max_i16 v205, v205, 0
    v_mul_f32 v156, v156, v17
    v_mul_f32 v157, v157, v17
    v_mul_f32 v158, v158, v17
    v_mul_f32 v159, v159, v17
    v_cvt_pk_bf16_f32 v206, v156, v157
    v_cvt_pk_bf16_f32 v207, v158, v159
    v_pk_max_i16 v206, v206, 0
    v_pk_max_i16 v207, v207, 0
    buffer_store_dwordx4 v[204:207], v18, s[12:15], s28 offen sc1
    s_barrier
    ds_read_b64 v[40:41], v19 offset:0
    ds_read_b64 v[44:45], v19 offset:512
    ds_read_b64 v[48:49], v19 offset:1024
    ds_read_b64 v[52:53], v19 offset:1536
    s_cmp_eq_u32 s19, 29
    s_cbranch_scc1 K1_EPI_H_LAST
    s_add_u32 s28, s25, 2048
    v_mul_f32 v160, v160, v14
    v_mul_f32 v161, v161, v14
    v_mul_f32 v162, v162, v14
    v_mul_f32 v163, v163, v14
    v_cvt_pk_bf16_f32 v192, v160, v161
    v_cvt_pk_bf16_f32 v193, v162, v163
    v_pk_max_i16 v192, v192, 0
    v_pk_max_i16 v193, v193, 0
    v_mul_f32 v176, v176, v14
    v_mul_f32 v177, v177, v14
    v_mul_f32 v178, v178, v14
    v_mul_f32 v179, v179, v14
    v_cvt_pk_bf16_f32 v194, v176, v177
    v_cvt_pk_bf16_f32 v195, v178, v179
    v_pk_max_i16 v194, v194, 0
    v_pk_max_i16 v195, v195, 0
    buffer_store_dwordx4 v[192:195], v18, s[12:15], s28 offen sc1
    s_add_u32 s28, s25, 77824
    v_mul_f32 v164, v164, v15
    v_mul_f32 v165, v165, v15
    v_mul_f32 v166, v166, v15
    v_mul_f32 v167, v167, v15
    v_cvt_pk_bf16_f32 v196, v164, v165
    v_cvt_pk_bf16_f32 v197, v166, v167
    v_pk_max_i16 v196, v196, 0
    v_pk_max_i16 v197, v197, 0
    v_mul_f32 v180, v180, v15
    v_mul_f32 v181, v181, v15
    v_mul_f32 v182, v182, v15
    v_mul_f32 v183, v183, v15
    v_cvt_pk_bf16_f32 v198, v180, v181
    v_cvt_pk_bf16_f32 v199, v182, v183
    v_pk_max_i16 v198, v198, 0
    v_pk_max_i16 v199, v199, 0
    buffer_store_dwordx4 v[196:199], v18, s[12:15], s28 offen sc1
    s_add_u32 s28, s25, 153600
    v_mul_f32 v168, v168, v16
    v_mul_f32 v169, v169, v16
    v_mul_f32 v170, v170, v16
    v_mul_f32 v171, v171, v16
    v_cvt_pk_bf16_f32 v200, v168, v169
    v_cvt_pk_bf16_f32 v201, v170, v171
    v_pk_max_i16 v200, v200, 0
    v_pk_max_i16 v201, v201, 0
    v_mul_f32 v184, v184, v16
    v_mul_f32 v185, v185, v16
    v_mul_f32 v186, v186, v16
    v_mul_f32 v187, v187, v16
    v_cvt_pk_bf16_f32 v202, v184, v185
    v_cvt_pk_bf16_f32 v203, v186, v187
    v_pk_max_i16 v202, v202, 0
    v_pk_max_i16 v203, v203, 0
    buffer_store_dwordx4 v[200:203], v18, s[12:15], s28 offen sc1
    s_add_u32 s28, s25, 229376
    v_mul_f32 v172, v172, v17
    v_mul_f32 v173, v173, v17
    v_mul_f32 v174, v174, v17
    v_mul_f32 v175, v175, v17
    v_cvt_pk_bf16_f32 v204, v172, v173
    v_cvt_pk_bf16_f32 v205, v174, v175
    v_pk_max_i16 v204, v204, 0
    v_pk_max_i16 v205, v205, 0
    v_mul_f32 v188, v188, v17
    v_mul_f32 v189, v189, v17
    v_mul_f32 v190, v190, v17
    v_mul_f32 v191, v191, v17
    v_cvt_pk_bf16_f32 v206, v188, v189
    v_cvt_pk_bf16_f32 v207, v190, v191
    v_pk_max_i16 v206, v206, 0
    v_pk_max_i16 v207, v207, 0
    buffer_store_dwordx4 v[204:207], v18, s[12:15], s28 offen sc1
    s_waitcnt lgkmcnt(0)
    s_add_u32 s28, s25, 0
    buffer_store_dwordx4 v[40:43], v18, s[12:15], s28 offen sc1
    s_add_u32 s28, s25, 75776
    buffer_store_dwordx4 v[44:47], v18, s[12:15], s28 offen sc1
    s_add_u32 s28, s25, 151552
    buffer_store_dwordx4 v[48:51], v18, s[12:15], s28 offen sc1
    s_add_u32 s28, s25, 227328
    buffer_store_dwordx4 v[52:55], v18, s[12:15], s28 offen sc1
    s_waitcnt vmcnt(12)
    s_branch K1_JOB
K1_EPI_H_LAST:
    s_waitcnt lgkmcnt(0)
    s_add_u32 s28, s25, 0
    buffer_store_dwordx4 v[40:43], v18, s[12:15], s28 offen sc1
    s_add_u32 s28, s25, 75776
    buffer_store_dwordx4 v[44:47], v18, s[12:15], s28 offen sc1
    s_add_u32 s28, s25, 151552
    buffer_store_dwordx4 v[48:51], v18, s[12:15], s28 offen sc1
    s_add_u32 s28, s25, 227328
    buffer_store_dwordx4 v[52:55], v18, s[12:15], s28 offen sc1
    s_waitcnt vmcnt(8)
    s_branch K1_JOB
K1_EPI_Q:
    s_barrier
    s_lshl_b32 s24, s16, 6
    s_lshl_b32 s25, s19, 2
    s_add_u32 s24, s24, s25
    s_mul_i32 s24, s24, 1280
    s_add_u32 s25, s24, 40960
    s_mul_i32 s31, s18, 10240
    v_mul_f32 v14, 0x3ea52b5c, v14
    v_mul_f32 v15, 0x3ea52b5c, v15
    v_mul_f32 v16, 0x3ea52b5c, v16
    v_mul_f32 v17, 0x3ea52b5c, v17
    v_mov_b32 v24, 128
    v_and_b32 v20, 1, v3
    v_lshlrev_b32 v20, 4, v20
    v_cmp_lt_u32 vcc, 1, v3
    v_lshlrev_b32 v22, 4, v2
    v_lshlrev_b32 v23, 3, v2
    v_mov_b32 v192, 0x80000
    v_mov_b32 v193, 0x2080200
    v_cndmask_b32 v192, v192, v193, vcc
    v_lshrrev_b32 v192, v20, v192
    v_and_b32 v192, 0xffff, v192
    v_mov_b32 v194, 0x5008400
    v_mov_b32 v195, 0x7000508
    v_cndmask_b32 v194, v194, v195, vcc
    v_lshrrev_b32 v194, v20, v194
    v_and_b32 v194, 0xffff, v194
    v_mov_b32 v196, 0x89000708
    v_mov_b32 v197, 0xa080a00
    v_cndmask_b32 v196, v196, v197, vcc
    v_lshrrev_b32 v196, v20, v196
    v_and_b32 v196, 0xffff, v196
    v_mov_b32 v198, 0xc080c00
    v_mov_b32 v199, 0xf008e00
    v_cndmask_b32 v198, v198, v199, vcc
    v_lshrrev_b32 v198, v20, v198
    v_and_b32 v198, 0xffff, v198
    v_mov_b32 v200, 0x11000f08
    v_mov_b32 v201, 0x93001108
    v_cndmask_b32 v200, v200, v201, vcc
    v_lshrrev_b32 v200, v20, v200
    v_and_b32 v200, 0xffff, v200
    v_cmp_lt_u32 vcc, 0x7fff, v192
    v_and_b32 v192, 0x7fff, v192
    v_add_u32 v192, s31, v192
    v_cndmask_b32 v21, v22, v23, vcc
    v_cndmask_b32 v193, 1, 0, vcc
    v_add_u32 v192, v192, v21
    v_lshlrev_b32 v193, v193, v24
    v_add_u32 v193, v192, v193
    v_cmp_lt_u32 vcc, 0x7fff, v194
    v_and_b32 v194, 0x7fff, v194
    v_add_u32 v194, s31, v194
    v_cndmask_b32 v21, v22, v23, vcc
    v_cndmask_b32 v195, 1, 0, vcc
    v_add_u32 v194, v194, v21
    v_lshlrev_b32 v195, v195, v24
    v_add_u32 v195, v194, v195
    v_cmp_lt_u32 vcc, 0x7fff, v196
    v_and_b32 v196, 0x7fff, v196
    v_add_u32 v196, s31, v196
    v_cndmask_b32 v21, v22, v23, vcc
    v_cndmask_b32 v197, 1, 0, vcc
    v_add_u32 v196, v196, v21
    v_lshlrev_b32 v197, v197, v24
    v_add_u32 v197, v196, v197
    v_cmp_lt_u32 vcc, 0x7fff, v198
    v_and_b32 v198, 0x7fff, v198
    v_add_u32 v198, s31, v198
    v_cndmask_b32 v21, v22, v23, vcc
    v_cndmask_b32 v199, 1, 0, vcc
    v_add_u32 v198, v198, v21
    v_lshlrev_b32 v199, v199, v24
    v_add_u32 v199, v198, v199
    v_cmp_lt_u32 vcc, 0x7fff, v200
    v_and_b32 v200, 0x7fff, v200
    v_add_u32 v200, s31, v200
    v_cndmask_b32 v21, v22, v23, vcc
    v_cndmask_b32 v201, 1, 0, vcc
    v_add_u32 v200, v200, v21
    v_lshlrev_b32 v201, v201, v24
    v_add_u32 v201, v200, v201
    v_lshlrev_b32 v18, 4, v1
    v_add_u32 v19, s31, v18
    s_add_u32 s26, s24, 4096
    s_add_u32 s27, s25, 4096
    v_mul_f32 v112, v112, v14
    v_mul_f32 v113, v113, v14
    v_mul_f32 v114, v114, v14
    v_mul_f32 v115, v115, v14
    v_cvt_pk_bf16_f32 v112, v112, v113
    v_cvt_pk_bf16_f32 v113, v114, v115
    ds_write_b64 v192, v[112:113] offset:0
    v_mul_f32 v116, v116, v15
    v_mul_f32 v117, v117, v15
    v_mul_f32 v118, v118, v15
    v_mul_f32 v119, v119, v15
    v_cvt_pk_bf16_f32 v116, v116, v117
    v_cvt_pk_bf16_f32 v117, v118, v119
    ds_write_b64 v193, v[116:117] offset:0
    v_mul_f32 v128, v128, v14
    v_mul_f32 v129, v129, v14
    v_mul_f32 v130, v130, v14
    v_mul_f32 v131, v131, v14
    v_cvt_pk_bf16_f32 v128, v128, v129
    v_cvt_pk_bf16_f32 v129, v130, v131
    ds_write_b64 v194, v[128:129] offset:0
    v_mul_f32 v132, v132, v15
    v_mul_f32 v133, v133, v15
    v_mul_f32 v134, v134, v15
    v_mul_f32 v135, v135, v15
    v_cvt_pk_bf16_f32 v132, v132, v133
    v_cvt_pk_bf16_f32 v133, v134, v135
    ds_write_b64 v195, v[132:133] offset:0
    v_mul_f32 v144, v144, v14
    v_mul_f32 v145, v145, v14
    v_mul_f32 v146, v146, v14
    v_mul_f32 v147, v147, v14
    v_cvt_pk_bf16_f32 v144, v144, v145
    v_cvt_pk_bf16_f32 v145, v146, v147
    ds_write_b64 v196, v[144:145] offset:0
    v_mul_f32 v148, v148, v15
    v_mul_f32 v149, v149, v15
    v_mul_f32 v150, v150, v15
    v_mul_f32 v151, v151, v15
    v_cvt_pk_bf16_f32 v148, v148, v149
    v_cvt_pk_bf16_f32 v149, v150, v151
    ds_write_b64 v197, v[148:149] offset:0
    v_mul_f32 v160, v160, v14
    v_mul_f32 v161, v161, v14
    v_mul_f32 v162, v162, v14
    v_mul_f32 v163, v163, v14
    v_cvt_pk_bf16_f32 v160, v160, v161
    v_cvt_pk_bf16_f32 v161, v162, v163
    ds_write_b64 v198, v[160:161] offset:0
    v_mul_f32 v164, v164, v15
    v_mul_f32 v165, v165, v15
    v_mul_f32 v166, v166, v15
    v_mul_f32 v167, v167, v15
    v_cvt_pk_bf16_f32 v164, v164, v165
    v_cvt_pk_bf16_f32 v165, v166, v167
    ds_write_b64 v199, v[164:165] offset:0
    v_mul_f32 v176, v176, v14
    v_mul_f32 v177, v177, v14
    v_mul_f32 v178, v178, v14
    v_mul_f32 v179, v179, v14
    v_cvt_pk_bf16_f32 v176, v176, v177
    v_cvt_pk_bf16_f32 v177, v178, v179
    ds_write_b64 v200, v[176:177] offset:0
    v_mul_f32 v180, v180, v15
    v_mul_f32 v181, v181, v15
    v_mul_f32 v182, v182, v15
    v_mul_f32 v183, v183, v15
    v_cvt_pk_bf16_f32 v180, v180, v181
    v_cvt_pk_bf16_f32 v181, v182, v183
    ds_write_b64 v201, v[180:181] offset:0
    s_waitcnt lgkmcnt(0)
    ds_read_b128 v[32:35], v19 offset:0
    ds_read_b128 v[36:39], v19 offset:1024
    ds_read_b128 v[40:43], v19 offset:2048
    ds_read_b128 v[44:47], v19 offset:3072
    ds_read_b128 v[48:51], v19 offset:4096
    v_mul_f32 v120, v120, v16
    v_mul_f32 v121, v121, v16
    v_mul_f32 v122, v122, v16
    v_mul_f32 v123, v123, v16
    v_cvt_pk_bf16_f32 v120, v120, v121
    v_cvt_pk_bf16_f32 v121, v122, v123
    ds_write_b64 v192, v[120:121] offset:5120
    v_mul_f32 v124, v124, v17
    v_mul_f32 v125, v125, v17
    v_mul_f32 v126, v126, v17
    v_mul_f32 v127, v127, v17
    v_cvt_pk_bf16_f32 v124, v124, v125
    v_cvt_pk_bf16_f32 v125, v126, v127
    ds_write_b64 v193, v[124:125] offset:5120
    v_mul_f32 v136, v136, v16
    v_mul_f32 v137, v137, v16
    v_mul_f32 v138, v138, v16
    v_mul_f32 v139, v139, v16
    v_cvt_pk_bf16_f32 v136, v136, v137
    v_cvt_pk_bf16_f32 v137, v138, v139
    ds_write_b64 v194, v[136:137] offset:5120
    v_mul_f32 v140, v140, v17
    v_mul_f32 v141, v141, v17
    v_mul_f32 v142, v142, v17
    v_mul_f32 v143, v143, v17
    v_cvt_pk_bf16_f32 v140, v140, v141
    v_cvt_pk_bf16_f32 v141, v142, v143
    ds_write_b64 v195, v[140:141] offset:5120
    v_mul_f32 v152, v152, v16
    v_mul_f32 v153, v153, v16
    v_mul_f32 v154, v154, v16
    v_mul_f32 v155, v155, v16
    v_cvt_pk_bf16_f32 v152, v152, v153
    v_cvt_pk_bf16_f32 v153, v154, v155
    ds_write_b64 v196, v[152:153] offset:5120
    v_mul_f32 v156, v156, v17
    v_mul_f32 v157, v157, v17
    v_mul_f32 v158, v158, v17
    v_mul_f32 v159, v159, v17
    v_cvt_pk_bf16_f32 v156, v156, v157
    v_cvt_pk_bf16_f32 v157, v158, v159
    ds_write_b64 v197, v[156:157] offset:5120
    v_mul_f32 v168, v168, v16
    v_mul_f32 v169, v169, v16
    v_mul_f32 v170, v170, v16
    v_mul_f32 v171, v171, v16
    v_cvt_pk_bf16_f32 v168, v168, v169
    v_cvt_pk_bf16_f32 v169, v170, v171
    ds_write_b64 v198, v[168:169] offset:5120
    v_mul_f32 v172, v172, v17
    v_mul_f32 v173, v173, v17
    v_mul_f32 v174, v174, v17
    v_mul_f32 v175, v175, v17
    v_cvt_pk_bf16_f32 v172, v172, v173
    v_cvt_pk_bf16_f32 v173, v174, v175
    ds_write_b64 v199, v[172:173] offset:5120
    v_mul_f32 v184, v184, v16
    v_mul_f32 v185, v185, v16
    v_mul_f32 v186, v186, v16
    v_mul_f32 v187, v187, v16
    v_cvt_pk_bf16_f32 v184, v184, v185
    v_cvt_pk_bf16_f32 v185, v186, v187
    ds_write_b64 v200, v[184:185] offset:5120
    v_mul_f32 v188, v188, v17
    v_mul_f32 v189, v189, v17
    v_mul_f32 v190, v190, v17
    v_mul_f32 v191, v191, v17
    v_cvt_pk_bf16_f32 v188, v188, v189
    v_cvt_pk_bf16_f32 v189, v190, v191
    ds_write_b64 v201, v[188:189] offset:5120
    s_waitcnt lgkmcnt(10)
    buffer_store_dwordx4 v[32:35], v18, s[12:15], s24 offen offset:0 sc1
    buffer_store_dwordx4 v[36:39], v18, s[12:15], s24 offen offset:1024 sc1
    buffer_store_dwordx4 v[40:43], v18, s[12:15], s24 offen offset:2048 sc1
    buffer_store_dwordx4 v[44:47], v18, s[12:15], s24 offen offset:3072 sc1
    buffer_store_dwordx4 v[48:51], v18, s[12:15], s26 offen offset:0 sc1
    s_waitcnt lgkmcnt(0)
    ds_read_b128 v[52:55], v19 offset:5120
    ds_read_b128 v[56:59], v19 offset:6144
    ds_read_b128 v[60:63], v19 offset:7168
    ds_read_b128 v[64:67], v19 offset:8192
    ds_read_b128 v[68:71], v19 offset:9216
    s_waitcnt lgkmcnt(0)
    buffer_store_dwordx4 v[52:55], v18, s[12:15], s25 offen offset:0 sc1
    buffer_store_dwordx4 v[56:59], v18, s[12:15], s25 offen offset:1024 sc1
    buffer_store_dwordx4 v[60:63], v18, s[12:15], s25 offen offset:2048 sc1
    buffer_store_dwordx4 v[64:67], v18, s[12:15], s25 offen offset:3072 sc1
    buffer_store_dwordx4 v[68:71], v18, s[12:15], s27 offen offset:0 sc1
    s_waitcnt vmcnt(10)
    s_branch K1_JOB
K1_EPI_K:
    s_mul_i32 s24, s16, 7168
    s_add_u32 s24, s24, 2621440
    s_add_u32 s25, s24, 3584
    s_mul_i32 s31, s18, 10240
    v_mov_b32 v24, 16
    v_add_u32 v22, 0, v3
    v_mul_u32_u24 v19, 52, v22
    v_lshrrev_b32 v19, 8, v19
    v_mul_u32_u24 v20, 5, v19
    v_sub_u32 v20, v22, v20
    v_mul_u32_u24 v19, 0, v19
    v_lshrrev_b32 v21, 1, v20
    v_lshlrev_b32 v21, 9, v21
    v_add_u32 v19, v19, v21
    v_and_b32 v21, 1, v20
    v_lshl_add_u32 v19, v21, 3, v19
    v_cmp_eq_u32 vcc, 4, v20
    v_add_u32 v19, s31, v19
    s_nop 0
    v_cndmask_b32 v21, 4, 3, vcc
    s_nop 0
    v_lshlrev_b32 v20, v21, v2
    v_add_u32 v192, v19, v20
    v_lshlrev_b32 v193, v21, v24
    v_add_u32 v193, v192, v193
    v_add_u32 v22, 4, v3
    v_mul_u32_u24 v19, 52, v22
    v_lshrrev_b32 v19, 8, v19
    v_mul_u32_u24 v20, 5, v19
    v_sub_u32 v20, v22, v20
    v_mul_u32_u24 v19, 0, v19
    v_lshrrev_b32 v21, 1, v20
    v_lshlrev_b32 v21, 9, v21
    v_add_u32 v19, v19, v21
    v_and_b32 v21, 1, v20
    v_lshl_add_u32 v19, v21, 3, v19
    v_cmp_eq_u32 vcc, 4, v20
    v_add_u32 v19, s31, v19
    s_nop 0
    v_cndmask_b32 v21, 4, 3, vcc
    s_nop 0
    v_lshlrev_b32 v20, v21, v2
    v_add_u32 v194, v19, v20
    v_lshlrev_b32 v195, v21, v24
    v_add_u32 v195, v194, v195
    s_add_u32 s26, s31, 4096
    v_lshl_add_u32 v23, v1, 3, s26
    v_cmp_eq_u32 vcc, 0, v3
    v_mov_b32 v25, 2147418112
    s_nop 0
    v_cndmask_b32 v194, v23, v194, vcc
    v_cndmask_b32 v195, v23, v195, vcc
    v_mov_b32 v200, 0
    v_mul_f32 v112, v112, v14
    v_mul_f32 v113, v113, v14
    v_mul_f32 v114, v114, v14
    v_mul_f32 v115, v115, v14
    v_mul_f32 v128, v128, v14
    v_mul_f32 v129, v129, v14
    v_mul_f32 v130, v130, v14
    v_mul_f32 v131, v131, v14
    v_mul_f32 v201, v112, v112
    v_fmac_f32 v201, v113, v113
    v_fmac_f32 v201, v114, v114
    v_fmac_f32 v201, v115, v115
    v_mul_f32 v202, v128, v128
    v_fmac_f32 v202, v129, v129
    v_fmac_f32 v202, v130, v130
    v_fmac_f32 v202, v131, v131
    v_cndmask_b32 v202, 0, v202, vcc
    v_add_f32 v201, v201, v202
    v_mov_b32 v202, v201
    s_nop 1
    v_permlane16_swap_b32 v202, v201
    s_nop 0
    v_add_f32 v201, v201, v202
    v_mov_b32 v202, v201
    s_nop 1
    v_permlane32_swap_b32 v202, v201
    s_nop 0
    v_add_f32 v201, v201, v202
    v_max_f32 v200, v200, v201
    v_cvt_pk_bf16_f32 v112, v112, v113
    v_cvt_pk_bf16_f32 v113, v114, v115
    ds_write_b64 v192, v[112:113] offset:0
    v_cvt_pk_bf16_f32 v128, v128, v129
    v_cvt_pk_bf16_f32 v129, v130, v131
    ds_write_b64 v194, v[128:129] offset:0
    v_mul_f32 v116, v116, v15
    v_mul_f32 v117, v117, v15
    v_mul_f32 v118, v118, v15
    v_mul_f32 v119, v119, v15
    v_mul_f32 v132, v132, v15
    v_mul_f32 v133, v133, v15
    v_mul_f32 v134, v134, v15
    v_mul_f32 v135, v135, v15
    v_mul_f32 v201, v116, v116
    v_fmac_f32 v201, v117, v117
    v_fmac_f32 v201, v118, v118
    v_fmac_f32 v201, v119, v119
    v_mul_f32 v202, v132, v132
    v_fmac_f32 v202, v133, v133
    v_fmac_f32 v202, v134, v134
    v_fmac_f32 v202, v135, v135
    v_cndmask_b32 v202, 0, v202, vcc
    v_add_f32 v201, v201, v202
    v_mov_b32 v202, v201
    s_nop 1
    v_permlane16_swap_b32 v202, v201
    s_nop 0
    v_add_f32 v201, v201, v202
    v_mov_b32 v202, v201
    s_nop 1
    v_permlane32_swap_b32 v202, v201
    s_nop 0
    v_add_f32 v201, v201, v202
    v_max_f32 v200, v200, v201
    v_cvt_pk_bf16_f32 v116, v116, v117
    v_cvt_pk_bf16_f32 v117, v118, v119
    ds_write_b64 v193, v[116:117] offset:0
    v_cvt_pk_bf16_f32 v132, v132, v133
    v_cvt_pk_bf16_f32 v133, v134, v135
    ds_write_b64 v195, v[132:133] offset:0
    v_mul_f32 v120, v120, v16
    v_mul_f32 v121, v121, v16
    v_mul_f32 v122, v122, v16
    v_mul_f32 v123, v123, v16
    v_mul_f32 v136, v136, v16
    v_mul_f32 v137, v137, v16
    v_mul_f32 v138, v138, v16
    v_mul_f32 v139, v139, v16
    v_mul_f32 v201, v120, v120
    v_fmac_f32 v201, v121, v121
    v_fmac_f32 v201, v122, v122
    v_fmac_f32 v201, v123, v123
    v_mul_f32 v202, v136, v136
    v_fmac_f32 v202, v137, v137
    v_fmac_f32 v202, v138, v138
    v_fmac_f32 v202, v139, v139
    v_cndmask_b32 v202, 0, v202, vcc
    v_add_f32 v201, v201, v202
    v_mov_b32 v202, v201
    s_nop 1
    v_permlane16_swap_b32 v202, v201
    s_nop 0
    v_add_f32 v201, v201, v202
    v_mov_b32 v202, v201
    s_nop 1
    v_permlane32_swap_b32 v202, v201
    s_nop 0
    v_add_f32 v201, v201, v202
    v_max_f32 v200, v200, v201
    v_cvt_pk_bf16_f32 v120, v120, v121
    v_cvt_pk_bf16_f32 v121, v122, v123
    ds_write_b64 v192, v[120:121] offset:2048
    v_cvt_pk_bf16_f32 v136, v136, v137
    v_cvt_pk_bf16_f32 v137, v138, v139
    ds_write_b64 v194, v[136:137] offset:2048
    v_mul_f32 v124, v124, v17
    v_mul_f32 v125, v125, v17
    v_mul_f32 v126, v126, v17
    v_mul_f32 v127, v127, v17
    v_mul_f32 v140, v140, v17
    v_mul_f32 v141, v141, v17
    v_mul_f32 v142, v142, v17
    v_mul_f32 v143, v143, v17
    v_mul_f32 v201, v124, v124
    v_fmac_f32 v201, v125, v125
    v_fmac_f32 v201, v126, v126
    v_fmac_f32 v201, v127, v127
    v_mul_f32 v202, v140, v140
    v_fmac_f32 v202, v141, v141
    v_fmac_f32 v202, v142, v142
    v_fmac_f32 v202, v143, v143
    v_cndmask_b32 v202, 0, v202, vcc
    v_add_f32 v201, v201, v202
    v_mov_b32 v202, v201
    s_nop 1
    v_permlane16_swap_b32 v202, v201
    s_nop 0
    v_add_f32 v201, v201, v202
    v_mov_b32 v202, v201
    s_nop 1
    v_permlane32_swap_b32 v202, v201
    s_nop 0
    v_add_f32 v201, v201, v202
    v_max_f32 v200, v200, v201
    v_cvt_pk_bf16_f32 v124, v124, v125
    v_cvt_pk_bf16_f32 v125, v126, v127
    ds_write_b64 v193, v[124:125] offset:2048
    v_cvt_pk_bf16_f32 v140, v140, v141
    v_cvt_pk_bf16_f32 v141, v142, v143
    ds_write_b64 v195, v[140:141] offset:2048
    s_add_u32 s26, s31, 1280
    v_lshl_add_u32 v19, v1, 3, s26
    v_cmp_gt_u32 vcc, 32, v1
    v_mov_b32 v20, 0x3f803f80
    v_mov_b32 v21, 0x00003f80
    v_cndmask_b32 v19, v23, v19, vcc
    ds_write_b64 v19, v[20:21] offset:0
    ds_write_b64 v19, v[20:21] offset:2048
    s_nop 1
    v_max_f32_dpp v200, v200, v200 row_ror:8 row_mask:0xf bank_mask:0xf
    s_nop 1
    v_max_f32_dpp v200, v200, v200 row_ror:4 row_mask:0xf bank_mask:0xf
    s_nop 1
    v_max_f32_dpp v200, v200, v200 row_ror:2 row_mask:0xf bank_mask:0xf
    s_nop 1
    v_max_f32_dpp v200, v200, v200 row_ror:1 row_mask:0xf bank_mask:0xf
    v_lshlrev_b32 v18, 4, v1
    v_add_u32 v19, s31, v18
    v_lshlrev_b32 v20, 3, v1
    v_add_u32 v21, s31, v20
    s_waitcnt lgkmcnt(0)
    s_barrier
    ds_read_b128 v[32:35], v19 offset:0
    ds_read_b64 v[36:37], v21 offset:1024
    ds_read_b128 v[40:43], v19 offset:2048
    ds_read_b64 v[44:45], v21 offset:3072
    s_lshl_b32 s26, s16, 2
    s_add_u32 s26, s26, 2850816
    v_cmp_eq_u32 vcc, 0, v1
    v_mov_b32 v22, 0
    s_waitcnt lgkmcnt(0)
    v_cndmask_b32 v22, v25, v22, vcc
    buffer_store_dwordx4 v[32:35], v18, s[12:15], s24 offen sc1
    buffer_store_dwordx2 v[36:37], v20, s[12:15], s24 offen offset:1024 sc1
    buffer_store_dwordx4 v[40:43], v18, s[12:15], s25 offen sc1
    buffer_store_dwordx2 v[44:45], v20, s[12:15], s25 offen offset:1024 sc1
    buffer_store_dword v200, v22, s[12:15], s26 offen sc1
    s_lshl_b32 s26, s16, 7
    s_add_u32 s26, s26, 2854912
    v_lshlrev_b32 v19, 2, v1
    v_cmp_gt_u32 vcc, 32, v1
    v_mov_b32 v20, 0
    s_nop 0
    v_cndmask_b32 v19, v25, v19, vcc
    buffer_store_dword v20, v19, s[12:15], s26 offen sc1
    s_waitcnt vmcnt(6)
    s_branch K1_JOB
K1_EPI_V:
    s_mul_i32 s24, s16, 7168
    s_add_u32 s24, s24, 2622976
    s_mul_i32 s31, s18, 10240
    v_lshrrev_b32 v19, 3, v2
    v_lshlrev_b32 v19, 9, v19
    v_and_b32 v20, 7, v2
    v_lshl_add_u32 v19, v20, 1, v19
    v_lshl_add_u32 v19, v3, 6, v19
    v_add_u32 v19, s31, v19
    s_add_u32 s26, s31, 4096
    v_lshl_add_u32 v23, v1, 3, s26
    v_mov_b32 v25, 2147418112
    v_cmp_eq_u32 vcc, 0, v3
    v_add_u32 v20, 256, v19
    s_nop 0
    v_cndmask_b32 v20, v23, v20, vcc
    v_mov_b32 v200, 0
    v_mul_f32 v112, v112, v14
    v_mul_f32 v113, v113, v14
    v_mul_f32 v114, v114, v14
    v_mul_f32 v115, v115, v14
    v_max3_f32 v200, |v112|, |v113|, v200
    v_max3_f32 v200, |v114|, |v115|, v200
    v_cvt_pk_bf16_f32 v112, v112, v113
    v_cvt_pk_bf16_f32 v114, v114, v115
    ds_write_b16 v19, v112 offset:0
    ds_write_b16_d16_hi v19, v112 offset:16
    ds_write_b16 v19, v114 offset:32
    ds_write_b16_d16_hi v19, v114 offset:48
    v_mul_f32 v128, v128, v14
    v_mul_f32 v129, v129, v14
    v_mul_f32 v130, v130, v14
    v_mul_f32 v131, v131, v14
    v_max3_f32 v201, |v128|, |v129|, |v130|
    v_max_f32_e64 v201, v201, |v131|
    v_cndmask_b32 v201, 0, v201, vcc
    v_max_f32 v200, v200, v201
    v_cvt_pk_bf16_f32 v128, v128, v129
    v_cvt_pk_bf16_f32 v130, v130, v131
    ds_write_b16 v20, v128 offset:0
    ds_write_b16_d16_hi v20, v128 offset:16
    ds_write_b16 v20, v130 offset:32
    ds_write_b16_d16_hi v20, v130 offset:48
    v_mul_f32 v116, v116, v15
    v_mul_f32 v117, v117, v15
    v_mul_f32 v118, v118, v15
    v_mul_f32 v119, v119, v15
    v_max3_f32 v200, |v116|, |v117|, v200
    v_max3_f32 v200, |v118|, |v119|, v200
    v_cvt_pk_bf16_f32 v116, v116, v117
    v_cvt_pk_bf16_f32 v118, v118, v119
    ds_write_b16 v19, v116 offset:1024
    ds_write_b16_d16_hi v19, v116 offset:1040
    ds_write_b16 v19, v118 offset:1056
    ds_write_b16_d16_hi v19, v118 offset:1072
    v_mul_f32 v132, v132, v15
    v_mul_f32 v133, v133, v15
    v_mul_f32 v134, v134, v15
    v_mul_f32 v135, v135, v15
    v_max3_f32 v201, |v132|, |v133|, |v134|
    v_max_f32_e64 v201, v201, |v135|
    v_cndmask_b32 v201, 0, v201, vcc
    v_max_f32 v200, v200, v201
    v_cvt_pk_bf16_f32 v132, v132, v133
    v_cvt_pk_bf16_f32 v134, v134, v135
    ds_write_b16 v20, v132 offset:1024
    ds_write_b16_d16_hi v20, v132 offset:1040
    ds_write_b16 v20, v134 offset:1056
    ds_write_b16_d16_hi v20, v134 offset:1072
    v_mul_f32 v120, v120, v16
    v_mul_f32 v121, v121, v16
    v_mul_f32 v122, v122, v16
    v_mul_f32 v123, v123, v16
    v_max3_f32 v200, |v120|, |v121|, v200
    v_max3_f32 v200, |v122|, |v123|, v200
    v_cvt_pk_bf16_f32 v120, v120, v121
    v_cvt_pk_bf16_f32 v122, v122, v123
    ds_write_b16 v19, v120 offset:2048
    ds_write_b16_d16_hi v19, v120 offset:2064
    ds_write_b16 v19, v122 offset:2080
    ds_write_b16_d16_hi v19, v122 offset:2096
    v_mul_f32 v136, v136, v16
    v_mul_f32 v137, v137, v16
    v_mul_f32 v138, v138, v16
    v_mul_f32 v139, v139, v16
    v_max3_f32 v201, |v136|, |v137|, |v138|
    v_max_f32_e64 v201, v201, |v139|
    v_cndmask_b32 v201, 0, v201, vcc
    v_max_f32 v200, v200, v201
    v_cvt_pk_bf16_f32 v136, v136, v137
    v_cvt_pk_bf16_f32 v138, v138, v139
    ds_write_b16 v20, v136 offset:2048
    ds_write_b16_d16_hi v20, v136 offset:2064
    ds_write_b16 v20, v138 offset:2080
    ds_write_b16_d16_hi v20, v138 offset:2096
    v_mul_f32 v124, v124, v17
    v_mul_f32 v125, v125, v17
    v_mul_f32 v126, v126, v17
    v_mul_f32 v127, v127, v17
    v_max3_f32 v200, |v124|, |v125|, v200
    v_max3_f32 v200, |v126|, |v127|, v200
    v_cvt_pk_bf16_f32 v124, v124, v125
    v_cvt_pk_bf16_f32 v126, v126, v127
    ds_write_b16 v19, v124 offset:3072
    ds_write_b16_d16_hi v19, v124 offset:3088
    ds_write_b16 v19, v126 offset:3104
    ds_write_b16_d16_hi v19, v126 offset:3120
    v_mul_f32 v140, v140, v17
    v_mul_f32 v141, v141, v17
    v_mul_f32 v142, v142, v17
    v_mul_f32 v143, v143, v17
    v_max3_f32 v201, |v140|, |v141|, |v142|
    v_max_f32_e64 v201, v201, |v143|
    v_cndmask_b32 v201, 0, v201, vcc
    v_max_f32 v200, v200, v201
    v_cvt_pk_bf16_f32 v140, v140, v141
    v_cvt_pk_bf16_f32 v142, v142, v143
    ds_write_b16 v20, v140 offset:3072
    ds_write_b16_d16_hi v20, v140 offset:3088
    ds_write_b16 v20, v142 offset:3104
    ds_write_b16_d16_hi v20, v142 offset:3120
    v_cmp_lt_u32 vcc, 11, v1
    s_nop 1
    v_cndmask_b32 v21, 0, 1, vcc
    v_mul_u32_u24 v22, 12, v21
    v_sub_u32 v22, v1, v22
    v_cmp_eq_u32 vcc, 0, v22
    v_add_u32 v22, 20, v22
    v_lshl_add_u32 v22, v21, 5, v22
    v_lshlrev_b32 v22, 4, v22
    v_add_u32 v22, s31, v22
    v_mov_b32 v24, 0x3f803f80
    v_cndmask_b32 v192, 0, v24, vcc
    v_mov_b32 v193, v192
    v_mov_b32 v194, v192
    v_mov_b32 v195, v192
    s_add_u32 s26, s31, 4096
    v_lshl_add_u32 v24, v1, 4, s26
    v_cmp_gt_u32 vcc, 24, v1
    s_nop 1
    v_cndmask_b32 v22, v24, v22, vcc
    ds_write_b128 v22, v[192:195] offset:0
    ds_write_b128 v22, v[192:195] offset:1024
    ds_write_b128 v22, v[192:195] offset:2048
    ds_write_b128 v22, v[192:195] offset:3072
    v_mov_b32 v201, v200
    s_nop 1
    v_permlane16_swap_b32 v201, v200
    s_nop 0
    v_max_f32 v200, v200, v201
    v_mov_b32 v201, v200
    s_nop 1
    v_permlane32_swap_b32 v201, v200
    s_nop 0
    v_max_f32 v200, v200, v201
    s_nop 1
    v_max_f32_dpp v200, v200, v200 row_ror:8 row_mask:0xf bank_mask:0xf
    s_nop 1
    v_max_f32_dpp v200, v200, v200 row_ror:4 row_mask:0xf bank_mask:0xf
    s_nop 1
    v_max_f32_dpp v200, v200, v200 row_ror:2 row_mask:0xf bank_mask:0xf
    s_nop 1
    v_max_f32_dpp v200, v200, v200 row_ror:1 row_mask:0xf bank_mask:0xf
    v_lshlrev_b32 v18, 4, v1
    v_add_u32 v19, s31, v18
    s_waitcnt lgkmcnt(0)
    s_barrier
    ds_read_b128 v[32:35], v19 offset:0
    ds_read_b128 v[36:39], v19 offset:1024
    ds_read_b128 v[40:43], v19 offset:2048
    ds_read_b128 v[44:47], v19 offset:3072
    s_lshl_b32 s26, s16, 2
    s_add_u32 s26, s26, 2850944
    s_add_u32 s25, s24, 3584
    v_cmp_eq_u32 vcc, 0, v1
    v_mov_b32 v19, 0
    s_waitcnt lgkmcnt(0)
    v_cndmask_b32 v19, v25, v19, vcc
    buffer_store_dwordx4 v[32:35], v18, s[12:15], s24 offen offset:0 sc1
    buffer_store_dwordx4 v[36:39], v18, s[12:15], s24 offen offset:1024 sc1
    buffer_store_dwordx4 v[40:43], v18, s[12:15], s25 offen offset:0 sc1
    buffer_store_dwordx4 v[44:47], v18, s[12:15], s25 offen offset:1024 sc1
    buffer_store_dword v200, v19, s[12:15], s26 offen sc1
    s_waitcnt vmcnt(5)
K1_JOB:
K1_END_WAIT:
K1_END:
    s_endpgm
K1_HELPER:
    s_waitcnt lgkmcnt(0)
    s_mov_b32 s12, s64
    s_and_b32 s13, s65, 0xffff
    s_mov_b32 s14, 16777216
    s_mov_b32 s15, 0x00020000
    v_lshrrev_b32 v18, 3, v1
    v_bfe_u32 v19, v18, 1, 2
    v_lshlrev_b32 v19, 1, v19
    v_and_b32 v20, 7, v1
    v_xor_b32 v20, v20, v19
    v_mul_u32_u24 v18, 1280, v18
    v_lshl_add_u32 v27, v20, 4, v18
    s_mov_b32 s18, 0
    s_lshl_b32 s32, s2, 2
    s_add_u32 s32, s32, s18
    s_mul_i32 s66, s32, 6554
    s_lshr_b32 s66, s66, 16
    s_mul_i32 s67, s66, 10
    s_sub_u32 s67, s32, s67
    s_cmp_lt_u32 s66, 54
    s_cselect_b32 s36, s58, s52
    s_cselect_b32 s37, s59, s53
    s_mov_b32 s38, 2211840
    s_cselect_b32 s38, s38, 819200
    s_cselect_b32 s32, 0, 54
    s_and_b32 s37, s37, 0xffff
    s_mov_b32 s39, 0x00020000
    s_sub_u32 s32, s66, s32
    s_mul_i32 s32, s32, 40960
    s_lshl_b32 s43, s67, 7
    s_add_u32 s43, s43, s32
    s_mov_b32 m0, 144384
    s_add_u32 s20, s43, 0
    buffer_load_dwordx4 v27, s[36:39], s20 offen lds
    s_mov_b32 m0, 145408
    s_add_u32 s20, s43, 10240
    buffer_load_dwordx4 v27, s[36:39], s20 offen lds
    s_mov_b32 m0, 146432
    s_add_u32 s20, s43, 20480
    buffer_load_dwordx4 v27, s[36:39], s20 offen lds
    s_mov_b32 m0, 147456
    s_add_u32 s20, s43, 30720
    buffer_load_dwordx4 v27, s[36:39], s20 offen lds
    s_mov_b32 s84, s66
    s_mov_b32 s88, s67
    s_mov_b32 s18, 1
    s_lshl_b32 s32, s2, 2
    s_add_u32 s32, s32, s18
    s_mul_i32 s66, s32, 6554
    s_lshr_b32 s66, s66, 16
    s_mul_i32 s67, s66, 10
    s_sub_u32 s67, s32, s67
    s_cmp_lt_u32 s66, 54
    s_cselect_b32 s36, s58, s52
    s_cselect_b32 s37, s59, s53
    s_mov_b32 s38, 2211840
    s_cselect_b32 s38, s38, 819200
    s_cselect_b32 s32, 0, 54
    s_and_b32 s37, s37, 0xffff
    s_mov_b32 s39, 0x00020000
    s_sub_u32 s32, s66, s32
    s_mul_i32 s32, s32, 40960
    s_lshl_b32 s43, s67, 7
    s_add_u32 s43, s43, s32
    s_mov_b32 m0, 149504
    s_add_u32 s20, s43, 0
    buffer_load_dwordx4 v27, s[36:39], s20 offen lds
    s_mov_b32 m0, 150528
    s_add_u32 s20, s43, 10240
    buffer_load_dwordx4 v27, s[36:39], s20 offen lds
    s_mov_b32 m0, 151552
    s_add_u32 s20, s43, 20480
    buffer_load_dwordx4 v27, s[36:39], s20 offen lds
    s_mov_b32 m0, 152576
    s_add_u32 s20, s43, 30720
    buffer_load_dwordx4 v27, s[36:39], s20 offen lds
    s_mov_b32 s85, s66
    s_mov_b32 s89, s67
    s_mov_b32 s18, 2
    s_lshl_b32 s32, s2, 2
    s_add_u32 s32, s32, s18
    s_mul_i32 s66, s32, 6554
    s_lshr_b32 s66, s66, 16
    s_mul_i32 s67, s66, 10
    s_sub_u32 s67, s32, s67
    s_cmp_lt_u32 s66, 54
    s_cselect_b32 s36, s58, s52
    s_cselect_b32 s37, s59, s53
    s_mov_b32 s38, 2211840
    s_cselect_b32 s38, s38, 819200
    s_cselect_b32 s32, 0, 54
    s_and_b32 s37, s37, 0xffff
    s_mov_b32 s39, 0x00020000
    s_sub_u32 s32, s66, s32
    s_mul_i32 s32, s32, 40960
    s_lshl_b32 s43, s67, 7
    s_add_u32 s43, s43, s32
    s_mov_b32 m0, 154624
    s_add_u32 s20, s43, 0
    buffer_load_dwordx4 v27, s[36:39], s20 offen lds
    s_mov_b32 m0, 155648
    s_add_u32 s20, s43, 10240
    buffer_load_dwordx4 v27, s[36:39], s20 offen lds
    s_mov_b32 m0, 156672
    s_add_u32 s20, s43, 20480
    buffer_load_dwordx4 v27, s[36:39], s20 offen lds
    s_mov_b32 m0, 157696
    s_add_u32 s20, s43, 30720
    buffer_load_dwordx4 v27, s[36:39], s20 offen lds
    s_mov_b32 s86, s66
    s_mov_b32 s90, s67
    s_mov_b32 s18, 3
    s_lshl_b32 s32, s2, 2
    s_add_u32 s32, s32, s18
    s_mul_i32 s66, s32, 6554
    s_lshr_b32 s66, s66, 16
    s_mul_i32 s67, s66, 10
    s_sub_u32 s67, s32, s67
    s_cmp_lt_u32 s66, 54
    s_cselect_b32 s36, s58, s52
    s_cselect_b32 s37, s59, s53
    s_mov_b32 s38, 2211840
    s_cselect_b32 s38, s38, 819200
    s_cselect_b32 s32, 0, 54
    s_and_b32 s37, s37, 0xffff
    s_mov_b32 s39, 0x00020000
    s_sub_u32 s32, s66, s32
    s_mul_i32 s32, s32, 40960
    s_lshl_b32 s43, s67, 7
    s_add_u32 s43, s43, s32
    s_mov_b32 m0, 159744
    s_add_u32 s20, s43, 0
    buffer_load_dwordx4 v27, s[36:39], s20 offen lds
    s_mov_b32 m0, 160768
    s_add_u32 s20, s43, 10240
    buffer_load_dwordx4 v27, s[36:39], s20 offen lds
    s_mov_b32 m0, 161792
    s_add_u32 s20, s43, 20480
    buffer_load_dwordx4 v27, s[36:39], s20 offen lds
    s_mov_b32 m0, 162816
    s_add_u32 s20, s43, 30720
    buffer_load_dwordx4 v27, s[36:39], s20 offen lds
    s_mov_b32 s87, s66
    s_mov_b32 s91, s67
    s_and_b32 s24, s16, 15
    s_cmp_lt_u32 s17, 2
    s_cselect_b32 s8, s46, s56
    s_cselect_b32 s9, s47, s57
    s_mov_b32 s10, 819200
    s_cselect_b32 s10, s10, 2211840
    s_mov_b32 s27, 1280
    s_cselect_b32 s27, s27, 3456
    s_cselect_b32 s28, 0, 2
    s_and_b32 s9, s9, 0xffff
    s_mov_b32 s11, 0x00020000
    s_sub_u32 s28, s17, s28
    s_mul_i32 s28, s28, 640
    s_mul_i32 s29, s24, 2
    v_add_u32 v18, 30, v1
    v_mul_u32_u24 v19, 6554, v18
    v_lshrrev_b32 v19, 16, v19
    v_mul_u32_u24 v20, 10, v19
    v_sub_u32 v20, v18, v20
    v_mul_u32_u24 v21, 52, v20
    v_lshrrev_b32 v21, 8, v21
    v_mul_u32_u24 v22, 5, v21
    v_sub_u32 v22, v20, v22
    v_lshl_add_u32 v21, v19, 5, v21
    v_add_u32 v21, s29, v21
    v_mul_lo_u32 v21, v21, s27
    v_lshl_add_u32 v40, v22, 7, v21
    v_add_u32 v18, 94, v1
    v_mul_u32_u24 v19, 6554, v18
    v_lshrrev_b32 v19, 16, v19
    v_mul_u32_u24 v20, 10, v19
    v_sub_u32 v20, v18, v20
    v_mul_u32_u24 v21, 52, v20
    v_lshrrev_b32 v21, 8, v21
    v_mul_u32_u24 v22, 5, v21
    v_sub_u32 v22, v20, v22
    v_lshl_add_u32 v21, v19, 5, v21
    v_add_u32 v21, s29, v21
    v_mul_lo_u32 v21, v21, s27
    v_lshl_add_u32 v41, v22, 7, v21
    v_add_u32 v18, 158, v1
    v_mul_u32_u24 v19, 6554, v18
    v_lshrrev_b32 v19, 16, v19
    v_mul_u32_u24 v20, 10, v19
    v_sub_u32 v20, v18, v20
    v_mul_u32_u24 v21, 52, v20
    v_lshrrev_b32 v21, 8, v21
    v_mul_u32_u24 v22, 5, v21
    v_sub_u32 v22, v20, v22
    v_lshl_add_u32 v21, v19, 5, v21
    v_add_u32 v21, s29, v21
    v_mul_lo_u32 v21, v21, s27
    v_lshl_add_u32 v42, v22, 7, v21
    s_cmp_lg_u32 s17, 7
    s_cbranch_scc1 K1_H_A
    s_mul_i32 s29, s24, 13
    v_min_u32 v18, 12, v1
    v_add_u32 v18, s29, v18
    v_lshlrev_b32 v18, 7, v18
    s_mov_b32 s36, s48
    s_and_b32 s37, s49, 0xffff
    s_mov_b32 s38, 25600
    s_mov_b32 s39, 0x00020000
    buffer_load_dword v26, v18, s[36:39], 0 offen
    s_mov_b32 s36, s50
    s_and_b32 s37, s51, 0xffff
    s_mov_b32 s38, 25600
    s_mov_b32 s39, 0x00020000
    buffer_load_dword v26, v18, s[36:39], 0 offen
K1_H_A:
    s_lshr_b32 s18, s2, 3
    s_getpc_b64 s[32:33]
CT_K1:
    s_sub_u32 s32, s32, CT_K1-K1_LOOP
    s_subb_u32 s33, s33, 0
    s_mul_i32 s34, s18, 3
    v_min_u32 v236, 2, v1
    v_add_u32 v236, s34, v236
    v_lshlrev_b32 v236, 7, v236
    v_min_u32 v236, K1_END-K1_LOOP-4, v236
    v_mov_b32 v237, s33
    v_add_co_u32 v236, vcc, s32, v236
    s_nop 1
    v_addc_co_u32 v237, vcc, 0, v237, vcc
    global_load_dword v238, v[236:237], off
    s_getpc_b64 s[32:33]
CT_K1N:
    s_add_u32 s32, s32, k2_attn_out_kernel-CT_K1N
    s_addc_u32 s33, s33, 0
    s_mul_i32 s34, s18, 7
    v_min_u32 v236, 6, v1
    v_add_u32 v236, s34, v236
    v_lshlrev_b32 v236, 7, v236
    v_min_u32 v236, K2_END-k2_attn_out_kernel-4, v236
    v_mov_b32 v237, s33
    v_add_co_u32 v236, vcc, s32, v236
    s_nop 1
    v_addc_co_u32 v237, vcc, 0, v237, vcc
    global_load_dword v238, v[236:237], off
    buffer_load_dword v26, v40, s[8:11], s28 offen
    s_lshl_b32 s32, s2, 2
    s_add_u32 s32, s32, 0
    s_lshl_b32 s24, s88, 2
    s_add_u32 s24, s24, 0
    s_mul_i32 s25, s24, 52
    s_lshr_b32 s25, s25, 8
    s_mul_i32 s26, s25, 5
    s_sub_u32 s26, s24, s26
    s_mul_i32 s25, s25, 378880
    s_mul_i32 s30, s84, 5
    s_add_u32 s30, s30, s26
    s_lshl_b32 s30, s30, 10
    s_add_u32 s25, s25, s30
    s_add_u32 s25, s25, 13631488
    s_cmp_ge_u32 s32, 740
    s_cselect_b32 s68, 2147418112, s25
    s_lshl_b32 s24, s88, 2
    s_add_u32 s24, s24, 1
    s_mul_i32 s25, s24, 52
    s_lshr_b32 s25, s25, 8
    s_mul_i32 s26, s25, 5
    s_sub_u32 s26, s24, s26
    s_mul_i32 s25, s25, 378880
    s_mul_i32 s30, s84, 5
    s_add_u32 s30, s30, s26
    s_lshl_b32 s30, s30, 10
    s_add_u32 s25, s25, s30
    s_add_u32 s25, s25, 13631488
    s_cmp_ge_u32 s32, 740
    s_cselect_b32 s69, 2147418112, s25
    s_lshl_b32 s24, s88, 2
    s_add_u32 s24, s24, 2
    s_mul_i32 s25, s24, 52
    s_lshr_b32 s25, s25, 8
    s_mul_i32 s26, s25, 5
    s_sub_u32 s26, s24, s26
    s_mul_i32 s25, s25, 378880
    s_mul_i32 s30, s84, 5
    s_add_u32 s30, s30, s26
    s_lshl_b32 s30, s30, 10
    s_add_u32 s25, s25, s30
    s_add_u32 s25, s25, 13631488
    s_cmp_ge_u32 s32, 740
    s_cselect_b32 s70, 2147418112, s25
    s_lshl_b32 s24, s88, 2
    s_add_u32 s24, s24, 3
    s_mul_i32 s25, s24, 52
    s_lshr_b32 s25, s25, 8
    s_mul_i32 s26, s25, 5
    s_sub_u32 s26, s24, s26
    s_mul_i32 s25, s25, 378880
    s_mul_i32 s30, s84, 5
    s_add_u32 s30, s30, s26
    s_lshl_b32 s30, s30, 10
    s_add_u32 s25, s25, s30
    s_add_u32 s25, s25, 13631488
    s_cmp_ge_u32 s32, 740
    s_cselect_b32 s71, 2147418112, s25
    s_lshl_b32 s32, s2, 2
    s_add_u32 s32, s32, 1
    s_lshl_b32 s24, s89, 2
    s_add_u32 s24, s24, 0
    s_mul_i32 s25, s24, 52
    s_lshr_b32 s25, s25, 8
    s_mul_i32 s26, s25, 5
    s_sub_u32 s26, s24, s26
    s_mul_i32 s25, s25, 378880
    s_mul_i32 s30, s85, 5
    s_add_u32 s30, s30, s26
    s_lshl_b32 s30, s30, 10
    s_add_u32 s25, s25, s30
    s_add_u32 s25, s25, 13631488
    s_cmp_ge_u32 s32, 740
    s_cselect_b32 s72, 2147418112, s25
    s_lshl_b32 s24, s89, 2
    s_add_u32 s24, s24, 1
    s_mul_i32 s25, s24, 52
    s_lshr_b32 s25, s25, 8
    s_mul_i32 s26, s25, 5
    s_sub_u32 s26, s24, s26
    s_mul_i32 s25, s25, 378880
    s_mul_i32 s30, s85, 5
    s_add_u32 s30, s30, s26
    s_lshl_b32 s30, s30, 10
    s_add_u32 s25, s25, s30
    s_add_u32 s25, s25, 13631488
    s_cmp_ge_u32 s32, 740
    s_cselect_b32 s73, 2147418112, s25
    s_lshl_b32 s24, s89, 2
    s_add_u32 s24, s24, 2
    s_mul_i32 s25, s24, 52
    s_lshr_b32 s25, s25, 8
    s_mul_i32 s26, s25, 5
    s_sub_u32 s26, s24, s26
    s_mul_i32 s25, s25, 378880
    s_mul_i32 s30, s85, 5
    s_add_u32 s30, s30, s26
    s_lshl_b32 s30, s30, 10
    s_add_u32 s25, s25, s30
    s_add_u32 s25, s25, 13631488
    s_cmp_ge_u32 s32, 740
    s_cselect_b32 s74, 2147418112, s25
    s_lshl_b32 s24, s89, 2
    s_add_u32 s24, s24, 3
    s_mul_i32 s25, s24, 52
    s_lshr_b32 s25, s25, 8
    s_mul_i32 s26, s25, 5
    s_sub_u32 s26, s24, s26
    s_mul_i32 s25, s25, 378880
    s_mul_i32 s30, s85, 5
    s_add_u32 s30, s30, s26
    s_lshl_b32 s30, s30, 10
    s_add_u32 s25, s25, s30
    s_add_u32 s25, s25, 13631488
    s_cmp_ge_u32 s32, 740
    s_cselect_b32 s75, 2147418112, s25
    s_lshl_b32 s32, s2, 2
    s_add_u32 s32, s32, 2
    s_lshl_b32 s24, s90, 2
    s_add_u32 s24, s24, 0
    s_mul_i32 s25, s24, 52
    s_lshr_b32 s25, s25, 8
    s_mul_i32 s26, s25, 5
    s_sub_u32 s26, s24, s26
    s_mul_i32 s25, s25, 378880
    s_mul_i32 s30, s86, 5
    s_add_u32 s30, s30, s26
    s_lshl_b32 s30, s30, 10
    s_add_u32 s25, s25, s30
    s_add_u32 s25, s25, 13631488
    s_cmp_ge_u32 s32, 740
    s_cselect_b32 s76, 2147418112, s25
    s_lshl_b32 s24, s90, 2
    s_add_u32 s24, s24, 1
    s_mul_i32 s25, s24, 52
    s_lshr_b32 s25, s25, 8
    s_mul_i32 s26, s25, 5
    s_sub_u32 s26, s24, s26
    s_mul_i32 s25, s25, 378880
    s_mul_i32 s30, s86, 5
    s_add_u32 s30, s30, s26
    s_lshl_b32 s30, s30, 10
    s_add_u32 s25, s25, s30
    s_add_u32 s25, s25, 13631488
    s_cmp_ge_u32 s32, 740
    s_cselect_b32 s77, 2147418112, s25
    s_lshl_b32 s24, s90, 2
    s_add_u32 s24, s24, 2
    s_mul_i32 s25, s24, 52
    s_lshr_b32 s25, s25, 8
    s_mul_i32 s26, s25, 5
    s_sub_u32 s26, s24, s26
    s_mul_i32 s25, s25, 378880
    s_mul_i32 s30, s86, 5
    s_add_u32 s30, s30, s26
    s_lshl_b32 s30, s30, 10
    s_add_u32 s25, s25, s30
    s_add_u32 s25, s25, 13631488
    s_cmp_ge_u32 s32, 740
    s_cselect_b32 s78, 2147418112, s25
    s_lshl_b32 s24, s90, 2
    s_add_u32 s24, s24, 3
    s_mul_i32 s25, s24, 52
    s_lshr_b32 s25, s25, 8
    s_mul_i32 s26, s25, 5
    s_sub_u32 s26, s24, s26
    s_mul_i32 s25, s25, 378880
    s_mul_i32 s30, s86, 5
    s_add_u32 s30, s30, s26
    s_lshl_b32 s30, s30, 10
    s_add_u32 s25, s25, s30
    s_add_u32 s25, s25, 13631488
    s_cmp_ge_u32 s32, 740
    s_cselect_b32 s79, 2147418112, s25
    s_lshl_b32 s32, s2, 2
    s_add_u32 s32, s32, 3
    s_lshl_b32 s24, s91, 2
    s_add_u32 s24, s24, 0
    s_mul_i32 s25, s24, 52
    s_lshr_b32 s25, s25, 8
    s_mul_i32 s26, s25, 5
    s_sub_u32 s26, s24, s26
    s_mul_i32 s25, s25, 378880
    s_mul_i32 s30, s87, 5
    s_add_u32 s30, s30, s26
    s_lshl_b32 s30, s30, 10
    s_add_u32 s25, s25, s30
    s_add_u32 s25, s25, 13631488
    s_cmp_ge_u32 s32, 740
    s_cselect_b32 s80, 2147418112, s25
    s_lshl_b32 s24, s91, 2
    s_add_u32 s24, s24, 1
    s_mul_i32 s25, s24, 52
    s_lshr_b32 s25, s25, 8
    s_mul_i32 s26, s25, 5
    s_sub_u32 s26, s24, s26
    s_mul_i32 s25, s25, 378880
    s_mul_i32 s30, s87, 5
    s_add_u32 s30, s30, s26
    s_lshl_b32 s30, s30, 10
    s_add_u32 s25, s25, s30
    s_add_u32 s25, s25, 13631488
    s_cmp_ge_u32 s32, 740
    s_cselect_b32 s81, 2147418112, s25
    s_lshl_b32 s24, s91, 2
    s_add_u32 s24, s24, 2
    s_mul_i32 s25, s24, 52
    s_lshr_b32 s25, s25, 8
    s_mul_i32 s26, s25, 5
    s_sub_u32 s26, s24, s26
    s_mul_i32 s25, s25, 378880
    s_mul_i32 s30, s87, 5
    s_add_u32 s30, s30, s26
    s_lshl_b32 s30, s30, 10
    s_add_u32 s25, s25, s30
    s_add_u32 s25, s25, 13631488
    s_cmp_ge_u32 s32, 740
    s_cselect_b32 s82, 2147418112, s25
    s_lshl_b32 s24, s91, 2
    s_add_u32 s24, s24, 3
    s_mul_i32 s25, s24, 52
    s_lshr_b32 s25, s25, 8
    s_mul_i32 s26, s25, 5
    s_sub_u32 s26, s24, s26
    s_mul_i32 s25, s25, 378880
    s_mul_i32 s30, s87, 5
    s_add_u32 s30, s30, s26
    s_lshl_b32 s30, s30, 10
    s_add_u32 s25, s25, s30
    s_add_u32 s25, s25, 13631488
    s_cmp_ge_u32 s32, 740
    s_cselect_b32 s83, 2147418112, s25
    v_lshrrev_b32 v18, 2, v2
    v_lshl_add_u32 v18, v3, 2, v18
    v_bfe_u32 v19, v18, 1, 2
    v_lshlrev_b32 v19, 1, v19
    v_lshlrev_b32 v18, 7, v18
    v_and_b32 v20, 1, v2
    v_lshl_add_u32 v18, v20, 3, v18
    v_add_u32 v18, 144384, v18
    v_bfe_u32 v20, v2, 1, 1
    v_add_u32 v21, 0, v20
    v_xor_b32 v21, v21, v19
    v_lshl_add_u32 v22, v21, 4, v18
    v_add_u32 v21, 2, v20
    v_xor_b32 v21, v21, v19
    v_lshl_add_u32 v23, v21, 4, v18
    v_add_u32 v21, 4, v20
    v_xor_b32 v21, v21, v19
    v_lshl_add_u32 v24, v21, 4, v18
    v_add_u32 v21, 6, v20
    v_xor_b32 v21, v21, v19
    v_lshl_add_u32 v25, v21, 4, v18
    s_waitcnt vmcnt(3)
    ds_read_b64_tr_b16 v[64:65], v22 offset:0
    ds_read_b64_tr_b16 v[66:67], v22 offset:2048
    ds_read_b64_tr_b16 v[68:69], v23 offset:0
    ds_read_b64_tr_b16 v[70:71], v23 offset:2048
    ds_read_b64_tr_b16 v[72:73], v24 offset:0
    ds_read_b64_tr_b16 v[74:75], v24 offset:2048
    ds_read_b64_tr_b16 v[76:77], v25 offset:0
    ds_read_b64_tr_b16 v[78:79], v25 offset:2048
    s_waitcnt lgkmcnt(0)
    ds_read_b64_tr_b16 v[80:81], v22 offset:5120
    ds_read_b64_tr_b16 v[82:83], v22 offset:7168
    ds_read_b64_tr_b16 v[84:85], v23 offset:5120
    ds_read_b64_tr_b16 v[86:87], v23 offset:7168
    ds_read_b64_tr_b16 v[88:89], v24 offset:5120
    ds_read_b64_tr_b16 v[90:91], v24 offset:7168
    ds_read_b64_tr_b16 v[92:93], v25 offset:5120
    ds_read_b64_tr_b16 v[94:95], v25 offset:7168
    s_waitcnt lgkmcnt(0)
    ds_read_b64_tr_b16 v[96:97], v22 offset:10240
    ds_read_b64_tr_b16 v[98:99], v22 offset:12288
    ds_read_b64_tr_b16 v[100:101], v23 offset:10240
    ds_read_b64_tr_b16 v[102:103], v23 offset:12288
    ds_read_b64_tr_b16 v[104:105], v24 offset:10240
    ds_read_b64_tr_b16 v[106:107], v24 offset:12288
    ds_read_b64_tr_b16 v[108:109], v25 offset:10240
    ds_read_b64_tr_b16 v[110:111], v25 offset:12288
    s_waitcnt lgkmcnt(0)
    ds_read_b64_tr_b16 v[112:113], v22 offset:15360
    ds_read_b64_tr_b16 v[114:115], v22 offset:17408
    ds_read_b64_tr_b16 v[116:117], v23 offset:15360
    ds_read_b64_tr_b16 v[118:119], v23 offset:17408
    ds_read_b64_tr_b16 v[120:121], v24 offset:15360
    ds_read_b64_tr_b16 v[122:123], v24 offset:17408
    ds_read_b64_tr_b16 v[124:125], v25 offset:15360
    ds_read_b64_tr_b16 v[126:127], v25 offset:17408
    s_waitcnt lgkmcnt(0)
    s_barrier
    buffer_load_dword v26, v41, s[8:11], s28 offen
    s_barrier
    buffer_load_dword v26, v42, s[8:11], s28 offen
    s_barrier
    v_lshlrev_b32 v18, 4, v1
    buffer_store_dwordx4 v[64:67], v18, s[12:15], s68 offen sc1
    s_barrier
    buffer_store_dwordx4 v[68:71], v18, s[12:15], s69 offen sc1
    s_barrier
    buffer_store_dwordx4 v[72:75], v18, s[12:15], s70 offen sc1
    s_barrier
    buffer_store_dwordx4 v[76:79], v18, s[12:15], s71 offen sc1
    s_barrier
    buffer_store_dwordx4 v[80:83], v18, s[12:15], s72 offen sc1
    s_barrier
    buffer_store_dwordx4 v[84:87], v18, s[12:15], s73 offen sc1
    s_barrier
    buffer_store_dwordx4 v[88:91], v18, s[12:15], s74 offen sc1
    s_barrier
    buffer_store_dwordx4 v[92:95], v18, s[12:15], s75 offen sc1
    s_barrier
    buffer_store_dwordx4 v[96:99], v18, s[12:15], s76 offen sc1
    s_barrier
    buffer_store_dwordx4 v[100:103], v18, s[12:15], s77 offen sc1
    s_barrier
    buffer_store_dwordx4 v[104:107], v18, s[12:15], s78 offen sc1
    s_barrier
    buffer_store_dwordx4 v[108:111], v18, s[12:15], s79 offen sc1
    s_barrier
    buffer_store_dwordx4 v[112:115], v18, s[12:15], s80 offen sc1
    s_barrier
    buffer_store_dwordx4 v[116:119], v18, s[12:15], s81 offen sc1
    s_barrier
    buffer_store_dwordx4 v[120:123], v18, s[12:15], s82 offen sc1
    s_barrier
    buffer_store_dwordx4 v[124:127], v18, s[12:15], s83 offen sc1
    s_endpgm
.text
.globl k2_attn_out_kernel
.p2align 8
.type k2_attn_out_kernel,@function
k2_attn_out_kernel:
    s_cmp_ge_u32 s2, 256
    s_cbranch_scc1 K2_END
    s_load_dwordx2 s[32:33], s[0:1], 80
    s_load_dwordx2 s[34:35], s[0:1], 0
    s_load_dwordx2 s[36:37], s[0:1], 64
    v_and_b32 v1, 63, v0
    v_lshrrev_b32 v5, 6, v0
    v_lshlrev_b32 v3, 4, v1
    v_readfirstlane_b32 s10, v5
    v_lshlrev_b32 v4, 3, v1
    s_and_b32 s16, s2, 7
    s_lshr_b32 s17, s2, 3
    s_lshr_b32 s18, s16, 1
    s_lshl_b32 s18, s18, 3
    s_lshr_b32 s19, s17, 2
    s_add_u32 s48, s18, s19
    s_and_b32 s18, s16, 1
    s_lshl_b32 s18, s18, 2
    s_and_b32 s19, s17, 3
    s_add_u32 s49, s18, s19
    s_lshr_b32 s16, s49, 2
    s_lshl_b32 s8, s48, 1
    s_add_u32 s8, s8, s16
    s_and_b32 s9, s49, 3
    s_lshl_b32 s24, s8, 5
    s_lshl_b32 s25, s9, 3
    s_add_u32 s24, s24, s25
    s_mul_i32 s24, s24, 1280
    s_mul_i32 s11, s10, 57344
    s_add_u32 s11, s11, 2621440
    s_mov_b32 s26, 2850816
    v_lshlrev_b32 v61, 2, v1
    v_mov_b32 v112, 0
    v_mov_b32 v113, 0
    v_mov_b32 v114, 0
    v_mov_b32 v115, 0
    v_mov_b32 v116, 0
    v_mov_b32 v117, 0
    v_mov_b32 v118, 0
    v_mov_b32 v119, 0
    s_nop 0
    v_mfma_f32_32x32x16_bf16 a[0:15], v[112:115], v[112:115], 0
    v_mfma_f32_32x32x16_bf16 a[16:31], v[112:115], v[112:115], 0
    v_mfma_f32_32x32x16_bf16 a[32:47], v[112:115], v[112:115], 0
    v_mfma_f32_32x32x16_bf16 a[48:63], v[112:115], v[112:115], 0
    v_mfma_f32_32x32x16_bf16 a[64:79], v[112:115], v[112:115], 0
    v_mfma_f32_32x32x16_bf16 a[80:95], v[112:115], v[112:115], 0
    v_mfma_f32_32x32x16_bf16 a[96:111], v[112:115], v[112:115], 0
    v_mfma_f32_32x32x16_bf16 a[112:127], v[112:115], v[112:115], 0
    v_mfma_f32_32x32x16_bf16 v[76:91], v[112:115], v[112:115], 0
    s_waitcnt lgkmcnt(0)
    s_mov_b32 s4, s32
    s_and_b32 s5, s33, 0xffff
    s_mov_b32 s6, 16777216
    s_mov_b32 s7, 0x00020000
    s_add_u32 s60, s10, 0
    s_lshl_b32 s61, s60, 10
    s_add_u32 s62, s24, s61
    s_add_u32 m0, s61, 0
    s_nop 0
    buffer_load_dwordx4 v3, s[4:7], s62 offen lds
    s_add_u32 s60, s10, 4
    s_lshl_b32 s61, s60, 10
    s_add_u32 s62, s24, s61
    s_add_u32 m0, s61, 0
    s_nop 0
    buffer_load_dwordx4 v3, s[4:7], s62 offen lds
    s_add_u32 s60, s10, 8
    s_lshl_b32 s61, s60, 10
    s_add_u32 s62, s24, s61
    s_cmp_ge_u32 s60, 10
    s_cselect_b32 s62, 2147418112, s62
    s_add_u32 m0, s61, 0
    s_nop 0
    buffer_load_dwordx4 v3, s[4:7], s62 offen lds
    buffer_load_dword v62, v61, s[4:7], s26 offen
    buffer_load_dwordx4 v[92:95], v3, s[4:7], s11 offen
    buffer_load_dwordx2 v[96:97], v4, s[4:7], s11 offen offset:1024
    buffer_load_dwordx4 v[104:107], v3, s[4:7], s11 offen offset:1536
    buffer_load_dwordx4 v[108:111], v3, s[4:7], s11 offen offset:2560
    s_lshr_b32 s60, s2, 3
    s_lshl_b32 s60, s60, 2
    s_add_u32 s60, s60, s10
    s_mul_i32 s60, s60, 1792
    s_add_u32 s60, s60, 2621440
    v_min_u32 v5, 13, v1
    v_lshlrev_b32 v5, 7, v5
    buffer_load_dword v127, v5, s[4:7], s60 offen
    s_lshr_b32 s63, s2, 3
    s_lshl_b32 s63, s63, 2
    s_add_u32 s63, s63, s10
    s_getpc_b64 s[60:61]
CT_K2:
    s_add_u32 s60, s60, K2_JOIN-CT_K2
    s_addc_u32 s61, s61, 0
    s_mul_i32 s62, s63, 2
    v_min_u32 v6, 1, v1
    v_add_u32 v6, s62, v6
    v_lshlrev_b32 v6, 7, v6
    v_min_u32 v6, K2_END-K2_JOIN-4, v6
    v_mov_b32 v7, s61
    v_add_co_u32 v6, vcc, s60, v6
    s_nop 1
    v_addc_co_u32 v7, vcc, 0, v7, vcc
    global_load_dword v127, v[6:7], off
    v_mov_b32 v44, 0
    v_mov_b32 v45, 0
    v_mov_b32 v46, 0
    v_mov_b32 v47, 0
    v_mov_b32 v48, 0
    v_mov_b32 v49, 0
    v_mov_b32 v50, 0
    v_mov_b32 v51, 0
    v_mov_b32 v52, 0
    v_mov_b32 v53, 0
    v_mov_b32 v54, 0
    v_mov_b32 v55, 0
    v_mov_b32 v56, 0
    v_mov_b32 v57, 0
    v_mov_b32 v58, 0
    v_mov_b32 v59, 0
    v_mov_b32 v2, 0xdddddddd
    s_mov_b32 s40, s34
    s_and_b32 s41, s35, 0xffff
    s_mov_b32 s42, 2621440
    s_mov_b32 s43, 0x00020000
    s_mov_b32 s44, s36
    s_and_b32 s45, s37, 0xffff
    s_mov_b32 s46, 2621440
    s_mov_b32 s47, 0x00020000
    s_lshl_b32 s50, s48, 2
    s_add_u32 s50, s50, s10
    s_and_b32 s58, s10, 1
    s_mul_i32 s51, s49, 378880
    s_add_u32 s51, s51, 13631488
    s_mul_i32 s53, s10, 5120
    s_xor_b32 s54, s50, 1
    s_mul_i32 s52, s50, 75776
    s_mul_i32 s54, s54, 75776
    s_lshl_b32 s16, s58, 11
    s_add_u32 s16, s16, 2883584
    s_add_u32 s52, s52, s16
    s_add_u32 s54, s54, s16
    s_add_u32 s14, s52, 55296
    s_add_u32 s15, s54, 55296
    s_and_b32 s16, s48, 7
    s_lshl_b32 s16, s16, 2
    s_add_u32 s16, s16, s10
    s_mul_i32 s16, s16, 11904
    s_add_u32 s56, s51, s16
    s_add_u32 s57, s56, 6016
    s_add_u32 s51, s51, s53
    s_lshl_b32 s55, s48, 7
    s_add_u32 s55, s55, 2854912
    v_and_b32 v6, 31, v1
    v_lshrrev_b32 v7, 5, v1
    v_lshrrev_b32 v8, 4, v6
    v_mul_u32_u24 v8, 5120, v8
    v_and_b32 v9, 15, v6
    v_lshl_add_u32 v8, v9, 4, v8
    v_add_u32 v8, 81920, v8
    s_mul_i32 s18, s10, 10
    v_cmp_gt_u32 vcc, 32, v1
    v_mov_b32 v11, 92160
    v_lshl_add_u32 v11, v6, 3, v11
    s_add_u32 s19, s18, 0
    v_add_u32 v9, s19, v7
    v_lshrrev_b32 v10, 3, v9
    v_lshl_add_u32 v120, v10, 10, v8
    v_and_b32 v10, 3, v9
    v_lshl_add_u32 v120, v10, 8, v120
    v_bfe_u32 v10, v9, 2, 1
    v_lshl_add_u32 v120, v10, 3, v120
    s_add_u32 s19, s18, 2
    v_add_u32 v9, s19, v7
    v_lshrrev_b32 v10, 3, v9
    v_lshl_add_u32 v121, v10, 10, v8
    v_and_b32 v10, 3, v9
    v_lshl_add_u32 v121, v10, 8, v121
    v_bfe_u32 v10, v9, 2, 1
    v_lshl_add_u32 v121, v10, 3, v121
    s_add_u32 s19, s18, 4
    v_add_u32 v9, s19, v7
    v_lshrrev_b32 v10, 3, v9
    v_lshl_add_u32 v122, v10, 10, v8
    v_and_b32 v10, 3, v9
    v_lshl_add_u32 v122, v10, 8, v122
    v_bfe_u32 v10, v9, 2, 1
    v_lshl_add_u32 v122, v10, 3, v122
    v_cndmask_b32 v122, v11, v122, vcc
    s_add_u32 s19, s18, 5
    v_add_u32 v9, s19, v7
    v_lshrrev_b32 v10, 3, v9
    v_lshl_add_u32 v123, v10, 10, v8
    v_and_b32 v10, 3, v9
    v_lshl_add_u32 v123, v10, 8, v123
    v_bfe_u32 v10, v9, 2, 1
    v_lshl_add_u32 v123, v10, 3, v123
    s_add_u32 s19, s18, 7
    v_add_u32 v9, s19, v7
    v_lshrrev_b32 v10, 3, v9
    v_lshl_add_u32 v124, v10, 10, v8
    v_and_b32 v10, 3, v9
    v_lshl_add_u32 v124, v10, 8, v124
    v_bfe_u32 v10, v9, 2, 1
    v_lshl_add_u32 v124, v10, 3, v124
    s_add_u32 s19, s18, 9
    v_add_u32 v9, s19, v7
    v_lshrrev_b32 v10, 3, v9
    v_lshl_add_u32 v125, v10, 10, v8
    v_and_b32 v10, 3, v9
    v_lshl_add_u32 v125, v10, 8, v125
    v_bfe_u32 v10, v9, 2, 1
    v_lshl_add_u32 v125, v10, 3, v125
    v_cndmask_b32 v125, v11, v125, vcc
    s_mul_i32 s16, s10, 24576
    v_add_u32 v126, s16, v3
    v_and_b32 v5, 15, v1
    s_lshl_b32 s17, s50, 4
    v_add_u32 v5, s17, v5
    v_mul_u32_u24 v5, 1280, v5
    v_lshrrev_b32 v6, 4, v1
    v_lshl_add_u32 v5, v6, 3, v5
    s_mul_i32 s17, s49, 160
    v_add_u32 v11, s17, v5
    v_cmp_gt_u32 vcc, 47, v1
    v_lshlrev_b32 v10, 7, v1
    v_mov_b32 v5, 2147418112
    v_cndmask_b32 v10, v5, v10, vcc
    s_add_u32 m0, s53, 98304
    s_nop 0
    buffer_load_dwordx4 v3, s[4:7], s51 offen lds
    buffer_load_dwordx4 v3, s[4:7], s51 offen offset:1024 lds
    buffer_load_dwordx4 v3, s[4:7], s51 offen offset:2048 lds
    buffer_load_dwordx4 v3, s[4:7], s51 offen offset:3072 lds
    s_add_u32 s60, s51, 4096
    s_add_u32 m0, s53, 102400
    s_nop 0
    buffer_load_dwordx4 v3, s[4:7], s60 offen lds
    s_add_u32 s51, s51, 20480
    s_add_u32 m0, s53, 118784
    s_nop 0
    buffer_load_dwordx4 v3, s[4:7], s51 offen lds
    buffer_load_dwordx4 v3, s[4:7], s51 offen offset:1024 lds
    buffer_load_dwordx4 v3, s[4:7], s51 offen offset:2048 lds
    buffer_load_dwordx4 v3, s[4:7], s51 offen offset:3072 lds
    s_add_u32 s60, s51, 4096
    s_add_u32 m0, s53, 122880
    s_nop 0
    buffer_load_dwordx4 v3, s[4:7], s60 offen lds
    s_add_u32 s51, s51, 20480
    s_waitcnt vmcnt(16)
    s_barrier
    v_add_u32 v5, 0, v3
    v_add_u32 v6, 1024, v4
    ds_read_b128 v[12:15], v5 offset:0
    ds_read_b128 v[16:19], v5 offset:1280
    ds_read_b128 v[20:23], v5 offset:2560
    ds_read_b128 v[24:27], v5 offset:3840
    ds_read_b128 v[28:31], v5 offset:5120
    ds_read_b128 v[32:35], v5 offset:6400
    ds_read_b128 v[36:39], v5 offset:7680
    ds_read_b128 v[40:43], v5 offset:8960
    s_mov_b32 exec_hi, 0
    ds_read_b64 v[44:45], v6 offset:0
    ds_read_b64 v[46:47], v6 offset:1280
    ds_read_b64 v[48:49], v6 offset:2560
    ds_read_b64 v[50:51], v6 offset:3840
    ds_read_b64 v[52:53], v6 offset:5120
    ds_read_b64 v[54:55], v6 offset:6400
    ds_read_b64 v[56:57], v6 offset:7680
    ds_read_b64 v[58:59], v6 offset:8960
    s_mov_b32 exec_hi, -1
    s_waitcnt lgkmcnt(0)
    v_dot2_f32_bf16 v64, v12, v12, 0
    v_dot2_f32_bf16 v65, v16, v16, 0
    v_dot2_f32_bf16 v66, v20, v20, 0
    v_dot2_f32_bf16 v67, v24, v24, 0
    v_dot2_f32_bf16 v68, v28, v28, 0
    v_dot2_f32_bf16 v69, v32, v32, 0
    v_dot2_f32_bf16 v70, v36, v36, 0
    v_dot2_f32_bf16 v71, v40, v40, 0
    v_dot2_f32_bf16 v64, v13, v13, v64
    v_dot2_f32_bf16 v65, v17, v17, v65
    v_dot2_f32_bf16 v66, v21, v21, v66
    v_dot2_f32_bf16 v67, v25, v25, v67
    v_dot2_f32_bf16 v68, v29, v29, v68
    v_dot2_f32_bf16 v69, v33, v33, v69
    v_dot2_f32_bf16 v70, v37, v37, v70
    v_dot2_f32_bf16 v71, v41, v41, v71
    v_dot2_f32_bf16 v64, v14, v14, v64
    v_dot2_f32_bf16 v65, v18, v18, v65
    v_dot2_f32_bf16 v66, v22, v22, v66
    v_dot2_f32_bf16 v67, v26, v26, v67
    v_dot2_f32_bf16 v68, v30, v30, v68
    v_dot2_f32_bf16 v69, v34, v34, v69
    v_dot2_f32_bf16 v70, v38, v38, v70
    v_dot2_f32_bf16 v71, v42, v42, v71
    v_dot2_f32_bf16 v64, v15, v15, v64
    v_dot2_f32_bf16 v65, v19, v19, v65
    v_dot2_f32_bf16 v66, v23, v23, v66
    v_dot2_f32_bf16 v67, v27, v27, v67
    v_dot2_f32_bf16 v68, v31, v31, v68
    v_dot2_f32_bf16 v69, v35, v35, v69
    v_dot2_f32_bf16 v70, v39, v39, v70
    v_dot2_f32_bf16 v71, v43, v43, v71
    v_dot2_f32_bf16 v64, v44, v44, v64
    v_dot2_f32_bf16 v65, v46, v46, v65
    v_dot2_f32_bf16 v66, v48, v48, v66
    v_dot2_f32_bf16 v67, v50, v50, v67
    v_dot2_f32_bf16 v68, v52, v52, v68
    v_dot2_f32_bf16 v69, v54, v54, v69
    v_dot2_f32_bf16 v70, v56, v56, v70
    v_dot2_f32_bf16 v71, v58, v58, v71
    v_dot2_f32_bf16 v64, v45, v45, v64
    v_dot2_f32_bf16 v65, v47, v47, v65
    v_dot2_f32_bf16 v66, v49, v49, v66
    v_dot2_f32_bf16 v67, v51, v51, v67
    v_dot2_f32_bf16 v68, v53, v53, v68
    v_dot2_f32_bf16 v69, v55, v55, v69
    v_dot2_f32_bf16 v70, v57, v57, v70
    v_dot2_f32_bf16 v71, v59, v59, v71
    s_nop 2
    v_max3_f32 v64, v64, v65, v66
    v_max3_f32 v67, v67, v68, v69
    v_max3_f32 v64, v64, v70, v71
    v_max_f32 v64, v64, v67
    s_nop 0
    s_nop 0
    v_max_f32_dpp v64, v64, v64 row_ror:8 row_mask:0xf bank_mask:0xf
    v_max_f32_dpp v62, v62, v62 row_ror:8 row_mask:0xf bank_mask:0xf
    s_nop 0
    v_max_f32_dpp v64, v64, v64 row_ror:4 row_mask:0xf bank_mask:0xf
    v_max_f32_dpp v62, v62, v62 row_ror:4 row_mask:0xf bank_mask:0xf
    s_nop 0
    v_max_f32_dpp v64, v64, v64 row_ror:2 row_mask:0xf bank_mask:0xf
    v_max_f32_dpp v62, v62, v62 row_ror:2 row_mask:0xf bank_mask:0xf
    s_nop 0
    v_max_f32_dpp v64, v64, v64 row_ror:1 row_mask:0xf bank_mask:0xf
    v_max_f32_dpp v62, v62, v62 row_ror:1 row_mask:0xf bank_mask:0xf
    v_mov_b32 v65, v64
    v_mov_b32 v66, v62
    s_nop 0
    v_permlane16_swap_b32 v65, v64
    v_permlane16_swap_b32 v66, v62
    s_nop 0
    v_max_f32 v64, v64, v65
    v_max_f32 v62, v62, v66
    v_mov_b32 v65, v64
    v_mov_b32 v66, v62
    s_nop 0
    v_permlane32_swap_b32 v65, v64
    v_permlane32_swap_b32 v66, v62
    s_nop 0
    v_add_f32 v64, v64, v65
    v_mov_b32 v67, 0x53800000
    v_mul_f32 v64, v64, v66
    v_cmp_ge_f32 s[20:21], v67, v62
    v_cmp_ge_f32 vcc, 0x455a7255, v64
    s_nop 3
    s_and_b64 s[20:21], s[20:21], vcc
    s_cbranch_scc0 K2_FALLBACK
    s_waitcnt vmcnt(12)
K2_JOIN:
    v_mfma_f32_32x32x16_bf16 v[60:75], v[92:95], v[12:15], 0
    v_mfma_f32_32x32x8_bf16 v[60:75], v[96:97], v[44:45], v[60:75]
    s_nop 11
    v_exp_f32 v60, v60
    v_exp_f32 v61, v61
    v_smfmac_f32_32x32x32_bf16 a[112:127], v[116:119], v[84:91], v2
    v_exp_f32 v62, v62
    v_exp_f32 v63, v63
    s_add_u32 s11, s11, 3584
    v_exp_f32 v64, v64
    v_mfma_f32_32x32x16_bf16 v[76:91], v[92:95], v[16:19], 0
    buffer_load_dwordx4 v[98:101], v3, s[4:7], s11 offen
    v_exp_f32 v65, v65
    v_exp_f32 v66, v66
    v_exp_f32 v67, v67
    buffer_load_dwordx2 v[102:103], v4, s[4:7], s11 offen offset:1024
    v_mfma_f32_32x32x8_bf16 v[76:91], v[96:97], v[46:47], v[76:91]
    v_exp_f32 v68, v68
    v_exp_f32 v69, v69
    v_exp_f32 v70, v70
    v_exp_f32 v71, v71
    v_exp_f32 v72, v72
    v_exp_f32 v73, v73
    v_smfmac_f32_32x32x32_bf16 a[0:15], v[104:107], v[60:67], v2
    v_exp_f32 v74, v74
    v_exp_f32 v75, v75
    v_exp_f32 v76, v76
    v_exp_f32 v77, v77
    v_smfmac_f32_32x32x32_bf16 a[0:15], v[108:111], v[68:75], v2
    v_exp_f32 v78, v78
    v_exp_f32 v79, v79
    buffer_load_dwordx4 v[112:115], v3, s[4:7], s11 offen offset:1536
    v_exp_f32 v80, v80
    v_mfma_f32_32x32x16_bf16 v[60:75], v[92:95], v[20:23], 0
    buffer_load_dwordx4 v[116:119], v3, s[4:7], s11 offen offset:2560
    v_exp_f32 v81, v81
    v_exp_f32 v82, v82
    v_exp_f32 v83, v83
    v_mfma_f32_32x32x8_bf16 v[60:75], v[96:97], v[48:49], v[60:75]
    v_exp_f32 v84, v84
    v_exp_f32 v85, v85
    v_exp_f32 v86, v86
    v_exp_f32 v87, v87
    v_exp_f32 v88, v88
    v_exp_f32 v89, v89
    v_smfmac_f32_32x32x32_bf16 a[16:31], v[104:107], v[76:83], v2
    v_exp_f32 v90, v90
    v_exp_f32 v91, v91
    v_exp_f32 v60, v60
    v_exp_f32 v61, v61
    v_smfmac_f32_32x32x32_bf16 a[16:31], v[108:111], v[84:91], v2
    v_exp_f32 v62, v62
    v_exp_f32 v63, v63
    buffer_load_dwordx4 v[128:131], v3, s[4:7], s52 offen offset:0
    v_exp_f32 v64, v64
    v_mfma_f32_32x32x16_bf16 v[76:91], v[92:95], v[24:27], 0
    v_exp_f32 v65, v65
    v_exp_f32 v66, v66
    v_exp_f32 v67, v67
    v_mfma_f32_32x32x8_bf16 v[76:91], v[96:97], v[50:51], v[76:91]
    v_exp_f32 v68, v68
    v_exp_f32 v69, v69
    v_exp_f32 v70, v70
    v_exp_f32 v71, v71
    v_exp_f32 v72, v72
    v_exp_f32 v73, v73
    v_smfmac_f32_32x32x32_bf16 a[32:47], v[104:107], v[60:67], v2
    v_exp_f32 v74, v74
    v_exp_f32 v75, v75
    v_exp_f32 v76, v76
    v_exp_f32 v77, v77
    v_smfmac_f32_32x32x32_bf16 a[32:47], v[108:111], v[68:75], v2
    v_exp_f32 v78, v78
    v_exp_f32 v79, v79
    buffer_load_dwordx4 v[132:135], v3, s[4:7], s52 offen offset:1024
    v_exp_f32 v80, v80
    v_mfma_f32_32x32x16_bf16 v[60:75], v[92:95], v[28:31], 0
    v_exp_f32 v81, v81
    v_exp_f32 v82, v82
    v_exp_f32 v83, v83
    v_mfma_f32_32x32x8_bf16 v[60:75], v[96:97], v[52:53], v[60:75]
    v_exp_f32 v84, v84
    v_exp_f32 v85, v85
    v_exp_f32 v86, v86
    v_exp_f32 v87, v87
    v_exp_f32 v88, v88
    v_exp_f32 v89, v89
    v_smfmac_f32_32x32x32_bf16 a[48:63], v[104:107], v[76:83], v2
    v_exp_f32 v90, v90
    v_exp_f32 v91, v91
    v_exp_f32 v60, v60
    v_exp_f32 v61, v61
    v_smfmac_f32_32x32x32_bf16 a[48:63], v[108:111], v[84:91], v2
    v_exp_f32 v62, v62
    v_exp_f32 v63, v63
    buffer_load_dwordx4 v[136:139], v3, s[4:7], s54 offen offset:0
    v_exp_f32 v64, v64
    v_mfma_f32_32x32x16_bf16 v[76:91], v[92:95], v[32:35], 0
    v_exp_f32 v65, v65
    v_exp_f32 v66, v66
    v_exp_f32 v67, v67
    v_mfma_f32_32x32x8_bf16 v[76:91], v[96:97], v[54:55], v[76:91]
    v_exp_f32 v68, v68
    v_exp_f32 v69, v69
    v_exp_f32 v70, v70
    v_exp_f32 v71, v71
    v_exp_f32 v72, v72
    v_exp_f32 v73, v73
    v_smfmac_f32_32x32x32_bf16 a[64:79], v[104:107], v[60:67], v2
    v_exp_f32 v74, v74
    v_exp_f32 v75, v75
    v_exp_f32 v76, v76
    v_exp_f32 v77, v77
    v_smfmac_f32_32x32x32_bf16 a[64:79], v[108:111], v[68:75], v2
    v_exp_f32 v78, v78
    v_exp_f32 v79, v79
    buffer_load_dwordx4 v[140:143], v3, s[4:7], s54 offen offset:1024
    v_exp_f32 v80, v80
    v_mfma_f32_32x32x16_bf16 v[60:75], v[92:95], v[36:39], 0
    v_exp_f32 v81, v81
    v_exp_f32 v82, v82
    v_exp_f32 v83, v83
    v_mfma_f32_32x32x8_bf16 v[60:75], v[96:97], v[56:57], v[60:75]
    v_exp_f32 v84, v84
    v_exp_f32 v85, v85
    v_exp_f32 v86, v86
    v_exp_f32 v87, v87
    v_exp_f32 v88, v88
    v_exp_f32 v89, v89
    v_smfmac_f32_32x32x32_bf16 a[80:95], v[104:107], v[76:83], v2
    v_exp_f32 v90, v90
    v_exp_f32 v91, v91
    v_exp_f32 v60, v60
    v_exp_f32 v61, v61
    v_smfmac_f32_32x32x32_bf16 a[80:95], v[108:111], v[84:91], v2
    v_exp_f32 v62, v62
    v_exp_f32 v63, v63
    buffer_load_dword v127, v10, s[4:7], s56 offen
    v_exp_f32 v64, v64
    v_mfma_f32_32x32x16_bf16 v[76:91], v[92:95], v[40:43], 0
    v_exp_f32 v65, v65
    v_exp_f32 v66, v66
    v_exp_f32 v67, v67
    v_mfma_f32_32x32x8_bf16 v[76:91], v[96:97], v[58:59], v[76:91]
    v_exp_f32 v68, v68
    v_exp_f32 v69, v69
    v_exp_f32 v70, v70
    v_exp_f32 v71, v71
    v_exp_f32 v72, v72
    v_exp_f32 v73, v73
    v_smfmac_f32_32x32x32_bf16 a[96:111], v[104:107], v[60:67], v2
    v_exp_f32 v74, v74
    v_exp_f32 v75, v75
    s_waitcnt vmcnt(5)
    v_exp_f32 v76, v76
    v_exp_f32 v77, v77
    v_smfmac_f32_32x32x32_bf16 a[96:111], v[108:111], v[68:75], v2
    v_exp_f32 v78, v78
    v_exp_f32 v79, v79
    v_exp_f32 v80, v80
    v_mfma_f32_32x32x16_bf16 v[60:75], v[98:101], v[12:15], 0
    v_exp_f32 v81, v81
    v_exp_f32 v82, v82
    v_exp_f32 v83, v83
    v_mfma_f32_32x32x8_bf16 v[60:75], v[102:103], v[44:45], v[60:75]
    v_exp_f32 v84, v84
    v_exp_f32 v85, v85
    v_exp_f32 v86, v86
    v_exp_f32 v87, v87
    v_exp_f32 v88, v88
    v_exp_f32 v89, v89
    v_smfmac_f32_32x32x32_bf16 a[112:127], v[104:107], v[76:83], v2
    v_exp_f32 v90, v90
    v_exp_f32 v91, v91
    v_exp_f32 v60, v60
    v_exp_f32 v61, v61
    v_smfmac_f32_32x32x32_bf16 a[112:127], v[108:111], v[84:91], v2
    v_exp_f32 v62, v62
    v_exp_f32 v63, v63
    s_add_u32 s11, s11, 3584
    v_exp_f32 v64, v64
    v_mfma_f32_32x32x16_bf16 v[76:91], v[98:101], v[16:19], 0
    buffer_load_dwordx4 v[92:95], v3, s[4:7], s11 offen
    v_exp_f32 v65, v65
    v_exp_f32 v66, v66
    v_exp_f32 v67, v67
    buffer_load_dwordx2 v[96:97], v4, s[4:7], s11 offen offset:1024
    v_mfma_f32_32x32x8_bf16 v[76:91], v[102:103], v[46:47], v[76:91]
    v_exp_f32 v68, v68
    v_exp_f32 v69, v69
    v_exp_f32 v70, v70
    v_exp_f32 v71, v71
    v_exp_f32 v72, v72
    v_exp_f32 v73, v73
    v_smfmac_f32_32x32x32_bf16 a[0:15], v[112:115], v[60:67], v2
    v_exp_f32 v74, v74
    v_exp_f32 v75, v75
    v_exp_f32 v76, v76
    v_exp_f32 v77, v77
    v_smfmac_f32_32x32x32_bf16 a[0:15], v[116:119], v[68:75], v2
    v_exp_f32 v78, v78
    v_exp_f32 v79, v79
    buffer_load_dwordx4 v[104:107], v3, s[4:7], s11 offen offset:1536
    v_exp_f32 v80, v80
    v_mfma_f32_32x32x16_bf16 v[60:75], v[98:101], v[20:23], 0
    buffer_load_dwordx4 v[108:111], v3, s[4:7], s11 offen offset:2560
    v_exp_f32 v81, v81
    v_exp_f32 v82, v82
    v_exp_f32 v83, v83
    v_mfma_f32_32x32x8_bf16 v[60:75], v[102:103], v[48:49], v[60:75]
    v_exp_f32 v84, v84
    v_exp_f32 v85, v85
    v_exp_f32 v86, v86
    v_exp_f32 v87, v87
    v_exp_f32 v88, v88
    v_exp_f32 v89, v89
    v_smfmac_f32_32x32x32_bf16 a[16:31], v[112:115], v[76:83], v2
    v_exp_f32 v90, v90
    v_exp_f32 v91, v91
    v_exp_f32 v60, v60
    v_exp_f32 v61, v61
    v_smfmac_f32_32x32x32_bf16 a[16:31], v[116:119], v[84:91], v2
    v_exp_f32 v62, v62
    v_exp_f32 v63, v63
    s_add_u32 s52, s52, 4096
    s_add_u32 s54, s54, 4096
    buffer_load_dwordx4 v[144:147], v3, s[4:7], s52 offen offset:0
    v_exp_f32 v64, v64
    v_mfma_f32_32x32x16_bf16 v[76:91], v[98:101], v[24:27], 0
    v_exp_f32 v65, v65
    v_exp_f32 v66, v66
    v_exp_f32 v67, v67
    v_mfma_f32_32x32x8_bf16 v[76:91], v[102:103], v[50:51], v[76:91]
    v_exp_f32 v68, v68
    v_exp_f32 v69, v69
    v_exp_f32 v70, v70
    v_exp_f32 v71, v71
    v_exp_f32 v72, v72
    v_exp_f32 v73, v73
    v_smfmac_f32_32x32x32_bf16 a[32:47], v[112:115], v[60:67], v2
    v_exp_f32 v74, v74
    v_exp_f32 v75, v75
    v_exp_f32 v76, v76
    v_exp_f32 v77, v77
    v_smfmac_f32_32x32x32_bf16 a[32:47], v[116:119], v[68:75], v2
    v_exp_f32 v78, v78
    v_exp_f32 v79, v79
    buffer_load_dwordx4 v[148:151], v3, s[4:7], s52 offen offset:1024
    v_exp_f32 v80, v80
    v_mfma_f32_32x32x16_bf16 v[60:75], v[98:101], v[28:31], 0
    v_exp_f32 v81, v81
    v_exp_f32 v82, v82
    v_exp_f32 v83, v83
    v_mfma_f32_32x32x8_bf16 v[60:75], v[102:103], v[52:53], v[60:75]
    v_exp_f32 v84, v84
    v_exp_f32 v85, v85
    v_exp_f32 v86, v86
    v_exp_f32 v87, v87
    v_exp_f32 v88, v88
    v_exp_f32 v89, v89
    v_smfmac_f32_32x32x32_bf16 a[48:63], v[112:115], v[76:83], v2
    v_exp_f32 v90, v90
    v_exp_f32 v91, v91
    v_exp_f32 v60, v60
    v_exp_f32 v61, v61
    v_smfmac_f32_32x32x32_bf16 a[48:63], v[116:119], v[84:91], v2
    v_exp_f32 v62, v62
    v_exp_f32 v63, v63
    buffer_load_dwordx4 v[152:155], v3, s[4:7], s54 offen offset:0
    v_exp_f32 v64, v64
    v_mfma_f32_32x32x16_bf16 v[76:91], v[98:101], v[32:35], 0
    v_exp_f32 v65, v65
    v_exp_f32 v66, v66
    v_exp_f32 v67, v67
    v_mfma_f32_32x32x8_bf16 v[76:91], v[102:103], v[54:55], v[76:91]
    v_exp_f32 v68, v68
    v_exp_f32 v69, v69
    v_exp_f32 v70, v70
    v_exp_f32 v71, v71
    v_exp_f32 v72, v72
    v_exp_f32 v73, v73
    v_smfmac_f32_32x32x32_bf16 a[64:79], v[112:115], v[60:67], v2
    v_exp_f32 v74, v74
    v_exp_f32 v75, v75
    v_exp_f32 v76, v76
    v_exp_f32 v77, v77
    v_smfmac_f32_32x32x32_bf16 a[64:79], v[116:119], v[68:75], v2
    v_exp_f32 v78, v78
    v_exp_f32 v79, v79
    buffer_load_dwordx4 v[156:159], v3, s[4:7], s54 offen offset:1024
    v_exp_f32 v80, v80
    v_mfma_f32_32x32x16_bf16 v[60:75], v[98:101], v[36:39], 0
    v_exp_f32 v81, v81
    v_exp_f32 v82, v82
    v_exp_f32 v83, v83
    v_mfma_f32_32x32x8_bf16 v[60:75], v[102:103], v[56:57], v[60:75]
    v_exp_f32 v84, v84
    v_exp_f32 v85, v85
    v_exp_f32 v86, v86
    v_exp_f32 v87, v87
    v_exp_f32 v88, v88
    v_exp_f32 v89, v89
    v_smfmac_f32_32x32x32_bf16 a[80:95], v[112:115], v[76:83], v2
    v_exp_f32 v90, v90
    v_exp_f32 v91, v91
    v_exp_f32 v60, v60
    v_exp_f32 v61, v61
    v_smfmac_f32_32x32x32_bf16 a[80:95], v[116:119], v[84:91], v2
    v_exp_f32 v62, v62
    v_exp_f32 v63, v63
    buffer_load_dword v127, v10, s[4:7], s57 offen
    v_exp_f32 v64, v64
    v_mfma_f32_32x32x16_bf16 v[76:91], v[98:101], v[40:43], 0
    v_exp_f32 v65, v65
    v_exp_f32 v66, v66
    v_exp_f32 v67, v67
    v_mfma_f32_32x32x8_bf16 v[76:91], v[102:103], v[58:59], v[76:91]
    v_exp_f32 v68, v68
    v_exp_f32 v69, v69
    v_exp_f32 v70, v70
    v_exp_f32 v71, v71
    v_exp_f32 v72, v72
    v_exp_f32 v73, v73
    v_smfmac_f32_32x32x32_bf16 a[96:111], v[112:115], v[60:67], v2
    v_exp_f32 v74, v74
    v_exp_f32 v75, v75
    s_waitcnt vmcnt(5)
    v_exp_f32 v76, v76
    v_exp_f32 v77, v77
    v_smfmac_f32_32x32x32_bf16 a[96:111], v[116:119], v[68:75], v2
    v_exp_f32 v78, v78
    v_exp_f32 v79, v79
    v_exp_f32 v80, v80
    v_mfma_f32_32x32x16_bf16 v[60:75], v[92:95], v[12:15], 0
    v_exp_f32 v81, v81
    v_exp_f32 v82, v82
    v_exp_f32 v83, v83
    v_mfma_f32_32x32x8_bf16 v[60:75], v[96:97], v[44:45], v[60:75]
    v_exp_f32 v84, v84
    v_exp_f32 v85, v85
    v_exp_f32 v86, v86
    v_exp_f32 v87, v87
    v_exp_f32 v88, v88
    v_exp_f32 v89, v89
    v_smfmac_f32_32x32x32_bf16 a[112:127], v[112:115], v[76:83], v2
    v_exp_f32 v90, v90
    v_exp_f32 v91, v91
    v_exp_f32 v60, v60
    v_exp_f32 v61, v61
    v_smfmac_f32_32x32x32_bf16 a[112:127], v[116:119], v[84:91], v2
    v_exp_f32 v62, v62
    v_exp_f32 v63, v63
    s_add_u32 s11, s11, 3584
    v_exp_f32 v64, v64
    v_mfma_f32_32x32x16_bf16 v[76:91], v[92:95], v[16:19], 0
    buffer_load_dwordx4 v[98:101], v3, s[4:7], s11 offen
    v_exp_f32 v65, v65
    v_exp_f32 v66, v66
    v_exp_f32 v67, v67
    buffer_load_dwordx2 v[102:103], v4, s[4:7], s11 offen offset:1024
    v_mfma_f32_32x32x8_bf16 v[76:91], v[96:97], v[46:47], v[76:91]
    v_exp_f32 v68, v68
    v_exp_f32 v69, v69
    v_exp_f32 v70, v70
    v_exp_f32 v71, v71
    v_exp_f32 v72, v72
    v_exp_f32 v73, v73
    v_smfmac_f32_32x32x32_bf16 a[0:15], v[104:107], v[60:67], v2
    v_exp_f32 v74, v74
    v_exp_f32 v75, v75
    v_exp_f32 v76, v76
    v_exp_f32 v77, v77
    v_smfmac_f32_32x32x32_bf16 a[0:15], v[108:111], v[68:75], v2
    v_exp_f32 v78, v78
    v_exp_f32 v79, v79
    buffer_load_dwordx4 v[112:115], v3, s[4:7], s11 offen offset:1536
    v_exp_f32 v80, v80
    v_mfma_f32_32x32x16_bf16 v[60:75], v[92:95], v[20:23], 0
    buffer_load_dwordx4 v[116:119], v3, s[4:7], s11 offen offset:2560
    v_exp_f32 v81, v81
    v_exp_f32 v82, v82
    v_exp_f32 v83, v83
    v_mfma_f32_32x32x8_bf16 v[60:75], v[96:97], v[48:49], v[60:75]
    v_exp_f32 v84, v84
    v_exp_f32 v85, v85
    v_exp_f32 v86, v86
    v_exp_f32 v87, v87
    v_exp_f32 v88, v88
    v_exp_f32 v89, v89
    v_smfmac_f32_32x32x32_bf16 a[16:31], v[104:107], v[76:83], v2
    v_exp_f32 v90, v90
    v_exp_f32 v91, v91
    v_exp_f32 v60, v60
    v_exp_f32 v61, v61
    v_smfmac_f32_32x32x32_bf16 a[16:31], v[108:111], v[84:91], v2
    v_exp_f32 v62, v62
    v_exp_f32 v63, v63
    s_add_u32 s52, s52, 4096
    s_add_u32 s54, s54, 4096
    buffer_load_dwordx4 v[160:163], v3, s[4:7], s52 offen offset:0
    v_exp_f32 v64, v64
    v_mfma_f32_32x32x16_bf16 v[76:91], v[92:95], v[24:27], 0
    v_exp_f32 v65, v65
    v_exp_f32 v66, v66
    v_exp_f32 v67, v67
    v_mfma_f32_32x32x8_bf16 v[76:91], v[96:97], v[50:51], v[76:91]
    v_exp_f32 v68, v68
    v_exp_f32 v69, v69
    v_exp_f32 v70, v70
    v_exp_f32 v71, v71
    v_exp_f32 v72, v72
    v_exp_f32 v73, v73
    v_smfmac_f32_32x32x32_bf16 a[32:47], v[104:107], v[60:67], v2
    v_exp_f32 v74, v74
    v_exp_f32 v75, v75
    v_exp_f32 v76, v76
    v_exp_f32 v77, v77
    v_smfmac_f32_32x32x32_bf16 a[32:47], v[108:111], v[68:75], v2
    v_exp_f32 v78, v78
    v_exp_f32 v79, v79
    buffer_load_dwordx4 v[164:167], v3, s[4:7], s52 offen offset:1024
    v_exp_f32 v80, v80
    v_mfma_f32_32x32x16_bf16 v[60:75], v[92:95], v[28:31], 0
    v_exp_f32 v81, v81
    v_exp_f32 v82, v82
    v_exp_f32 v83, v83
    v_mfma_f32_32x32x8_bf16 v[60:75], v[96:97], v[52:53], v[60:75]
    v_exp_f32 v84, v84
    v_exp_f32 v85, v85
    v_exp_f32 v86, v86
    v_exp_f32 v87, v87
    v_exp_f32 v88, v88
    v_exp_f32 v89, v89
    v_smfmac_f32_32x32x32_bf16 a[48:63], v[104:107], v[76:83], v2
    v_exp_f32 v90, v90
    v_exp_f32 v91, v91
    v_exp_f32 v60, v60
    v_exp_f32 v61, v61
    v_smfmac_f32_32x32x32_bf16 a[48:63], v[108:111], v[84:91], v2
    v_exp_f32 v62, v62
    v_exp_f32 v63, v63
    buffer_load_dwordx4 v[168:171], v3, s[4:7], s54 offen offset:0
    v_exp_f32 v64, v64
    v_mfma_f32_32x32x16_bf16 v[76:91], v[92:95], v[32:35], 0
    v_exp_f32 v65, v65
    v_exp_f32 v66, v66
    v_exp_f32 v67, v67
    v_mfma_f32_32x32x8_bf16 v[76:91], v[96:97], v[54:55], v[76:91]
    v_exp_f32 v68, v68
    v_exp_f32 v69, v69
    v_exp_f32 v70, v70
    v_exp_f32 v71, v71
    v_exp_f32 v72, v72
    v_exp_f32 v73, v73
    v_smfmac_f32_32x32x32_bf16 a[64:79], v[104:107], v[60:67], v2
    v_exp_f32 v74, v74
    v_exp_f32 v75, v75
    v_exp_f32 v76, v76
    v_exp_f32 v77, v77
    v_smfmac_f32_32x32x32_bf16 a[64:79], v[108:111], v[68:75], v2
    v_exp_f32 v78, v78
    v_exp_f32 v79, v79
    buffer_load_dwordx4 v[172:175], v3, s[4:7], s54 offen offset:1024
    v_exp_f32 v80, v80
    v_mfma_f32_32x32x16_bf16 v[60:75], v[92:95], v[36:39], 0
    v_exp_f32 v81, v81
    v_exp_f32 v82, v82
    v_exp_f32 v83, v83
    v_mfma_f32_32x32x8_bf16 v[60:75], v[96:97], v[56:57], v[60:75]
    v_exp_f32 v84, v84
    v_exp_f32 v85, v85
    v_exp_f32 v86, v86
    v_exp_f32 v87, v87
    v_exp_f32 v88, v88
    v_exp_f32 v89, v89
    v_smfmac_f32_32x32x32_bf16 a[80:95], v[104:107], v[76:83], v2
    v_exp_f32 v90, v90
    v_exp_f32 v91, v91
    v_exp_f32 v60, v60
    v_exp_f32 v61, v61
    v_smfmac_f32_32x32x32_bf16 a[80:95], v[108:111], v[84:91], v2
    v_exp_f32 v62, v62
    v_exp_f32 v63, v63
    v_exp_f32 v64, v64
    v_mfma_f32_32x32x16_bf16 v[76:91], v[92:95], v[40:43], 0
    v_exp_f32 v65, v65
    v_exp_f32 v66, v66
    v_exp_f32 v67, v67
    v_mfma_f32_32x32x8_bf16 v[76:91], v[96:97], v[58:59], v[76:91]
    v_exp_f32 v68, v68
    v_exp_f32 v69, v69
    v_exp_f32 v70, v70
    v_exp_f32 v71, v71
    v_exp_f32 v72, v72
    v_exp_f32 v73, v73
    v_smfmac_f32_32x32x32_bf16 a[96:111], v[104:107], v[60:67], v2
    v_exp_f32 v74, v74
    v_exp_f32 v75, v75
    s_waitcnt vmcnt(4)
    v_exp_f32 v76, v76
    v_exp_f32 v77, v77
    v_smfmac_f32_32x32x32_bf16 a[96:111], v[108:111], v[68:75], v2
    v_exp_f32 v78, v78
    v_exp_f32 v79, v79
    v_exp_f32 v80, v80
    v_mfma_f32_32x32x16_bf16 v[60:75], v[98:101], v[12:15], 0
    v_exp_f32 v81, v81
    v_exp_f32 v82, v82
    v_exp_f32 v83, v83
    v_mfma_f32_32x32x8_bf16 v[60:75], v[102:103], v[44:45], v[60:75]
    v_exp_f32 v84, v84
    v_exp_f32 v85, v85
    v_exp_f32 v86, v86
    v_exp_f32 v87, v87
    v_exp_f32 v88, v88
    v_exp_f32 v89, v89
    v_smfmac_f32_32x32x32_bf16 a[112:127], v[104:107], v[76:83], v2
    v_exp_f32 v90, v90
    v_exp_f32 v91, v91
    v_exp_f32 v60, v60
    v_exp_f32 v61, v61
    v_smfmac_f32_32x32x32_bf16 a[112:127], v[108:111], v[84:91], v2
    v_exp_f32 v62, v62
    v_exp_f32 v63, v63
    s_add_u32 s11, s11, 3584
    v_exp_f32 v64, v64
    v_mfma_f32_32x32x16_bf16 v[76:91], v[98:101], v[16:19], 0
    buffer_load_dwordx4 v[92:95], v3, s[4:7], s11 offen
    v_exp_f32 v65, v65
    v_exp_f32 v66, v66
    v_exp_f32 v67, v67
    buffer_load_dwordx2 v[96:97], v4, s[4:7], s11 offen offset:1024
    v_mfma_f32_32x32x8_bf16 v[76:91], v[102:103], v[46:47], v[76:91]
    v_exp_f32 v68, v68
    v_exp_f32 v69, v69
    v_exp_f32 v70, v70
    v_exp_f32 v71, v71
    v_exp_f32 v72, v72
    v_exp_f32 v73, v73
    v_smfmac_f32_32x32x32_bf16 a[0:15], v[112:115], v[60:67], v2
    v_exp_f32 v74, v74
    v_exp_f32 v75, v75
    v_exp_f32 v76, v76
    v_exp_f32 v77, v77
    v_smfmac_f32_32x32x32_bf16 a[0:15], v[116:119], v[68:75], v2
    v_exp_f32 v78, v78
    v_exp_f32 v79, v79
    buffer_load_dwordx4 v[104:107], v3, s[4:7], s11 offen offset:1536
    v_exp_f32 v80, v80
    v_mfma_f32_32x32x16_bf16 v[60:75], v[98:101], v[20:23], 0
    buffer_load_dwordx4 v[108:111], v3, s[4:7], s11 offen offset:2560
    v_exp_f32 v81, v81
    v_exp_f32 v82, v82
    v_exp_f32 v83, v83
    v_mfma_f32_32x32x8_bf16 v[60:75], v[102:103], v[48:49], v[60:75]
    v_exp_f32 v84, v84
    v_exp_f32 v85, v85
    v_exp_f32 v86, v86
    v_exp_f32 v87, v87
    v_exp_f32 v88, v88
    v_exp_f32 v89, v89
    v_smfmac_f32_32x32x32_bf16 a[16:31], v[112:115], v[76:83], v2
    v_exp_f32 v90, v90
    v_exp_f32 v91, v91
    v_exp_f32 v60, v60
    v_exp_f32 v61, v61
    v_smfmac_f32_32x32x32_bf16 a[16:31], v[116:119], v[84:91], v2
    v_exp_f32 v62, v62
    v_exp_f32 v63, v63
    s_add_u32 s52, s52, 4096
    s_add_u32 s54, s54, 4096
    buffer_load_dwordx4 v[176:179], v3, s[4:7], s52 offen offset:0
    v_exp_f32 v64, v64
    v_mfma_f32_32x32x16_bf16 v[76:91], v[98:101], v[24:27], 0
    v_exp_f32 v65, v65
    v_exp_f32 v66, v66
    v_exp_f32 v67, v67
    v_mfma_f32_32x32x8_bf16 v[76:91], v[102:103], v[50:51], v[76:91]
    v_exp_f32 v68, v68
    v_exp_f32 v69, v69
    v_exp_f32 v70, v70
    v_exp_f32 v71, v71
    v_exp_f32 v72, v72
    v_exp_f32 v73, v73
    v_smfmac_f32_32x32x32_bf16 a[32:47], v[112:115], v[60:67], v2
    v_exp_f32 v74, v74
    v_exp_f32 v75, v75
    v_exp_f32 v76, v76
    v_exp_f32 v77, v77
    v_smfmac_f32_32x32x32_bf16 a[32:47], v[116:119], v[68:75], v2
    v_exp_f32 v78, v78
    v_exp_f32 v79, v79
    buffer_load_dwordx4 v[180:183], v3, s[4:7], s52 offen offset:1024
    v_exp_f32 v80, v80
    v_mfma_f32_32x32x16_bf16 v[60:75], v[98:101], v[28:31], 0
    v_exp_f32 v81, v81
    v_exp_f32 v82, v82
    v_exp_f32 v83, v83
    v_mfma_f32_32x32x8_bf16 v[60:75], v[102:103], v[52:53], v[60:75]
    v_exp_f32 v84, v84
    v_exp_f32 v85, v85
    v_exp_f32 v86, v86
    v_exp_f32 v87, v87
    v_exp_f32 v88, v88
    v_exp_f32 v89, v89
    v_smfmac_f32_32x32x32_bf16 a[48:63], v[112:115], v[76:83], v2
    v_exp_f32 v90, v90
    v_exp_f32 v91, v91
    v_exp_f32 v60, v60
    v_exp_f32 v61, v61
    v_smfmac_f32_32x32x32_bf16 a[48:63], v[116:119], v[84:91], v2
    v_exp_f32 v62, v62
    v_exp_f32 v63, v63
    buffer_load_dwordx4 v[184:187], v3, s[4:7], s54 offen offset:0
    v_exp_f32 v64, v64
    v_mfma_f32_32x32x16_bf16 v[76:91], v[98:101], v[32:35], 0
    v_exp_f32 v65, v65
    v_exp_f32 v66, v66
    v_exp_f32 v67, v67
    v_mfma_f32_32x32x8_bf16 v[76:91], v[102:103], v[54:55], v[76:91]
    v_exp_f32 v68, v68
    v_exp_f32 v69, v69
    v_exp_f32 v70, v70
    v_exp_f32 v71, v71
    v_exp_f32 v72, v72
    v_exp_f32 v73, v73
    v_smfmac_f32_32x32x32_bf16 a[64:79], v[112:115], v[60:67], v2
    v_exp_f32 v74, v74
    v_exp_f32 v75, v75
    v_exp_f32 v76, v76
    v_exp_f32 v77, v77
    v_smfmac_f32_32x32x32_bf16 a[64:79], v[116:119], v[68:75], v2
    v_exp_f32 v78, v78
    v_exp_f32 v79, v79
    buffer_load_dwordx4 v[188:191], v3, s[4:7], s54 offen offset:1024
    v_exp_f32 v80, v80
    v_mfma_f32_32x32x16_bf16 v[60:75], v[98:101], v[36:39], 0
    v_exp_f32 v81, v81
    v_exp_f32 v82, v82
    v_exp_f32 v83, v83
    v_mfma_f32_32x32x8_bf16 v[60:75], v[102:103], v[56:57], v[60:75]
    v_exp_f32 v84, v84
    v_exp_f32 v85, v85
    v_exp_f32 v86, v86
    v_exp_f32 v87, v87
    v_exp_f32 v88, v88
    v_exp_f32 v89, v89
    v_smfmac_f32_32x32x32_bf16 a[80:95], v[112:115], v[76:83], v2
    v_exp_f32 v90, v90
    v_exp_f32 v91, v91
    v_exp_f32 v60, v60
    v_exp_f32 v61, v61
    v_smfmac_f32_32x32x32_bf16 a[80:95], v[116:119], v[84:91], v2
    v_exp_f32 v62, v62
    v_exp_f32 v63, v63
    v_exp_f32 v64, v64
    v_mfma_f32_32x32x16_bf16 v[76:91], v[98:101], v[40:43], 0
    v_exp_f32 v65, v65
    v_exp_f32 v66, v66
    v_exp_f32 v67, v67
    v_mfma_f32_32x32x8_bf16 v[76:91], v[102:103], v[58:59], v[76:91]
    v_exp_f32 v68, v68
    v_exp_f32 v69, v69
    v_exp_f32 v70, v70
    v_exp_f32 v71, v71
    v_exp_f32 v72, v72
    v_exp_f32 v73, v73
    v_smfmac_f32_32x32x32_bf16 a[96:111], v[112:115], v[60:67], v2
    v_exp_f32 v74, v74
    v_exp_f32 v75, v75
    s_waitcnt vmcnt(4)
    v_exp_f32 v76, v76
    v_exp_f32 v77, v77
    v_smfmac_f32_32x32x32_bf16 a[96:111], v[116:119], v[68:75], v2
    v_exp_f32 v78, v78
    v_exp_f32 v79, v79
    v_exp_f32 v80, v80
    v_mfma_f32_32x32x16_bf16 v[60:75], v[92:95], v[12:15], 0
    v_exp_f32 v81, v81
    v_exp_f32 v82, v82
    v_exp_f32 v83, v83
    v_mfma_f32_32x32x8_bf16 v[60:75], v[96:97], v[44:45], v[60:75]
    v_exp_f32 v84, v84
    v_exp_f32 v85, v85
    v_exp_f32 v86, v86
    v_exp_f32 v87, v87
    v_exp_f32 v88, v88
    v_exp_f32 v89, v89
    v_smfmac_f32_32x32x32_bf16 a[112:127], v[112:115], v[76:83], v2
    v_exp_f32 v90, v90
    v_exp_f32 v91, v91
    v_exp_f32 v60, v60
    v_exp_f32 v61, v61
    v_smfmac_f32_32x32x32_bf16 a[112:127], v[116:119], v[84:91], v2
    v_exp_f32 v62, v62
    v_exp_f32 v63, v63
    s_add_u32 s11, s11, 3584
    v_exp_f32 v64, v64
    v_mfma_f32_32x32x16_bf16 v[76:91], v[92:95], v[16:19], 0
    buffer_load_dwordx4 v[98:101], v3, s[4:7], s11 offen
    v_exp_f32 v65, v65
    v_exp_f32 v66, v66
    v_exp_f32 v67, v67
    buffer_load_dwordx2 v[102:103], v4, s[4:7], s11 offen offset:1024
    v_mfma_f32_32x32x8_bf16 v[76:91], v[96:97], v[46:47], v[76:91]
    v_exp_f32 v68, v68
    v_exp_f32 v69, v69
    v_exp_f32 v70, v70
    v_exp_f32 v71, v71
    v_exp_f32 v72, v72
    v_exp_f32 v73, v73
    v_smfmac_f32_32x32x32_bf16 a[0:15], v[104:107], v[60:67], v2
    v_exp_f32 v74, v74
    v_exp_f32 v75, v75
    v_exp_f32 v76, v76
    v_exp_f32 v77, v77
    v_smfmac_f32_32x32x32_bf16 a[0:15], v[108:111], v[68:75], v2
    v_exp_f32 v78, v78
    v_exp_f32 v79, v79
    buffer_load_dwordx4 v[112:115], v3, s[4:7], s11 offen offset:1536
    v_exp_f32 v80, v80
    v_mfma_f32_32x32x16_bf16 v[60:75], v[92:95], v[20:23], 0
    buffer_load_dwordx4 v[116:119], v3, s[4:7], s11 offen offset:2560
    v_exp_f32 v81, v81
    v_exp_f32 v82, v82
    v_exp_f32 v83, v83
    v_mfma_f32_32x32x8_bf16 v[60:75], v[96:97], v[48:49], v[60:75]
    v_exp_f32 v84, v84
    v_exp_f32 v85, v85
    v_exp_f32 v86, v86
    v_exp_f32 v87, v87
    v_exp_f32 v88, v88
    v_exp_f32 v89, v89
    v_smfmac_f32_32x32x32_bf16 a[16:31], v[104:107], v[76:83], v2
    v_exp_f32 v90, v90
    v_exp_f32 v91, v91
    v_exp_f32 v60, v60
    v_exp_f32 v61, v61
    v_smfmac_f32_32x32x32_bf16 a[16:31], v[108:111], v[84:91], v2
    v_exp_f32 v62, v62
    v_exp_f32 v63, v63
    s_add_u32 s52, s52, 4096
    s_add_u32 s54, s54, 4096
    buffer_load_dwordx4 v[192:195], v3, s[4:7], s52 offen offset:0
    v_exp_f32 v64, v64
    v_mfma_f32_32x32x16_bf16 v[76:91], v[92:95], v[24:27], 0
    v_exp_f32 v65, v65
    v_exp_f32 v66, v66
    v_exp_f32 v67, v67
    v_mfma_f32_32x32x8_bf16 v[76:91], v[96:97], v[50:51], v[76:91]
    v_exp_f32 v68, v68
    v_exp_f32 v69, v69
    v_exp_f32 v70, v70
    v_exp_f32 v71, v71
    v_exp_f32 v72, v72
    v_exp_f32 v73, v73
    v_smfmac_f32_32x32x32_bf16 a[32:47], v[104:107], v[60:67], v2
    v_exp_f32 v74, v74
    v_exp_f32 v75, v75
    v_exp_f32 v76, v76
    v_exp_f32 v77, v77
    v_smfmac_f32_32x32x32_bf16 a[32:47], v[108:111], v[68:75], v2
    v_exp_f32 v78, v78
    v_exp_f32 v79, v79
    buffer_load_dwordx4 v[196:199], v3, s[4:7], s52 offen offset:1024
    v_exp_f32 v80, v80
    v_mfma_f32_32x32x16_bf16 v[60:75], v[92:95], v[28:31], 0
    v_exp_f32 v81, v81
    v_exp_f32 v82, v82
    v_exp_f32 v83, v83
    v_mfma_f32_32x32x8_bf16 v[60:75], v[96:97], v[52:53], v[60:75]
    v_exp_f32 v84, v84
    v_exp_f32 v85, v85
    v_exp_f32 v86, v86
    v_exp_f32 v87, v87
    v_exp_f32 v88, v88
    v_exp_f32 v89, v89
    v_smfmac_f32_32x32x32_bf16 a[48:63], v[104:107], v[76:83], v2
    v_exp_f32 v90, v90
    v_exp_f32 v91, v91
    v_exp_f32 v60, v60
    v_exp_f32 v61, v61
    v_smfmac_f32_32x32x32_bf16 a[48:63], v[108:111], v[84:91], v2
    v_exp_f32 v62, v62
    v_exp_f32 v63, v63
    buffer_load_dwordx4 v[200:203], v3, s[4:7], s54 offen offset:0
    v_exp_f32 v64, v64
    v_mfma_f32_32x32x16_bf16 v[76:91], v[92:95], v[32:35], 0
    v_exp_f32 v65, v65
    v_exp_f32 v66, v66
    v_exp_f32 v67, v67
    v_mfma_f32_32x32x8_bf16 v[76:91], v[96:97], v[54:55], v[76:91]
    v_exp_f32 v68, v68
    v_exp_f32 v69, v69
    v_exp_f32 v70, v70
    v_exp_f32 v71, v71
    v_exp_f32 v72, v72
    v_exp_f32 v73, v73
    v_smfmac_f32_32x32x32_bf16 a[64:79], v[104:107], v[60:67], v2
    v_exp_f32 v74, v74
    v_exp_f32 v75, v75
    v_exp_f32 v76, v76
    v_exp_f32 v77, v77
    v_smfmac_f32_32x32x32_bf16 a[64:79], v[108:111], v[68:75], v2
    v_exp_f32 v78, v78
    v_exp_f32 v79, v79
    buffer_load_dwordx4 v[204:207], v3, s[4:7], s54 offen offset:1024
    v_exp_f32 v80, v80
    v_mfma_f32_32x32x16_bf16 v[60:75], v[92:95], v[36:39], 0
    v_exp_f32 v81, v81
    v_exp_f32 v82, v82
    v_exp_f32 v83, v83
    v_mfma_f32_32x32x8_bf16 v[60:75], v[96:97], v[56:57], v[60:75]
    v_exp_f32 v84, v84
    v_exp_f32 v85, v85
    v_exp_f32 v86, v86
    v_exp_f32 v87, v87
    v_exp_f32 v88, v88
    v_exp_f32 v89, v89
    v_smfmac_f32_32x32x32_bf16 a[80:95], v[104:107], v[76:83], v2
    v_exp_f32 v90, v90
    v_exp_f32 v91, v91
    v_exp_f32 v60, v60
    v_exp_f32 v61, v61
    v_smfmac_f32_32x32x32_bf16 a[80:95], v[108:111], v[84:91], v2
    v_exp_f32 v62, v62
    v_exp_f32 v63, v63
    v_exp_f32 v64, v64
    v_mfma_f32_32x32x16_bf16 v[76:91], v[92:95], v[40:43], 0
    v_exp_f32 v65, v65
    v_exp_f32 v66, v66
    v_exp_f32 v67, v67
    v_mfma_f32_32x32x8_bf16 v[76:91], v[96:97], v[58:59], v[76:91]
    v_exp_f32 v68, v68
    v_exp_f32 v69, v69
    v_exp_f32 v70, v70
    v_exp_f32 v71, v71
    v_exp_f32 v72, v72
    v_exp_f32 v73, v73
    v_smfmac_f32_32x32x32_bf16 a[96:111], v[104:107], v[60:67], v2
    v_exp_f32 v74, v74
    v_exp_f32 v75, v75
    s_waitcnt vmcnt(4)
    v_exp_f32 v76, v76
    v_exp_f32 v77, v77
    v_smfmac_f32_32x32x32_bf16 a[96:111], v[108:111], v[68:75], v2
    v_exp_f32 v78, v78
    v_exp_f32 v79, v79
    v_exp_f32 v80, v80
    v_mfma_f32_32x32x16_bf16 v[60:75], v[98:101], v[12:15], 0
    v_exp_f32 v81, v81
    v_exp_f32 v82, v82
    v_exp_f32 v83, v83
    v_mfma_f32_32x32x8_bf16 v[60:75], v[102:103], v[44:45], v[60:75]
    v_exp_f32 v84, v84
    v_exp_f32 v85, v85
    v_exp_f32 v86, v86
    v_exp_f32 v87, v87
    v_exp_f32 v88, v88
    v_exp_f32 v89, v89
    v_smfmac_f32_32x32x32_bf16 a[112:127], v[104:107], v[76:83], v2
    v_exp_f32 v90, v90
    v_exp_f32 v91, v91
    v_exp_f32 v60, v60
    v_exp_f32 v61, v61
    v_smfmac_f32_32x32x32_bf16 a[112:127], v[108:111], v[84:91], v2
    v_exp_f32 v62, v62
    v_exp_f32 v63, v63
    s_add_u32 s11, s11, 3584
    v_exp_f32 v64, v64
    v_mfma_f32_32x32x16_bf16 v[76:91], v[98:101], v[16:19], 0
    buffer_load_dwordx4 v[92:95], v3, s[4:7], s11 offen
    v_exp_f32 v65, v65
    v_exp_f32 v66, v66
    v_exp_f32 v67, v67
    buffer_load_dwordx2 v[96:97], v4, s[4:7], s11 offen offset:1024
    v_mfma_f32_32x32x8_bf16 v[76:91], v[102:103], v[46:47], v[76:91]
    v_exp_f32 v68, v68
    v_exp_f32 v69, v69
    v_exp_f32 v70, v70
    v_exp_f32 v71, v71
    v_exp_f32 v72, v72
    v_exp_f32 v73, v73
    v_smfmac_f32_32x32x32_bf16 a[0:15], v[112:115], v[60:67], v2
    v_exp_f32 v74, v74
    v_exp_f32 v75, v75
    v_exp_f32 v76, v76
    v_exp_f32 v77, v77
    v_smfmac_f32_32x32x32_bf16 a[0:15], v[116:119], v[68:75], v2
    v_exp_f32 v78, v78
    v_exp_f32 v79, v79
    buffer_load_dwordx4 v[104:107], v3, s[4:7], s11 offen offset:1536
    v_exp_f32 v80, v80
    v_mfma_f32_32x32x16_bf16 v[60:75], v[98:101], v[20:23], 0
    buffer_load_dwordx4 v[108:111], v3, s[4:7], s11 offen offset:2560
    v_exp_f32 v81, v81
    v_exp_f32 v82, v82
    v_exp_f32 v83, v83
    v_mfma_f32_32x32x8_bf16 v[60:75], v[102:103], v[48:49], v[60:75]
    v_exp_f32 v84, v84
    v_exp_f32 v85, v85
    v_exp_f32 v86, v86
    v_exp_f32 v87, v87
    v_exp_f32 v88, v88
    v_exp_f32 v89, v89
    v_smfmac_f32_32x32x32_bf16 a[16:31], v[112:115], v[76:83], v2
    v_exp_f32 v90, v90
    v_exp_f32 v91, v91
    v_exp_f32 v60, v60
    v_exp_f32 v61, v61
    v_smfmac_f32_32x32x32_bf16 a[16:31], v[116:119], v[84:91], v2
    v_exp_f32 v62, v62
    v_exp_f32 v63, v63
    s_add_u32 s52, s52, 4096
    s_add_u32 s54, s54, 4096
    buffer_load_dwordx4 v[208:211], v3, s[4:7], s52 offen offset:0
    v_exp_f32 v64, v64
    v_mfma_f32_32x32x16_bf16 v[76:91], v[98:101], v[24:27], 0
    v_exp_f32 v65, v65
    v_exp_f32 v66, v66
    v_exp_f32 v67, v67
    v_mfma_f32_32x32x8_bf16 v[76:91], v[102:103], v[50:51], v[76:91]
    v_exp_f32 v68, v68
    v_exp_f32 v69, v69
    v_exp_f32 v70, v70
    v_exp_f32 v71, v71
    v_exp_f32 v72, v72
    v_exp_f32 v73, v73
    v_smfmac_f32_32x32x32_bf16 a[32:47], v[112:115], v[60:67], v2
    v_exp_f32 v74, v74
    v_exp_f32 v75, v75
    v_exp_f32 v76, v76
    v_exp_f32 v77, v77
    v_smfmac_f32_32x32x32_bf16 a[32:47], v[116:119], v[68:75], v2
    v_exp_f32 v78, v78
    v_exp_f32 v79, v79
    buffer_load_dwordx4 v[212:215], v3, s[4:7], s52 offen offset:1024
    v_exp_f32 v80, v80
    v_mfma_f32_32x32x16_bf16 v[60:75], v[98:101], v[28:31], 0
    v_exp_f32 v81, v81
    v_exp_f32 v82, v82
    v_exp_f32 v83, v83
    v_mfma_f32_32x32x8_bf16 v[60:75], v[102:103], v[52:53], v[60:75]
    v_exp_f32 v84, v84
    v_exp_f32 v85, v85
    v_exp_f32 v86, v86
    v_exp_f32 v87, v87
    v_exp_f32 v88, v88
    v_exp_f32 v89, v89
    v_smfmac_f32_32x32x32_bf16 a[48:63], v[112:115], v[76:83], v2
    v_exp_f32 v90, v90
    v_exp_f32 v91, v91
    v_exp_f32 v60, v60
    v_exp_f32 v61, v61
    v_smfmac_f32_32x32x32_bf16 a[48:63], v[116:119], v[84:91], v2
    v_exp_f32 v62, v62
    v_exp_f32 v63, v63
    buffer_load_dwordx4 v[216:219], v3, s[4:7], s54 offen offset:0
    v_exp_f32 v64, v64
    v_mfma_f32_32x32x16_bf16 v[76:91], v[98:101], v[32:35], 0
    v_exp_f32 v65, v65
    v_exp_f32 v66, v66
    v_exp_f32 v67, v67
    v_mfma_f32_32x32x8_bf16 v[76:91], v[102:103], v[54:55], v[76:91]
    v_exp_f32 v68, v68
    v_exp_f32 v69, v69
    v_exp_f32 v70, v70
    v_exp_f32 v71, v71
    v_exp_f32 v72, v72
    v_exp_f32 v73, v73
    v_smfmac_f32_32x32x32_bf16 a[64:79], v[112:115], v[60:67], v2
    v_exp_f32 v74, v74
    v_exp_f32 v75, v75
    v_exp_f32 v76, v76
    v_exp_f32 v77, v77
    v_smfmac_f32_32x32x32_bf16 a[64:79], v[116:119], v[68:75], v2
    v_exp_f32 v78, v78
    v_exp_f32 v79, v79
    buffer_load_dwordx4 v[220:223], v3, s[4:7], s54 offen offset:1024
    v_exp_f32 v80, v80
    v_mfma_f32_32x32x16_bf16 v[60:75], v[98:101], v[36:39], 0
    v_exp_f32 v81, v81
    v_exp_f32 v82, v82
    v_exp_f32 v83, v83
    v_mfma_f32_32x32x8_bf16 v[60:75], v[102:103], v[56:57], v[60:75]
    v_exp_f32 v84, v84
    v_exp_f32 v85, v85
    v_exp_f32 v86, v86
    v_exp_f32 v87, v87
    v_exp_f32 v88, v88
    v_exp_f32 v89, v89
    v_smfmac_f32_32x32x32_bf16 a[80:95], v[112:115], v[76:83], v2
    v_exp_f32 v90, v90
    v_exp_f32 v91, v91
    v_exp_f32 v60, v60
    v_exp_f32 v61, v61
    v_smfmac_f32_32x32x32_bf16 a[80:95], v[116:119], v[84:91], v2
    v_exp_f32 v62, v62
    v_exp_f32 v63, v63
    v_exp_f32 v64, v64
    v_mfma_f32_32x32x16_bf16 v[76:91], v[98:101], v[40:43], 0
    v_exp_f32 v65, v65
    v_exp_f32 v66, v66
    v_exp_f32 v67, v67
    v_mfma_f32_32x32x8_bf16 v[76:91], v[102:103], v[58:59], v[76:91]
    v_exp_f32 v68, v68
    v_exp_f32 v69, v69
    v_exp_f32 v70, v70
    v_exp_f32 v71, v71
    v_exp_f32 v72, v72
    v_exp_f32 v73, v73
    v_smfmac_f32_32x32x32_bf16 a[96:111], v[112:115], v[60:67], v2
    v_exp_f32 v74, v74
    v_exp_f32 v75, v75
    s_waitcnt vmcnt(4)
    v_exp_f32 v76, v76
    v_exp_f32 v77, v77
    v_smfmac_f32_32x32x32_bf16 a[96:111], v[116:119], v[68:75], v2
    v_exp_f32 v78, v78
    v_exp_f32 v79, v79
    v_exp_f32 v80, v80
    v_mfma_f32_32x32x16_bf16 v[60:75], v[92:95], v[12:15], 0
    v_exp_f32 v81, v81
    v_exp_f32 v82, v82
    v_exp_f32 v83, v83
    v_mfma_f32_32x32x8_bf16 v[60:75], v[96:97], v[44:45], v[60:75]
    v_exp_f32 v84, v84
    v_exp_f32 v85, v85
    v_exp_f32 v86, v86
    v_exp_f32 v87, v87
    v_exp_f32 v88, v88
    v_exp_f32 v89, v89
    v_smfmac_f32_32x32x32_bf16 a[112:127], v[112:115], v[76:83], v2
    v_exp_f32 v90, v90
    v_exp_f32 v91, v91
    v_exp_f32 v60, v60
    v_exp_f32 v61, v61
    v_smfmac_f32_32x32x32_bf16 a[112:127], v[116:119], v[84:91], v2
    v_exp_f32 v62, v62
    v_exp_f32 v63, v63
    s_add_u32 s11, s11, 3584
    v_exp_f32 v64, v64
    v_mfma_f32_32x32x16_bf16 v[76:91], v[92:95], v[16:19], 0
    buffer_load_dwordx4 v[98:101], v3, s[4:7], s11 offen
    v_exp_f32 v65, v65
    v_exp_f32 v66, v66
    v_exp_f32 v67, v67
    buffer_load_dwordx2 v[102:103], v4, s[4:7], s11 offen offset:1024
    v_mfma_f32_32x32x8_bf16 v[76:91], v[96:97], v[46:47], v[76:91]
    v_exp_f32 v68, v68
    v_exp_f32 v69, v69
    v_exp_f32 v70, v70
    v_exp_f32 v71, v71
    v_exp_f32 v72, v72
    v_exp_f32 v73, v73
    v_smfmac_f32_32x32x32_bf16 a[0:15], v[104:107], v[60:67], v2
    v_exp_f32 v74, v74
    v_exp_f32 v75, v75
    v_exp_f32 v76, v76
    v_exp_f32 v77, v77
    v_smfmac_f32_32x32x32_bf16 a[0:15], v[108:111], v[68:75], v2
    v_exp_f32 v78, v78
    v_exp_f32 v79, v79
    buffer_load_dwordx4 v[112:115], v3, s[4:7], s11 offen offset:1536
    v_exp_f32 v80, v80
    v_mfma_f32_32x32x16_bf16 v[60:75], v[92:95], v[20:23], 0
    buffer_load_dwordx4 v[116:119], v3, s[4:7], s11 offen offset:2560
    v_exp_f32 v81, v81
    v_exp_f32 v82, v82
    v_exp_f32 v83, v83
    v_mfma_f32_32x32x8_bf16 v[60:75], v[96:97], v[48:49], v[60:75]
    v_exp_f32 v84, v84
    v_exp_f32 v85, v85
    v_exp_f32 v86, v86
    v_exp_f32 v87, v87
    v_exp_f32 v88, v88
    v_exp_f32 v89, v89
    v_smfmac_f32_32x32x32_bf16 a[16:31], v[104:107], v[76:83], v2
    v_exp_f32 v90, v90
    v_exp_f32 v91, v91
    v_exp_f32 v60, v60
    v_exp_f32 v61, v61
    v_smfmac_f32_32x32x32_bf16 a[16:31], v[108:111], v[84:91], v2
    v_exp_f32 v62, v62
    v_exp_f32 v63, v63
    s_add_u32 s52, s52, 4096
    s_add_u32 s54, s54, 4096
    buffer_load_dwordx4 v[224:227], v3, s[4:7], s52 offen offset:0
    v_exp_f32 v64, v64
    v_mfma_f32_32x32x16_bf16 v[76:91], v[92:95], v[24:27], 0
    v_exp_f32 v65, v65
    v_exp_f32 v66, v66
    v_exp_f32 v67, v67
    v_mfma_f32_32x32x8_bf16 v[76:91], v[96:97], v[50:51], v[76:91]
    v_exp_f32 v68, v68
    v_exp_f32 v69, v69
    v_exp_f32 v70, v70
    v_exp_f32 v71, v71
    v_exp_f32 v72, v72
    v_exp_f32 v73, v73
    v_smfmac_f32_32x32x32_bf16 a[32:47], v[104:107], v[60:67], v2
    v_exp_f32 v74, v74
    v_exp_f32 v75, v75
    v_exp_f32 v76, v76
    v_exp_f32 v77, v77
    v_smfmac_f32_32x32x32_bf16 a[32:47], v[108:111], v[68:75], v2
    v_exp_f32 v78, v78
    v_exp_f32 v79, v79
    buffer_load_dwordx4 v[228:231], v3, s[4:7], s52 offen offset:1024
    v_exp_f32 v80, v80
    v_mfma_f32_32x32x16_bf16 v[60:75], v[92:95], v[28:31], 0
    v_exp_f32 v81, v81
    v_exp_f32 v82, v82
    v_exp_f32 v83, v83
    v_mfma_f32_32x32x8_bf16 v[60:75], v[96:97], v[52:53], v[60:75]
    v_exp_f32 v84, v84
    v_exp_f32 v85, v85
    v_exp_f32 v86, v86
    v_exp_f32 v87, v87
    v_exp_f32 v88, v88
    v_exp_f32 v89, v89
    v_smfmac_f32_32x32x32_bf16 a[48:63], v[104:107], v[76:83], v2
    v_exp_f32 v90, v90
    v_exp_f32 v91, v91
    v_exp_f32 v60, v60
    v_exp_f32 v61, v61
    v_smfmac_f32_32x32x32_bf16 a[48:63], v[108:111], v[84:91], v2
    v_exp_f32 v62, v62
    v_exp_f32 v63, v63
    buffer_load_dwordx4 v[232:235], v3, s[4:7], s54 offen offset:0
    v_exp_f32 v64, v64
    v_mfma_f32_32x32x16_bf16 v[76:91], v[92:95], v[32:35], 0
    v_exp_f32 v65, v65
    v_exp_f32 v66, v66
    v_exp_f32 v67, v67
    v_mfma_f32_32x32x8_bf16 v[76:91], v[96:97], v[54:55], v[76:91]
    v_exp_f32 v68, v68
    v_exp_f32 v69, v69
    v_exp_f32 v70, v70
    v_exp_f32 v71, v71
    v_exp_f32 v72, v72
    v_exp_f32 v73, v73
    v_smfmac_f32_32x32x32_bf16 a[64:79], v[104:107], v[60:67], v2
    v_exp_f32 v74, v74
    v_exp_f32 v75, v75
    v_exp_f32 v76, v76
    v_exp_f32 v77, v77
    v_smfmac_f32_32x32x32_bf16 a[64:79], v[108:111], v[68:75], v2
    v_exp_f32 v78, v78
    v_exp_f32 v79, v79
    buffer_load_dwordx4 v[236:239], v3, s[4:7], s54 offen offset:1024
    v_exp_f32 v80, v80
    v_mfma_f32_32x32x16_bf16 v[60:75], v[92:95], v[36:39], 0
    v_exp_f32 v81, v81
    v_exp_f32 v82, v82
    v_exp_f32 v83, v83
    v_mfma_f32_32x32x8_bf16 v[60:75], v[96:97], v[56:57], v[60:75]
    v_exp_f32 v84, v84
    v_exp_f32 v85, v85
    v_exp_f32 v86, v86
    v_exp_f32 v87, v87
    v_exp_f32 v88, v88
    v_exp_f32 v89, v89
    v_smfmac_f32_32x32x32_bf16 a[80:95], v[104:107], v[76:83], v2
    v_exp_f32 v90, v90
    v_exp_f32 v91, v91
    v_exp_f32 v60, v60
    v_exp_f32 v61, v61
    v_smfmac_f32_32x32x32_bf16 a[80:95], v[108:111], v[84:91], v2
    v_exp_f32 v62, v62
    v_exp_f32 v63, v63
    v_exp_f32 v64, v64
    v_mfma_f32_32x32x16_bf16 v[76:91], v[92:95], v[40:43], 0
    v_exp_f32 v65, v65
    v_exp_f32 v66, v66
    v_exp_f32 v67, v67
    v_mfma_f32_32x32x8_bf16 v[76:91], v[96:97], v[58:59], v[76:91]
    v_exp_f32 v68, v68
    v_exp_f32 v69, v69
    v_exp_f32 v70, v70
    v_exp_f32 v71, v71
    v_exp_f32 v72, v72
    v_exp_f32 v73, v73
    v_smfmac_f32_32x32x32_bf16 a[96:111], v[104:107], v[60:67], v2
    v_exp_f32 v74, v74
    v_exp_f32 v75, v75
    s_waitcnt vmcnt(4)
    v_exp_f32 v76, v76
    v_exp_f32 v77, v77
    v_smfmac_f32_32x32x32_bf16 a[96:111], v[108:111], v[68:75], v2
    v_exp_f32 v78, v78
    v_exp_f32 v79, v79
    v_exp_f32 v80, v80
    v_mfma_f32_32x32x16_bf16 v[60:75], v[98:101], v[12:15], 0
    v_exp_f32 v81, v81
    v_exp_f32 v82, v82
    v_exp_f32 v83, v83
    v_mfma_f32_32x32x8_bf16 v[60:75], v[102:103], v[44:45], v[60:75]
    v_exp_f32 v84, v84
    v_exp_f32 v85, v85
    v_exp_f32 v86, v86
    v_exp_f32 v87, v87
    v_exp_f32 v88, v88
    v_exp_f32 v89, v89
    v_smfmac_f32_32x32x32_bf16 a[112:127], v[104:107], v[76:83], v2
    v_exp_f32 v90, v90
    v_exp_f32 v91, v91
    v_exp_f32 v60, v60
    v_exp_f32 v61, v61
    v_smfmac_f32_32x32x32_bf16 a[112:127], v[108:111], v[84:91], v2
    v_exp_f32 v62, v62
    v_exp_f32 v63, v63
    s_add_u32 s11, s11, 3584
    v_exp_f32 v64, v64
    v_mfma_f32_32x32x16_bf16 v[76:91], v[98:101], v[16:19], 0
    buffer_load_dwordx4 v[92:95], v3, s[4:7], s11 offen
    v_exp_f32 v65, v65
    v_exp_f32 v66, v66
    v_exp_f32 v67, v67
    buffer_load_dwordx2 v[96:97], v4, s[4:7], s11 offen offset:1024
    v_mfma_f32_32x32x8_bf16 v[76:91], v[102:103], v[46:47], v[76:91]
    v_exp_f32 v68, v68
    v_exp_f32 v69, v69
    v_exp_f32 v70, v70
    v_exp_f32 v71, v71
    v_exp_f32 v72, v72
    v_exp_f32 v73, v73
    v_smfmac_f32_32x32x32_bf16 a[0:15], v[112:115], v[60:67], v2
    v_exp_f32 v74, v74
    v_exp_f32 v75, v75
    v_exp_f32 v76, v76
    v_exp_f32 v77, v77
    v_smfmac_f32_32x32x32_bf16 a[0:15], v[116:119], v[68:75], v2
    v_exp_f32 v78, v78
    v_exp_f32 v79, v79
    buffer_load_dwordx4 v[104:107], v3, s[4:7], s11 offen offset:1536
    v_exp_f32 v80, v80
    v_mfma_f32_32x32x16_bf16 v[60:75], v[98:101], v[20:23], 0
    buffer_load_dwordx4 v[108:111], v3, s[4:7], s11 offen offset:2560
    v_exp_f32 v81, v81
    v_exp_f32 v82, v82
    v_exp_f32 v83, v83
    v_mfma_f32_32x32x8_bf16 v[60:75], v[102:103], v[48:49], v[60:75]
    v_exp_f32 v84, v84
    v_exp_f32 v85, v85
    v_exp_f32 v86, v86
    v_exp_f32 v87, v87
    v_exp_f32 v88, v88
    v_exp_f32 v89, v89
    v_smfmac_f32_32x32x32_bf16 a[16:31], v[112:115], v[76:83], v2
    v_exp_f32 v90, v90
    v_exp_f32 v91, v91
    v_exp_f32 v60, v60
    v_exp_f32 v61, v61
    v_smfmac_f32_32x32x32_bf16 a[16:31], v[116:119], v[84:91], v2
    v_exp_f32 v62, v62
    v_exp_f32 v63, v63
    s_add_u32 s52, s52, 4096
    s_add_u32 s54, s54, 4096
    buffer_load_dwordx4 v[240:243], v3, s[4:7], s52 offen offset:0
    v_exp_f32 v64, v64
    v_mfma_f32_32x32x16_bf16 v[76:91], v[98:101], v[24:27], 0
    v_exp_f32 v65, v65
    v_exp_f32 v66, v66
    v_exp_f32 v67, v67
    v_mfma_f32_32x32x8_bf16 v[76:91], v[102:103], v[50:51], v[76:91]
    v_exp_f32 v68, v68
    v_exp_f32 v69, v69
    v_exp_f32 v70, v70
    v_exp_f32 v71, v71
    v_exp_f32 v72, v72
    v_exp_f32 v73, v73
    v_smfmac_f32_32x32x32_bf16 a[32:47], v[112:115], v[60:67], v2
    v_exp_f32 v74, v74
    v_exp_f32 v75, v75
    v_exp_f32 v76, v76
    v_exp_f32 v77, v77
    v_smfmac_f32_32x32x32_bf16 a[32:47], v[116:119], v[68:75], v2
    v_exp_f32 v78, v78
    v_exp_f32 v79, v79
    buffer_load_dwordx4 v[244:247], v3, s[4:7], s52 offen offset:1024
    v_exp_f32 v80, v80
    v_mfma_f32_32x32x16_bf16 v[60:75], v[98:101], v[28:31], 0
    v_exp_f32 v81, v81
    v_exp_f32 v82, v82
    v_exp_f32 v83, v83
    v_mfma_f32_32x32x8_bf16 v[60:75], v[102:103], v[52:53], v[60:75]
    v_exp_f32 v84, v84
    v_exp_f32 v85, v85
    v_exp_f32 v86, v86
    v_exp_f32 v87, v87
    v_exp_f32 v88, v88
    v_exp_f32 v89, v89
    v_smfmac_f32_32x32x32_bf16 a[48:63], v[112:115], v[76:83], v2
    v_exp_f32 v90, v90
    v_exp_f32 v91, v91
    v_exp_f32 v60, v60
    v_exp_f32 v61, v61
    v_smfmac_f32_32x32x32_bf16 a[48:63], v[116:119], v[84:91], v2
    v_exp_f32 v62, v62
    v_exp_f32 v63, v63
    buffer_load_dwordx4 v[248:251], v3, s[4:7], s54 offen offset:0
    v_exp_f32 v64, v64
    v_mfma_f32_32x32x16_bf16 v[76:91], v[98:101], v[32:35], 0
    v_exp_f32 v65, v65
    v_exp_f32 v66, v66
    v_exp_f32 v67, v67
    v_mfma_f32_32x32x8_bf16 v[76:91], v[102:103], v[54:55], v[76:91]
    v_exp_f32 v68, v68
    v_exp_f32 v69, v69
    v_exp_f32 v70, v70
    v_exp_f32 v71, v71
    v_exp_f32 v72, v72
    v_exp_f32 v73, v73
    v_smfmac_f32_32x32x32_bf16 a[64:79], v[112:115], v[60:67], v2
    v_exp_f32 v74, v74
    v_exp_f32 v75, v75
    v_exp_f32 v76, v76
    v_exp_f32 v77, v77
    v_smfmac_f32_32x32x32_bf16 a[64:79], v[116:119], v[68:75], v2
    v_exp_f32 v78, v78
    v_exp_f32 v79, v79
    buffer_load_dwordx4 v[252:255], v3, s[4:7], s54 offen offset:1024
    v_exp_f32 v80, v80
    v_mfma_f32_32x32x16_bf16 v[60:75], v[98:101], v[36:39], 0
    v_exp_f32 v81, v81
    v_exp_f32 v82, v82
    v_exp_f32 v83, v83
    v_mfma_f32_32x32x8_bf16 v[60:75], v[102:103], v[56:57], v[60:75]
    v_exp_f32 v84, v84
    v_exp_f32 v85, v85
    v_exp_f32 v86, v86
    v_exp_f32 v87, v87
    v_exp_f32 v88, v88
    v_exp_f32 v89, v89
    v_smfmac_f32_32x32x32_bf16 a[80:95], v[112:115], v[76:83], v2
    v_exp_f32 v90, v90
    v_exp_f32 v91, v91
    v_exp_f32 v60, v60
    v_exp_f32 v61, v61
    v_smfmac_f32_32x32x32_bf16 a[80:95], v[116:119], v[84:91], v2
    v_exp_f32 v62, v62
    v_exp_f32 v63, v63
    v_exp_f32 v64, v64
    v_mfma_f32_32x32x16_bf16 v[76:91], v[98:101], v[40:43], 0
    v_exp_f32 v65, v65
    v_exp_f32 v66, v66
    v_exp_f32 v67, v67
    v_mfma_f32_32x32x8_bf16 v[76:91], v[102:103], v[58:59], v[76:91]
    v_exp_f32 v68, v68
    v_exp_f32 v69, v69
    v_exp_f32 v70, v70
    v_exp_f32 v71, v71
    v_exp_f32 v72, v72
    v_exp_f32 v73, v73
    v_smfmac_f32_32x32x32_bf16 a[96:111], v[112:115], v[60:67], v2
    v_exp_f32 v74, v74
    v_exp_f32 v75, v75
    s_waitcnt vmcnt(4)
    v_exp_f32 v76, v76
    v_exp_f32 v77, v77
    v_smfmac_f32_32x32x32_bf16 a[96:111], v[116:119], v[68:75], v2
    v_exp_f32 v78, v78
    v_exp_f32 v79, v79
    v_exp_f32 v80, v80
    v_mfma_f32_32x32x16_bf16 v[60:75], v[92:95], v[12:15], 0
    v_exp_f32 v81, v81
    v_exp_f32 v82, v82
    v_exp_f32 v83, v83
    v_mfma_f32_32x32x8_bf16 v[60:75], v[96:97], v[44:45], v[60:75]
    v_exp_f32 v84, v84
    v_exp_f32 v85, v85
    v_exp_f32 v86, v86
    v_exp_f32 v87, v87
    v_exp_f32 v88, v88
    v_exp_f32 v89, v89
    v_smfmac_f32_32x32x32_bf16 a[112:127], v[112:115], v[76:83], v2
    v_exp_f32 v90, v90
    v_exp_f32 v91, v91
    v_exp_f32 v60, v60
    v_exp_f32 v61, v61
    v_smfmac_f32_32x32x32_bf16 a[112:127], v[116:119], v[84:91], v2
    v_exp_f32 v62, v62
    v_exp_f32 v63, v63
    s_add_u32 s11, s11, 3584
    v_exp_f32 v64, v64
    v_mfma_f32_32x32x16_bf16 v[76:91], v[92:95], v[16:19], 0
    buffer_load_dwordx4 v[98:101], v3, s[4:7], s11 offen
    v_exp_f32 v65, v65
    v_exp_f32 v66, v66
    v_exp_f32 v67, v67
    buffer_load_dwordx2 v[102:103], v4, s[4:7], s11 offen offset:1024
    v_mfma_f32_32x32x8_bf16 v[76:91], v[96:97], v[46:47], v[76:91]
    v_exp_f32 v68, v68
    v_exp_f32 v69, v69
    v_exp_f32 v70, v70
    v_exp_f32 v71, v71
    v_exp_f32 v72, v72
    v_exp_f32 v73, v73
    v_smfmac_f32_32x32x32_bf16 a[0:15], v[104:107], v[60:67], v2
    v_exp_f32 v74, v74
    v_exp_f32 v75, v75
    v_exp_f32 v76, v76
    v_exp_f32 v77, v77
    v_smfmac_f32_32x32x32_bf16 a[0:15], v[108:111], v[68:75], v2
    v_exp_f32 v78, v78
    v_exp_f32 v79, v79
    buffer_load_dwordx4 v[112:115], v3, s[4:7], s11 offen offset:1536
    v_exp_f32 v80, v80
    v_mfma_f32_32x32x16_bf16 v[60:75], v[92:95], v[20:23], 0
    buffer_load_dwordx4 v[116:119], v3, s[4:7], s11 offen offset:2560
    v_exp_f32 v81, v81
    v_exp_f32 v82, v82
    v_exp_f32 v83, v83
    v_mfma_f32_32x32x8_bf16 v[60:75], v[96:97], v[48:49], v[60:75]
    v_exp_f32 v84, v84
    v_exp_f32 v85, v85
    v_exp_f32 v86, v86
    v_exp_f32 v87, v87
    v_exp_f32 v88, v88
    v_exp_f32 v89, v89
    v_smfmac_f32_32x32x32_bf16 a[16:31], v[104:107], v[76:83], v2
    v_exp_f32 v90, v90
    v_exp_f32 v91, v91
    v_exp_f32 v60, v60
    v_exp_f32 v61, v61
    v_smfmac_f32_32x32x32_bf16 a[16:31], v[108:111], v[84:91], v2
    v_exp_f32 v62, v62
    v_exp_f32 v63, v63
    s_add_u32 s52, s52, 4096
    s_add_u32 s54, s54, 4096
    buffer_load_dwordx4 a[128:131], v3, s[4:7], s52 offen offset:0
    v_exp_f32 v64, v64
    v_mfma_f32_32x32x16_bf16 v[76:91], v[92:95], v[24:27], 0
    v_exp_f32 v65, v65
    v_exp_f32 v66, v66
    v_exp_f32 v67, v67
    v_mfma_f32_32x32x8_bf16 v[76:91], v[96:97], v[50:51], v[76:91]
    v_exp_f32 v68, v68
    v_exp_f32 v69, v69
    v_exp_f32 v70, v70
    v_exp_f32 v71, v71
    v_exp_f32 v72, v72
    v_exp_f32 v73, v73
    v_smfmac_f32_32x32x32_bf16 a[32:47], v[104:107], v[60:67], v2
    v_exp_f32 v74, v74
    v_exp_f32 v75, v75
    v_exp_f32 v76, v76
    v_exp_f32 v77, v77
    v_smfmac_f32_32x32x32_bf16 a[32:47], v[108:111], v[68:75], v2
    v_exp_f32 v78, v78
    v_exp_f32 v79, v79
    buffer_load_dwordx4 a[132:135], v3, s[4:7], s52 offen offset:1024
    v_exp_f32 v80, v80
    v_mfma_f32_32x32x16_bf16 v[60:75], v[92:95], v[28:31], 0
    v_exp_f32 v81, v81
    v_exp_f32 v82, v82
    v_exp_f32 v83, v83
    v_mfma_f32_32x32x8_bf16 v[60:75], v[96:97], v[52:53], v[60:75]
    v_exp_f32 v84, v84
    v_exp_f32 v85, v85
    v_exp_f32 v86, v86
    v_exp_f32 v87, v87
    v_exp_f32 v88, v88
    v_exp_f32 v89, v89
    v_smfmac_f32_32x32x32_bf16 a[48:63], v[104:107], v[76:83], v2
    v_exp_f32 v90, v90
    v_exp_f32 v91, v91
    v_exp_f32 v60, v60
    v_exp_f32 v61, v61
    v_smfmac_f32_32x32x32_bf16 a[48:63], v[108:111], v[84:91], v2
    v_exp_f32 v62, v62
    v_exp_f32 v63, v63
    buffer_load_dwordx4 a[136:139], v3, s[4:7], s54 offen offset:0
    v_exp_f32 v64, v64
    v_mfma_f32_32x32x16_bf16 v[76:91], v[92:95], v[32:35], 0
    v_exp_f32 v65, v65
    v_exp_f32 v66, v66
    v_exp_f32 v67, v67
    v_mfma_f32_32x32x8_bf16 v[76:91], v[96:97], v[54:55], v[76:91]
    v_exp_f32 v68, v68
    v_exp_f32 v69, v69
    v_exp_f32 v70, v70
    v_exp_f32 v71, v71
    v_exp_f32 v72, v72
    v_exp_f32 v73, v73
    v_smfmac_f32_32x32x32_bf16 a[64:79], v[104:107], v[60:67], v2
    v_exp_f32 v74, v74
    v_exp_f32 v75, v75
    v_exp_f32 v76, v76
    v_exp_f32 v77, v77
    v_smfmac_f32_32x32x32_bf16 a[64:79], v[108:111], v[68:75], v2
    v_exp_f32 v78, v78
    v_exp_f32 v79, v79
    buffer_load_dwordx4 a[140:143], v3, s[4:7], s54 offen offset:1024
    v_exp_f32 v80, v80
    v_mfma_f32_32x32x16_bf16 v[60:75], v[92:95], v[36:39], 0
    v_exp_f32 v81, v81
    v_exp_f32 v82, v82
    v_exp_f32 v83, v83
    v_mfma_f32_32x32x8_bf16 v[60:75], v[96:97], v[56:57], v[60:75]
    v_exp_f32 v84, v84
    v_exp_f32 v85, v85
    v_exp_f32 v86, v86
    v_exp_f32 v87, v87
    v_exp_f32 v88, v88
    v_exp_f32 v89, v89
    v_smfmac_f32_32x32x32_bf16 a[80:95], v[104:107], v[76:83], v2
    v_exp_f32 v90, v90
    v_exp_f32 v91, v91
    v_exp_f32 v60, v60
    v_exp_f32 v61, v61
    v_smfmac_f32_32x32x32_bf16 a[80:95], v[108:111], v[84:91], v2
    v_exp_f32 v62, v62
    v_exp_f32 v63, v63
    v_exp_f32 v64, v64
    v_mfma_f32_32x32x16_bf16 v[76:91], v[92:95], v[40:43], 0
    v_exp_f32 v65, v65
    v_exp_f32 v66, v66
    v_exp_f32 v67, v67
    v_mfma_f32_32x32x8_bf16 v[76:91], v[96:97], v[58:59], v[76:91]
    v_exp_f32 v68, v68
    v_exp_f32 v69, v69
    v_exp_f32 v70, v70
    v_exp_f32 v71, v71
    v_exp_f32 v72, v72
    v_exp_f32 v73, v73
    v_smfmac_f32_32x32x32_bf16 a[96:111], v[104:107], v[60:67], v2
    v_exp_f32 v74, v74
    v_exp_f32 v75, v75
    s_waitcnt vmcnt(4)
    v_exp_f32 v76, v76
    v_exp_f32 v77, v77
    v_smfmac_f32_32x32x32_bf16 a[96:111], v[108:111], v[68:75], v2
    v_exp_f32 v78, v78
    v_exp_f32 v79, v79
    v_exp_f32 v80, v80
    v_mfma_f32_32x32x16_bf16 v[60:75], v[98:101], v[12:15], 0
    v_exp_f32 v81, v81
    v_exp_f32 v82, v82
    v_exp_f32 v83, v83
    v_mfma_f32_32x32x8_bf16 v[60:75], v[102:103], v[44:45], v[60:75]
    v_exp_f32 v84, v84
    v_exp_f32 v85, v85
    v_exp_f32 v86, v86
    v_exp_f32 v87, v87
    v_exp_f32 v88, v88
    v_exp_f32 v89, v89
    v_smfmac_f32_32x32x32_bf16 a[112:127], v[104:107], v[76:83], v2
    v_exp_f32 v90, v90
    v_exp_f32 v91, v91
    v_exp_f32 v60, v60
    v_exp_f32 v61, v61
    v_smfmac_f32_32x32x32_bf16 a[112:127], v[108:111], v[84:91], v2
    v_exp_f32 v62, v62
    v_exp_f32 v63, v63
    s_add_u32 s11, s11, 3584
    v_exp_f32 v64, v64
    v_mfma_f32_32x32x16_bf16 v[76:91], v[98:101], v[16:19], 0
    buffer_load_dwordx4 v[92:95], v3, s[4:7], s11 offen
    v_exp_f32 v65, v65
    v_exp_f32 v66, v66
    v_exp_f32 v67, v67
    buffer_load_dwordx2 v[96:97], v4, s[4:7], s11 offen offset:1024
    v_mfma_f32_32x32x8_bf16 v[76:91], v[102:103], v[46:47], v[76:91]
    v_exp_f32 v68, v68
    v_exp_f32 v69, v69
    v_exp_f32 v70, v70
    v_exp_f32 v71, v71
    v_exp_f32 v72, v72
    v_exp_f32 v73, v73
    v_smfmac_f32_32x32x32_bf16 a[0:15], v[112:115], v[60:67], v2
    v_exp_f32 v74, v74
    v_exp_f32 v75, v75
    v_exp_f32 v76, v76
    v_exp_f32 v77, v77
    v_smfmac_f32_32x32x32_bf16 a[0:15], v[116:119], v[68:75], v2
    v_exp_f32 v78, v78
    v_exp_f32 v79, v79
    buffer_load_dwordx4 v[104:107], v3, s[4:7], s11 offen offset:1536
    v_exp_f32 v80, v80
    v_mfma_f32_32x32x16_bf16 v[60:75], v[98:101], v[20:23], 0
    buffer_load_dwordx4 v[108:111], v3, s[4:7], s11 offen offset:2560
    v_exp_f32 v81, v81
    v_exp_f32 v82, v82
    v_exp_f32 v83, v83
    v_mfma_f32_32x32x8_bf16 v[60:75], v[102:103], v[48:49], v[60:75]
    v_exp_f32 v84, v84
    v_exp_f32 v85, v85
    v_exp_f32 v86, v86
    v_exp_f32 v87, v87
    v_exp_f32 v88, v88
    v_exp_f32 v89, v89
    v_smfmac_f32_32x32x32_bf16 a[16:31], v[112:115], v[76:83], v2
    v_exp_f32 v90, v90
    v_exp_f32 v91, v91
    v_exp_f32 v60, v60
    v_exp_f32 v61, v61
    v_smfmac_f32_32x32x32_bf16 a[16:31], v[116:119], v[84:91], v2
    v_exp_f32 v62, v62
    v_exp_f32 v63, v63
    s_add_u32 s52, s52, 4096
    s_add_u32 s54, s54, 4096
    buffer_load_dwordx4 a[144:147], v3, s[4:7], s52 offen offset:0
    v_exp_f32 v64, v64
    v_mfma_f32_32x32x16_bf16 v[76:91], v[98:101], v[24:27], 0
    v_exp_f32 v65, v65
    v_exp_f32 v66, v66
    v_exp_f32 v67, v67
    v_mfma_f32_32x32x8_bf16 v[76:91], v[102:103], v[50:51], v[76:91]
    v_exp_f32 v68, v68
    v_exp_f32 v69, v69
    v_exp_f32 v70, v70
    v_exp_f32 v71, v71
    v_exp_f32 v72, v72
    v_exp_f32 v73, v73
    v_smfmac_f32_32x32x32_bf16 a[32:47], v[112:115], v[60:67], v2
    v_exp_f32 v74, v74
    v_exp_f32 v75, v75
    v_exp_f32 v76, v76
    v_exp_f32 v77, v77
    v_smfmac_f32_32x32x32_bf16 a[32:47], v[116:119], v[68:75], v2
    v_exp_f32 v78, v78
    v_exp_f32 v79, v79
    buffer_load_dwordx4 a[148:151], v3, s[4:7], s52 offen offset:1024
    v_exp_f32 v80, v80
    v_mfma_f32_32x32x16_bf16 v[60:75], v[98:101], v[28:31], 0
    v_exp_f32 v81, v81
    v_exp_f32 v82, v82
    v_exp_f32 v83, v83
    v_mfma_f32_32x32x8_bf16 v[60:75], v[102:103], v[52:53], v[60:75]
    v_exp_f32 v84, v84
    v_exp_f32 v85, v85
    v_exp_f32 v86, v86
    v_exp_f32 v87, v87
    v_exp_f32 v88, v88
    v_exp_f32 v89, v89
    v_smfmac_f32_32x32x32_bf16 a[48:63], v[112:115], v[76:83], v2
    v_exp_f32 v90, v90
    v_exp_f32 v91, v91
    v_exp_f32 v60, v60
    v_exp_f32 v61, v61
    v_smfmac_f32_32x32x32_bf16 a[48:63], v[116:119], v[84:91], v2
    v_exp_f32 v62, v62
    v_exp_f32 v63, v63
    buffer_load_dwordx4 a[152:155], v3, s[4:7], s54 offen offset:0
    v_exp_f32 v64, v64
    v_mfma_f32_32x32x16_bf16 v[76:91], v[98:101], v[32:35], 0
    v_exp_f32 v65, v65
    v_exp_f32 v66, v66
    v_exp_f32 v67, v67
    v_mfma_f32_32x32x8_bf16 v[76:91], v[102:103], v[54:55], v[76:91]
    v_exp_f32 v68, v68
    v_exp_f32 v69, v69
    v_exp_f32 v70, v70
    v_exp_f32 v71, v71
    v_exp_f32 v72, v72
    v_exp_f32 v73, v73
    v_smfmac_f32_32x32x32_bf16 a[64:79], v[112:115], v[60:67], v2
    v_exp_f32 v74, v74
    v_exp_f32 v75, v75
    v_exp_f32 v76, v76
    v_exp_f32 v77, v77
    v_smfmac_f32_32x32x32_bf16 a[64:79], v[116:119], v[68:75], v2
    v_exp_f32 v78, v78
    v_exp_f32 v79, v79
    buffer_load_dwordx4 a[156:159], v3, s[4:7], s54 offen offset:1024
    v_exp_f32 v80, v80
    v_mfma_f32_32x32x16_bf16 v[60:75], v[98:101], v[36:39], 0
    v_exp_f32 v81, v81
    v_exp_f32 v82, v82
    v_exp_f32 v83, v83
    v_mfma_f32_32x32x8_bf16 v[60:75], v[102:103], v[56:57], v[60:75]
    v_exp_f32 v84, v84
    v_exp_f32 v85, v85
    v_exp_f32 v86, v86
    v_exp_f32 v87, v87
    v_exp_f32 v88, v88
    v_exp_f32 v89, v89
    v_smfmac_f32_32x32x32_bf16 a[80:95], v[112:115], v[76:83], v2
    v_exp_f32 v90, v90
    v_exp_f32 v91, v91
    v_exp_f32 v60, v60
    v_exp_f32 v61, v61
    v_smfmac_f32_32x32x32_bf16 a[80:95], v[116:119], v[84:91], v2
    v_exp_f32 v62, v62
    v_exp_f32 v63, v63
    v_exp_f32 v64, v64
    v_mfma_f32_32x32x16_bf16 v[76:91], v[98:101], v[40:43], 0
    v_exp_f32 v65, v65
    v_exp_f32 v66, v66
    v_exp_f32 v67, v67
    v_mfma_f32_32x32x8_bf16 v[76:91], v[102:103], v[58:59], v[76:91]
    v_exp_f32 v68, v68
    v_exp_f32 v69, v69
    v_exp_f32 v70, v70
    v_exp_f32 v71, v71
    v_exp_f32 v72, v72
    v_exp_f32 v73, v73
    v_smfmac_f32_32x32x32_bf16 a[96:111], v[112:115], v[60:67], v2
    v_exp_f32 v74, v74
    v_exp_f32 v75, v75
    s_waitcnt vmcnt(4)
    v_exp_f32 v76, v76
    v_exp_f32 v77, v77
    v_smfmac_f32_32x32x32_bf16 a[96:111], v[116:119], v[68:75], v2
    v_exp_f32 v78, v78
    v_exp_f32 v79, v79
    v_exp_f32 v80, v80
    v_mfma_f32_32x32x16_bf16 v[60:75], v[92:95], v[12:15], 0
    v_exp_f32 v81, v81
    v_exp_f32 v82, v82
    v_exp_f32 v83, v83
    v_mfma_f32_32x32x8_bf16 v[60:75], v[96:97], v[44:45], v[60:75]
    v_exp_f32 v84, v84
    v_exp_f32 v85, v85
    v_exp_f32 v86, v86
    v_exp_f32 v87, v87
    v_exp_f32 v88, v88
    v_exp_f32 v89, v89
    v_smfmac_f32_32x32x32_bf16 a[112:127], v[112:115], v[76:83], v2
    v_exp_f32 v90, v90
    v_exp_f32 v91, v91
    v_exp_f32 v60, v60
    v_exp_f32 v61, v61
    v_smfmac_f32_32x32x32_bf16 a[112:127], v[116:119], v[84:91], v2
    v_exp_f32 v62, v62
    v_exp_f32 v63, v63
    s_add_u32 s11, s11, 3584
    v_exp_f32 v64, v64
    v_mfma_f32_32x32x16_bf16 v[76:91], v[92:95], v[16:19], 0
    buffer_load_dwordx4 v[98:101], v3, s[4:7], s11 offen
    v_exp_f32 v65, v65
    v_exp_f32 v66, v66
    v_exp_f32 v67, v67
    buffer_load_dwordx2 v[102:103], v4, s[4:7], s11 offen offset:1024
    v_mfma_f32_32x32x8_bf16 v[76:91], v[96:97], v[46:47], v[76:91]
    v_exp_f32 v68, v68
    v_exp_f32 v69, v69
    v_exp_f32 v70, v70
    v_exp_f32 v71, v71
    v_exp_f32 v72, v72
    v_exp_f32 v73, v73
    v_smfmac_f32_32x32x32_bf16 a[0:15], v[104:107], v[60:67], v2
    v_exp_f32 v74, v74
    v_exp_f32 v75, v75
    v_exp_f32 v76, v76
    v_exp_f32 v77, v77
    v_smfmac_f32_32x32x32_bf16 a[0:15], v[108:111], v[68:75], v2
    v_exp_f32 v78, v78
    v_exp_f32 v79, v79
    buffer_load_dwordx4 v[112:115], v3, s[4:7], s11 offen offset:1536
    v_exp_f32 v80, v80
    v_mfma_f32_32x32x16_bf16 v[60:75], v[92:95], v[20:23], 0
    buffer_load_dwordx4 v[116:119], v3, s[4:7], s11 offen offset:2560
    v_exp_f32 v81, v81
    v_exp_f32 v82, v82
    v_exp_f32 v83, v83
    v_mfma_f32_32x32x8_bf16 v[60:75], v[96:97], v[48:49], v[60:75]
    v_exp_f32 v84, v84
    v_exp_f32 v85, v85
    v_exp_f32 v86, v86
    v_exp_f32 v87, v87
    v_exp_f32 v88, v88
    v_exp_f32 v89, v89
    v_smfmac_f32_32x32x32_bf16 a[16:31], v[104:107], v[76:83], v2
    v_exp_f32 v90, v90
    v_exp_f32 v91, v91
    v_exp_f32 v60, v60
    v_exp_f32 v61, v61
    v_smfmac_f32_32x32x32_bf16 a[16:31], v[108:111], v[84:91], v2
    v_exp_f32 v62, v62
    v_exp_f32 v63, v63
    s_add_u32 s52, s52, 4096
    s_add_u32 s54, s54, 4096
    buffer_load_dwordx4 a[160:163], v3, s[4:7], s52 offen offset:0
    v_exp_f32 v64, v64
    v_mfma_f32_32x32x16_bf16 v[76:91], v[92:95], v[24:27], 0
    v_exp_f32 v65, v65
    v_exp_f32 v66, v66
    v_exp_f32 v67, v67
    v_mfma_f32_32x32x8_bf16 v[76:91], v[96:97], v[50:51], v[76:91]
    v_exp_f32 v68, v68
    v_exp_f32 v69, v69
    v_exp_f32 v70, v70
    v_exp_f32 v71, v71
    v_exp_f32 v72, v72
    v_exp_f32 v73, v73
    v_smfmac_f32_32x32x32_bf16 a[32:47], v[104:107], v[60:67], v2
    v_exp_f32 v74, v74
    v_exp_f32 v75, v75
    v_exp_f32 v76, v76
    v_exp_f32 v77, v77
    v_smfmac_f32_32x32x32_bf16 a[32:47], v[108:111], v[68:75], v2
    v_exp_f32 v78, v78
    v_exp_f32 v79, v79
    buffer_load_dwordx4 a[164:167], v3, s[4:7], s52 offen offset:1024
    v_exp_f32 v80, v80
    v_mfma_f32_32x32x16_bf16 v[60:75], v[92:95], v[28:31], 0
    v_exp_f32 v81, v81
    v_exp_f32 v82, v82
    v_exp_f32 v83, v83
    v_mfma_f32_32x32x8_bf16 v[60:75], v[96:97], v[52:53], v[60:75]
    v_exp_f32 v84, v84
    v_exp_f32 v85, v85
    v_exp_f32 v86, v86
    v_exp_f32 v87, v87
    v_exp_f32 v88, v88
    v_exp_f32 v89, v89
    v_smfmac_f32_32x32x32_bf16 a[48:63], v[104:107], v[76:83], v2
    v_exp_f32 v90, v90
    v_exp_f32 v91, v91
    v_exp_f32 v60, v60
    v_exp_f32 v61, v61
    v_smfmac_f32_32x32x32_bf16 a[48:63], v[108:111], v[84:91], v2
    v_exp_f32 v62, v62
    v_exp_f32 v63, v63
    buffer_load_dwordx4 a[168:171], v3, s[4:7], s54 offen offset:0
    v_exp_f32 v64, v64
    v_mfma_f32_32x32x16_bf16 v[76:91], v[92:95], v[32:35], 0
    v_exp_f32 v65, v65
    v_exp_f32 v66, v66
    v_exp_f32 v67, v67
    v_mfma_f32_32x32x8_bf16 v[76:91], v[96:97], v[54:55], v[76:91]
    v_exp_f32 v68, v68
    v_exp_f32 v69, v69
    v_exp_f32 v70, v70
    v_exp_f32 v71, v71
    v_exp_f32 v72, v72
    v_exp_f32 v73, v73
    v_smfmac_f32_32x32x32_bf16 a[64:79], v[104:107], v[60:67], v2
    v_exp_f32 v74, v74
    v_exp_f32 v75, v75
    v_exp_f32 v76, v76
    v_exp_f32 v77, v77
    v_smfmac_f32_32x32x32_bf16 a[64:79], v[108:111], v[68:75], v2
    v_exp_f32 v78, v78
    v_exp_f32 v79, v79
    buffer_load_dwordx4 a[172:175], v3, s[4:7], s54 offen offset:1024
    v_exp_f32 v80, v80
    v_mfma_f32_32x32x16_bf16 v[60:75], v[92:95], v[36:39], 0
    v_exp_f32 v81, v81
    v_exp_f32 v82, v82
    v_exp_f32 v83, v83
    v_mfma_f32_32x32x8_bf16 v[60:75], v[96:97], v[56:57], v[60:75]
    v_exp_f32 v84, v84
    v_exp_f32 v85, v85
    v_exp_f32 v86, v86
    v_exp_f32 v87, v87
    v_exp_f32 v88, v88
    v_exp_f32 v89, v89
    v_smfmac_f32_32x32x32_bf16 a[80:95], v[104:107], v[76:83], v2
    v_exp_f32 v90, v90
    v_exp_f32 v91, v91
    v_exp_f32 v60, v60
    v_exp_f32 v61, v61
    v_smfmac_f32_32x32x32_bf16 a[80:95], v[108:111], v[84:91], v2
    v_exp_f32 v62, v62
    v_exp_f32 v63, v63
    v_exp_f32 v64, v64
    v_mfma_f32_32x32x16_bf16 v[76:91], v[92:95], v[40:43], 0
    v_exp_f32 v65, v65
    v_exp_f32 v66, v66
    v_exp_f32 v67, v67
    v_mfma_f32_32x32x8_bf16 v[76:91], v[96:97], v[58:59], v[76:91]
    v_exp_f32 v68, v68
    v_exp_f32 v69, v69
    v_exp_f32 v70, v70
    v_exp_f32 v71, v71
    v_exp_f32 v72, v72
    v_exp_f32 v73, v73
    v_smfmac_f32_32x32x32_bf16 a[96:111], v[104:107], v[60:67], v2
    v_exp_f32 v74, v74
    v_exp_f32 v75, v75
    s_waitcnt vmcnt(4)
    v_exp_f32 v76, v76
    v_exp_f32 v77, v77
    v_smfmac_f32_32x32x32_bf16 a[96:111], v[108:111], v[68:75], v2
    v_exp_f32 v78, v78
    v_exp_f32 v79, v79
    v_exp_f32 v80, v80
    v_mfma_f32_32x32x16_bf16 v[60:75], v[98:101], v[12:15], 0
    v_exp_f32 v81, v81
    v_exp_f32 v82, v82
    v_exp_f32 v83, v83
    v_mfma_f32_32x32x8_bf16 v[60:75], v[102:103], v[44:45], v[60:75]
    v_exp_f32 v84, v84
    v_exp_f32 v85, v85
    v_exp_f32 v86, v86
    v_exp_f32 v87, v87
    v_exp_f32 v88, v88
    v_exp_f32 v89, v89
    v_smfmac_f32_32x32x32_bf16 a[112:127], v[104:107], v[76:83], v2
    v_exp_f32 v90, v90
    v_exp_f32 v91, v91
    v_exp_f32 v60, v60
    v_exp_f32 v61, v61
    v_smfmac_f32_32x32x32_bf16 a[112:127], v[108:111], v[84:91], v2
    v_exp_f32 v62, v62
    v_exp_f32 v63, v63
    s_add_u32 s11, s11, 3584
    v_exp_f32 v64, v64
    v_mfma_f32_32x32x16_bf16 v[76:91], v[98:101], v[16:19], 0
    buffer_load_dwordx4 v[92:95], v3, s[4:7], s11 offen
    v_exp_f32 v65, v65
    v_exp_f32 v66, v66
    v_exp_f32 v67, v67
    buffer_load_dwordx2 v[96:97], v4, s[4:7], s11 offen offset:1024
    v_mfma_f32_32x32x8_bf16 v[76:91], v[102:103], v[46:47], v[76:91]
    v_exp_f32 v68, v68
    v_exp_f32 v69, v69
    v_exp_f32 v70, v70
    v_exp_f32 v71, v71
    v_exp_f32 v72, v72
    v_exp_f32 v73, v73
    v_smfmac_f32_32x32x32_bf16 a[0:15], v[112:115], v[60:67], v2
    v_exp_f32 v74, v74
    v_exp_f32 v75, v75
    v_exp_f32 v76, v76
    v_exp_f32 v77, v77
    v_smfmac_f32_32x32x32_bf16 a[0:15], v[116:119], v[68:75], v2
    v_exp_f32 v78, v78
    v_exp_f32 v79, v79
    buffer_load_dwordx4 v[104:107], v3, s[4:7], s11 offen offset:1536
    v_exp_f32 v80, v80
    v_mfma_f32_32x32x16_bf16 v[60:75], v[98:101], v[20:23], 0
    buffer_load_dwordx4 v[108:111], v3, s[4:7], s11 offen offset:2560
    v_exp_f32 v81, v81
    v_exp_f32 v82, v82
    v_exp_f32 v83, v83
    v_mfma_f32_32x32x8_bf16 v[60:75], v[102:103], v[48:49], v[60:75]
    v_exp_f32 v84, v84
    v_exp_f32 v85, v85
    v_exp_f32 v86, v86
    v_exp_f32 v87, v87
    v_exp_f32 v88, v88
    v_exp_f32 v89, v89
    v_smfmac_f32_32x32x32_bf16 a[16:31], v[112:115], v[76:83], v2
    v_exp_f32 v90, v90
    v_exp_f32 v91, v91
    v_exp_f32 v60, v60
    v_exp_f32 v61, v61
    v_smfmac_f32_32x32x32_bf16 a[16:31], v[116:119], v[84:91], v2
    v_exp_f32 v62, v62
    v_exp_f32 v63, v63
    s_add_u32 s52, s52, 4096
    s_add_u32 s54, s54, 4096
    buffer_load_dwordx4 a[176:179], v3, s[4:7], s52 offen offset:0
    v_exp_f32 v64, v64
    v_mfma_f32_32x32x16_bf16 v[76:91], v[98:101], v[24:27], 0
    v_exp_f32 v65, v65
    v_exp_f32 v66, v66
    v_exp_f32 v67, v67
    v_mfma_f32_32x32x8_bf16 v[76:91], v[102:103], v[50:51], v[76:91]
    v_exp_f32 v68, v68
    v_exp_f32 v69, v69
    v_exp_f32 v70, v70
    v_exp_f32 v71, v71
    v_exp_f32 v72, v72
    v_exp_f32 v73, v73
    v_smfmac_f32_32x32x32_bf16 a[32:47], v[112:115], v[60:67], v2
    v_exp_f32 v74, v74
    v_exp_f32 v75, v75
    v_exp_f32 v76, v76
    v_exp_f32 v77, v77
    v_smfmac_f32_32x32x32_bf16 a[32:47], v[116:119], v[68:75], v2
    v_exp_f32 v78, v78
    v_exp_f32 v79, v79
    buffer_load_dwordx4 a[180:183], v3, s[4:7], s52 offen offset:1024
    v_exp_f32 v80, v80
    v_mfma_f32_32x32x16_bf16 v[60:75], v[98:101], v[28:31], 0
    v_exp_f32 v81, v81
    v_exp_f32 v82, v82
    v_exp_f32 v83, v83
    v_mfma_f32_32x32x8_bf16 v[60:75], v[102:103], v[52:53], v[60:75]
    v_exp_f32 v84, v84
    v_exp_f32 v85, v85
    v_exp_f32 v86, v86
    v_exp_f32 v87, v87
    v_exp_f32 v88, v88
    v_exp_f32 v89, v89
    v_smfmac_f32_32x32x32_bf16 a[48:63], v[112:115], v[76:83], v2
    v_exp_f32 v90, v90
    v_exp_f32 v91, v91
    v_exp_f32 v60, v60
    v_exp_f32 v61, v61
    v_smfmac_f32_32x32x32_bf16 a[48:63], v[116:119], v[84:91], v2
    v_exp_f32 v62, v62
    v_exp_f32 v63, v63
    buffer_load_dwordx4 a[184:187], v3, s[4:7], s54 offen offset:0
    v_exp_f32 v64, v64
    v_mfma_f32_32x32x16_bf16 v[76:91], v[98:101], v[32:35], 0
    v_exp_f32 v65, v65
    v_exp_f32 v66, v66
    v_exp_f32 v67, v67
    v_mfma_f32_32x32x8_bf16 v[76:91], v[102:103], v[54:55], v[76:91]
    v_exp_f32 v68, v68
    v_exp_f32 v69, v69
    v_exp_f32 v70, v70
    v_exp_f32 v71, v71
    v_exp_f32 v72, v72
    v_exp_f32 v73, v73
    v_smfmac_f32_32x32x32_bf16 a[64:79], v[112:115], v[60:67], v2
    v_exp_f32 v74, v74
    v_exp_f32 v75, v75
    v_exp_f32 v76, v76
    v_exp_f32 v77, v77
    v_smfmac_f32_32x32x32_bf16 a[64:79], v[116:119], v[68:75], v2
    v_exp_f32 v78, v78
    v_exp_f32 v79, v79
    buffer_load_dwordx4 a[188:191], v3, s[4:7], s54 offen offset:1024
    v_exp_f32 v80, v80
    v_mfma_f32_32x32x16_bf16 v[60:75], v[98:101], v[36:39], 0
    v_exp_f32 v81, v81
    v_exp_f32 v82, v82
    v_exp_f32 v83, v83
    v_mfma_f32_32x32x8_bf16 v[60:75], v[102:103], v[56:57], v[60:75]
    v_exp_f32 v84, v84
    v_exp_f32 v85, v85
    v_exp_f32 v86, v86
    v_exp_f32 v87, v87
    v_exp_f32 v88, v88
    v_exp_f32 v89, v89
    v_smfmac_f32_32x32x32_bf16 a[80:95], v[112:115], v[76:83], v2
    v_exp_f32 v90, v90
    v_exp_f32 v91, v91
    v_exp_f32 v60, v60
    v_exp_f32 v61, v61
    v_smfmac_f32_32x32x32_bf16 a[80:95], v[116:119], v[84:91], v2
    v_exp_f32 v62, v62
    v_exp_f32 v63, v63
    v_exp_f32 v64, v64
    v_mfma_f32_32x32x16_bf16 v[76:91], v[98:101], v[40:43], 0
    v_exp_f32 v65, v65
    v_exp_f32 v66, v66
    v_exp_f32 v67, v67
    v_mfma_f32_32x32x8_bf16 v[76:91], v[102:103], v[58:59], v[76:91]
    v_exp_f32 v68, v68
    v_exp_f32 v69, v69
    v_exp_f32 v70, v70
    v_exp_f32 v71, v71
    v_exp_f32 v72, v72
    v_exp_f32 v73, v73
    v_smfmac_f32_32x32x32_bf16 a[96:111], v[112:115], v[60:67], v2
    v_exp_f32 v74, v74
    v_exp_f32 v75, v75
    s_waitcnt vmcnt(4)
    v_exp_f32 v76, v76
    v_exp_f32 v77, v77
    v_smfmac_f32_32x32x32_bf16 a[96:111], v[116:119], v[68:75], v2
    v_exp_f32 v78, v78
    v_exp_f32 v79, v79
    v_exp_f32 v80, v80
    v_mfma_f32_32x32x16_bf16 v[60:75], v[92:95], v[12:15], 0
    v_exp_f32 v81, v81
    v_exp_f32 v82, v82
    v_exp_f32 v83, v83
    v_mfma_f32_32x32x8_bf16 v[60:75], v[96:97], v[44:45], v[60:75]
    v_exp_f32 v84, v84
    v_exp_f32 v85, v85
    v_exp_f32 v86, v86
    v_exp_f32 v87, v87
    v_exp_f32 v88, v88
    v_exp_f32 v89, v89
    v_smfmac_f32_32x32x32_bf16 a[112:127], v[112:115], v[76:83], v2
    v_exp_f32 v90, v90
    v_exp_f32 v91, v91
    v_exp_f32 v60, v60
    v_exp_f32 v61, v61
    v_smfmac_f32_32x32x32_bf16 a[112:127], v[116:119], v[84:91], v2
    v_exp_f32 v62, v62
    v_exp_f32 v63, v63
    s_add_u32 s11, s11, 3584
    v_exp_f32 v64, v64
    v_mfma_f32_32x32x16_bf16 v[76:91], v[92:95], v[16:19], 0
    buffer_load_dwordx4 v[98:101], v3, s[4:7], s11 offen
    v_exp_f32 v65, v65
    v_exp_f32 v66, v66
    v_exp_f32 v67, v67
    buffer_load_dwordx2 v[102:103], v4, s[4:7], s11 offen offset:1024
    v_mfma_f32_32x32x8_bf16 v[76:91], v[96:97], v[46:47], v[76:91]
    v_exp_f32 v68, v68
    v_exp_f32 v69, v69
    v_exp_f32 v70, v70
    v_exp_f32 v71, v71
    v_exp_f32 v72, v72
    v_exp_f32 v73, v73
    v_smfmac_f32_32x32x32_bf16 a[0:15], v[104:107], v[60:67], v2
    v_exp_f32 v74, v74
    v_exp_f32 v75, v75
    v_exp_f32 v76, v76
    v_exp_f32 v77, v77
    v_smfmac_f32_32x32x32_bf16 a[0:15], v[108:111], v[68:75], v2
    v_exp_f32 v78, v78
    v_exp_f32 v79, v79
    buffer_load_dwordx4 v[112:115], v3, s[4:7], s11 offen offset:1536
    v_exp_f32 v80, v80
    v_mfma_f32_32x32x16_bf16 v[60:75], v[92:95], v[20:23], 0
    buffer_load_dwordx4 v[116:119], v3, s[4:7], s11 offen offset:2560
    v_exp_f32 v81, v81
    v_exp_f32 v82, v82
    v_exp_f32 v83, v83
    v_mfma_f32_32x32x8_bf16 v[60:75], v[96:97], v[48:49], v[60:75]
    v_exp_f32 v84, v84
    v_exp_f32 v85, v85
    v_exp_f32 v86, v86
    v_exp_f32 v87, v87
    v_exp_f32 v88, v88
    v_exp_f32 v89, v89
    v_smfmac_f32_32x32x32_bf16 a[16:31], v[104:107], v[76:83], v2
    v_exp_f32 v90, v90
    v_exp_f32 v91, v91
    v_exp_f32 v60, v60
    v_exp_f32 v61, v61
    v_smfmac_f32_32x32x32_bf16 a[16:31], v[108:111], v[84:91], v2
    v_exp_f32 v62, v62
    v_exp_f32 v63, v63
    s_add_u32 s52, s52, 4096
    s_add_u32 s54, s54, 4096
    buffer_load_dwordx4 a[192:195], v3, s[4:7], s52 offen offset:0
    v_exp_f32 v64, v64
    v_mfma_f32_32x32x16_bf16 v[76:91], v[92:95], v[24:27], 0
    v_exp_f32 v65, v65
    v_exp_f32 v66, v66
    v_exp_f32 v67, v67
    v_mfma_f32_32x32x8_bf16 v[76:91], v[96:97], v[50:51], v[76:91]
    v_exp_f32 v68, v68
    v_exp_f32 v69, v69
    v_exp_f32 v70, v70
    v_exp_f32 v71, v71
    v_exp_f32 v72, v72
    v_exp_f32 v73, v73
    v_smfmac_f32_32x32x32_bf16 a[32:47], v[104:107], v[60:67], v2
    v_exp_f32 v74, v74
    v_exp_f32 v75, v75
    v_exp_f32 v76, v76
    v_exp_f32 v77, v77
    v_smfmac_f32_32x32x32_bf16 a[32:47], v[108:111], v[68:75], v2
    v_exp_f32 v78, v78
    v_exp_f32 v79, v79
    buffer_load_dwordx4 a[196:199], v3, s[4:7], s52 offen offset:1024
    v_exp_f32 v80, v80
    v_mfma_f32_32x32x16_bf16 v[60:75], v[92:95], v[28:31], 0
    v_exp_f32 v81, v81
    v_exp_f32 v82, v82
    v_exp_f32 v83, v83
    v_mfma_f32_32x32x8_bf16 v[60:75], v[96:97], v[52:53], v[60:75]
    v_exp_f32 v84, v84
    v_exp_f32 v85, v85
    v_exp_f32 v86, v86
    v_exp_f32 v87, v87
    v_exp_f32 v88, v88
    v_exp_f32 v89, v89
    v_smfmac_f32_32x32x32_bf16 a[48:63], v[104:107], v[76:83], v2
    v_exp_f32 v90, v90
    v_exp_f32 v91, v91
    v_exp_f32 v60, v60
    v_exp_f32 v61, v61
    v_smfmac_f32_32x32x32_bf16 a[48:63], v[108:111], v[84:91], v2
    v_exp_f32 v62, v62
    v_exp_f32 v63, v63
    buffer_load_dwordx4 a[200:203], v3, s[4:7], s54 offen offset:0
    v_exp_f32 v64, v64
    v_mfma_f32_32x32x16_bf16 v[76:91], v[92:95], v[32:35], 0
    v_exp_f32 v65, v65
    v_exp_f32 v66, v66
    v_exp_f32 v67, v67
    v_mfma_f32_32x32x8_bf16 v[76:91], v[96:97], v[54:55], v[76:91]
    v_exp_f32 v68, v68
    v_exp_f32 v69, v69
    v_exp_f32 v70, v70
    v_exp_f32 v71, v71
    v_exp_f32 v72, v72
    v_exp_f32 v73, v73
    v_smfmac_f32_32x32x32_bf16 a[64:79], v[104:107], v[60:67], v2
    v_exp_f32 v74, v74
    v_exp_f32 v75, v75
    v_exp_f32 v76, v76
    v_exp_f32 v77, v77
    v_smfmac_f32_32x32x32_bf16 a[64:79], v[108:111], v[68:75], v2
    v_exp_f32 v78, v78
    v_exp_f32 v79, v79
    buffer_load_dwordx4 a[204:207], v3, s[4:7], s54 offen offset:1024
    v_exp_f32 v80, v80
    v_mfma_f32_32x32x16_bf16 v[60:75], v[92:95], v[36:39], 0
    v_exp_f32 v81, v81
    v_exp_f32 v82, v82
    v_exp_f32 v83, v83
    v_mfma_f32_32x32x8_bf16 v[60:75], v[96:97], v[56:57], v[60:75]
    v_exp_f32 v84, v84
    v_exp_f32 v85, v85
    v_exp_f32 v86, v86
    v_exp_f32 v87, v87
    v_exp_f32 v88, v88
    v_exp_f32 v89, v89
    v_smfmac_f32_32x32x32_bf16 a[80:95], v[104:107], v[76:83], v2
    v_exp_f32 v90, v90
    v_exp_f32 v91, v91
    v_exp_f32 v60, v60
    v_exp_f32 v61, v61
    v_smfmac_f32_32x32x32_bf16 a[80:95], v[108:111], v[84:91], v2
    v_exp_f32 v62, v62
    v_exp_f32 v63, v63
    v_exp_f32 v64, v64
    v_mfma_f32_32x32x16_bf16 v[76:91], v[92:95], v[40:43], 0
    v_exp_f32 v65, v65
    v_exp_f32 v66, v66
    v_exp_f32 v67, v67
    v_mfma_f32_32x32x8_bf16 v[76:91], v[96:97], v[58:59], v[76:91]
    v_exp_f32 v68, v68
    v_exp_f32 v69, v69
    v_exp_f32 v70, v70
    v_exp_f32 v71, v71
    v_exp_f32 v72, v72
    v_exp_f32 v73, v73
    v_smfmac_f32_32x32x32_bf16 a[96:111], v[104:107], v[60:67], v2
    v_exp_f32 v74, v74
    v_exp_f32 v75, v75
    s_waitcnt vmcnt(4)
    v_exp_f32 v76, v76
    v_exp_f32 v77, v77
    v_smfmac_f32_32x32x32_bf16 a[96:111], v[108:111], v[68:75], v2
    v_exp_f32 v78, v78
    v_exp_f32 v79, v79
    v_exp_f32 v80, v80
    v_mfma_f32_32x32x16_bf16 v[60:75], v[98:101], v[12:15], 0
    v_exp_f32 v81, v81
    v_exp_f32 v82, v82
    v_exp_f32 v83, v83
    v_mfma_f32_32x32x8_bf16 v[60:75], v[102:103], v[44:45], v[60:75]
    v_exp_f32 v84, v84
    v_exp_f32 v85, v85
    v_exp_f32 v86, v86
    v_exp_f32 v87, v87
    v_exp_f32 v88, v88
    v_exp_f32 v89, v89
    v_smfmac_f32_32x32x32_bf16 a[112:127], v[104:107], v[76:83], v2
    v_exp_f32 v90, v90
    v_exp_f32 v91, v91
    v_exp_f32 v60, v60
    v_exp_f32 v61, v61
    v_smfmac_f32_32x32x32_bf16 a[112:127], v[108:111], v[84:91], v2
    v_exp_f32 v62, v62
    v_exp_f32 v63, v63
    s_add_u32 s11, s11, 3584
    v_exp_f32 v64, v64
    v_mfma_f32_32x32x16_bf16 v[76:91], v[98:101], v[16:19], 0
    buffer_load_dwordx4 v[92:95], v3, s[4:7], s11 offen
    v_exp_f32 v65, v65
    v_exp_f32 v66, v66
    v_exp_f32 v67, v67
    buffer_load_dwordx2 v[96:97], v4, s[4:7], s11 offen offset:1024
    v_mfma_f32_32x32x8_bf16 v[76:91], v[102:103], v[46:47], v[76:91]
    v_exp_f32 v68, v68
    v_exp_f32 v69, v69
    v_exp_f32 v70, v70
    v_exp_f32 v71, v71
    v_exp_f32 v72, v72
    v_exp_f32 v73, v73
    v_smfmac_f32_32x32x32_bf16 a[0:15], v[112:115], v[60:67], v2
    v_exp_f32 v74, v74
    v_exp_f32 v75, v75
    v_exp_f32 v76, v76
    v_exp_f32 v77, v77
    v_smfmac_f32_32x32x32_bf16 a[0:15], v[116:119], v[68:75], v2
    v_exp_f32 v78, v78
    v_exp_f32 v79, v79
    buffer_load_dwordx4 v[104:107], v3, s[4:7], s11 offen offset:1536
    v_exp_f32 v80, v80
    v_mfma_f32_32x32x16_bf16 v[60:75], v[98:101], v[20:23], 0
    buffer_load_dwordx4 v[108:111], v3, s[4:7], s11 offen offset:2560
    v_exp_f32 v81, v81
    v_exp_f32 v82, v82
    v_exp_f32 v83, v83
    v_mfma_f32_32x32x8_bf16 v[60:75], v[102:103], v[48:49], v[60:75]
    v_exp_f32 v84, v84
    v_exp_f32 v85, v85
    v_exp_f32 v86, v86
    v_exp_f32 v87, v87
    v_exp_f32 v88, v88
    v_exp_f32 v89, v89
    v_smfmac_f32_32x32x32_bf16 a[16:31], v[112:115], v[76:83], v2
    v_exp_f32 v90, v90
    v_exp_f32 v91, v91
    v_exp_f32 v60, v60
    v_exp_f32 v61, v61
    v_smfmac_f32_32x32x32_bf16 a[16:31], v[116:119], v[84:91], v2
    v_exp_f32 v62, v62
    v_exp_f32 v63, v63
    s_add_u32 s52, s52, 4096
    s_add_u32 s54, s54, 4096
    s_cmp_eq_u32 s58, 1
    s_cselect_b32 s52, 2147418112, s52
    s_cselect_b32 s54, 2147418112, s54
    buffer_load_dwordx4 a[208:211], v3, s[4:7], s52 offen offset:0
    v_exp_f32 v64, v64
    v_mfma_f32_32x32x16_bf16 v[76:91], v[98:101], v[24:27], 0
    s_add_u32 m0, s53, 139264
    s_nop 0
    buffer_load_dwordx4 v3, s[4:7], s51 offen lds
    v_exp_f32 v65, v65
    v_exp_f32 v66, v66
    v_exp_f32 v67, v67
    v_mfma_f32_32x32x8_bf16 v[76:91], v[102:103], v[50:51], v[76:91]
    v_exp_f32 v68, v68
    v_exp_f32 v69, v69
    v_exp_f32 v70, v70
    v_exp_f32 v71, v71
    v_exp_f32 v72, v72
    v_exp_f32 v73, v73
    v_smfmac_f32_32x32x32_bf16 a[32:47], v[112:115], v[60:67], v2
    v_exp_f32 v74, v74
    v_exp_f32 v75, v75
    v_exp_f32 v76, v76
    v_exp_f32 v77, v77
    v_smfmac_f32_32x32x32_bf16 a[32:47], v[116:119], v[68:75], v2
    v_exp_f32 v78, v78
    v_exp_f32 v79, v79
    buffer_load_dwordx4 a[212:215], v3, s[4:7], s52 offen offset:1024
    v_exp_f32 v80, v80
    v_mfma_f32_32x32x16_bf16 v[60:75], v[98:101], v[28:31], 0
    buffer_load_dwordx4 v3, s[4:7], s51 offen offset:1024 lds
    v_exp_f32 v81, v81
    v_exp_f32 v82, v82
    v_exp_f32 v83, v83
    v_mfma_f32_32x32x8_bf16 v[60:75], v[102:103], v[52:53], v[60:75]
    v_exp_f32 v84, v84
    v_exp_f32 v85, v85
    v_exp_f32 v86, v86
    v_exp_f32 v87, v87
    v_exp_f32 v88, v88
    v_exp_f32 v89, v89
    v_smfmac_f32_32x32x32_bf16 a[48:63], v[112:115], v[76:83], v2
    v_exp_f32 v90, v90
    v_exp_f32 v91, v91
    v_exp_f32 v60, v60
    v_exp_f32 v61, v61
    v_smfmac_f32_32x32x32_bf16 a[48:63], v[116:119], v[84:91], v2
    v_exp_f32 v62, v62
    v_exp_f32 v63, v63
    buffer_load_dwordx4 a[216:219], v3, s[4:7], s54 offen offset:0
    v_exp_f32 v64, v64
    v_mfma_f32_32x32x16_bf16 v[76:91], v[98:101], v[32:35], 0
    buffer_load_dwordx4 v3, s[4:7], s51 offen offset:2048 lds
    v_exp_f32 v65, v65
    v_exp_f32 v66, v66
    v_exp_f32 v67, v67
    v_mfma_f32_32x32x8_bf16 v[76:91], v[102:103], v[54:55], v[76:91]
    v_exp_f32 v68, v68
    v_exp_f32 v69, v69
    v_exp_f32 v70, v70
    v_exp_f32 v71, v71
    v_exp_f32 v72, v72
    v_exp_f32 v73, v73
    v_smfmac_f32_32x32x32_bf16 a[64:79], v[112:115], v[60:67], v2
    v_exp_f32 v74, v74
    v_exp_f32 v75, v75
    v_exp_f32 v76, v76
    v_exp_f32 v77, v77
    v_smfmac_f32_32x32x32_bf16 a[64:79], v[116:119], v[68:75], v2
    v_exp_f32 v78, v78
    v_exp_f32 v79, v79
    buffer_load_dwordx4 a[220:223], v3, s[4:7], s54 offen offset:1024
    v_exp_f32 v80, v80
    v_mfma_f32_32x32x16_bf16 v[60:75], v[98:101], v[36:39], 0
    buffer_load_dwordx4 v3, s[4:7], s51 offen offset:3072 lds
    v_exp_f32 v81, v81
    v_exp_f32 v82, v82
    v_exp_f32 v83, v83
    v_mfma_f32_32x32x8_bf16 v[60:75], v[102:103], v[56:57], v[60:75]
    v_exp_f32 v84, v84
    v_exp_f32 v85, v85
    v_exp_f32 v86, v86
    v_exp_f32 v87, v87
    v_exp_f32 v88, v88
    v_exp_f32 v89, v89
    v_smfmac_f32_32x32x32_bf16 a[80:95], v[112:115], v[76:83], v2
    v_exp_f32 v90, v90
    v_exp_f32 v91, v91
    v_exp_f32 v60, v60
    v_exp_f32 v61, v61
    v_smfmac_f32_32x32x32_bf16 a[80:95], v[116:119], v[84:91], v2
    v_exp_f32 v62, v62
    v_exp_f32 v63, v63
    s_add_u32 s60, s51, 4096
    s_add_u32 m0, s53, 143360
    s_nop 0
    buffer_load_dwordx4 v3, s[4:7], s60 offen lds
    s_add_u32 s51, s51, 20480
    v_exp_f32 v64, v64
    v_mfma_f32_32x32x16_bf16 v[76:91], v[98:101], v[40:43], 0
    v_exp_f32 v65, v65
    v_exp_f32 v66, v66
    v_exp_f32 v67, v67
    v_mfma_f32_32x32x8_bf16 v[76:91], v[102:103], v[58:59], v[76:91]
    v_exp_f32 v68, v68
    v_exp_f32 v69, v69
    v_exp_f32 v70, v70
    v_exp_f32 v71, v71
    v_exp_f32 v72, v72
    v_exp_f32 v73, v73
    v_smfmac_f32_32x32x32_bf16 a[96:111], v[112:115], v[60:67], v2
    v_exp_f32 v74, v74
    v_exp_f32 v75, v75
    s_waitcnt vmcnt(9)
    v_exp_f32 v76, v76
    v_exp_f32 v77, v77
    v_smfmac_f32_32x32x32_bf16 a[96:111], v[116:119], v[68:75], v2
    v_exp_f32 v78, v78
    v_exp_f32 v79, v79
    v_exp_f32 v80, v80
    v_mfma_f32_32x32x16_bf16 v[60:75], v[92:95], v[12:15], 0
    v_exp_f32 v81, v81
    v_exp_f32 v82, v82
    v_exp_f32 v83, v83
    v_mfma_f32_32x32x8_bf16 v[60:75], v[96:97], v[44:45], v[60:75]
    v_exp_f32 v84, v84
    v_exp_f32 v85, v85
    v_exp_f32 v86, v86
    v_exp_f32 v87, v87
    v_exp_f32 v88, v88
    v_exp_f32 v89, v89
    v_smfmac_f32_32x32x32_bf16 a[112:127], v[112:115], v[76:83], v2
    v_exp_f32 v90, v90
    v_exp_f32 v91, v91
    v_exp_f32 v60, v60
    v_exp_f32 v61, v61
    v_smfmac_f32_32x32x32_bf16 a[112:127], v[116:119], v[84:91], v2
    v_exp_f32 v62, v62
    v_exp_f32 v63, v63
    s_add_u32 s11, s11, 3584
    v_exp_f32 v64, v64
    v_mfma_f32_32x32x16_bf16 v[76:91], v[92:95], v[16:19], 0
    buffer_load_dwordx4 v[98:101], v3, s[4:7], s11 offen
    v_exp_f32 v65, v65
    v_exp_f32 v66, v66
    v_exp_f32 v67, v67
    buffer_load_dwordx2 v[102:103], v4, s[4:7], s11 offen offset:1024
    v_mfma_f32_32x32x8_bf16 v[76:91], v[96:97], v[46:47], v[76:91]
    v_exp_f32 v68, v68
    v_exp_f32 v69, v69
    v_exp_f32 v70, v70
    v_exp_f32 v71, v71
    v_exp_f32 v72, v72
    v_exp_f32 v73, v73
    v_smfmac_f32_32x32x32_bf16 a[0:15], v[104:107], v[60:67], v2
    v_exp_f32 v74, v74
    v_exp_f32 v75, v75
    v_exp_f32 v76, v76
    v_exp_f32 v77, v77
    v_smfmac_f32_32x32x32_bf16 a[0:15], v[108:111], v[68:75], v2
    v_exp_f32 v78, v78
    v_exp_f32 v79, v79
    buffer_load_dwordx4 v[112:115], v3, s[4:7], s11 offen offset:1536
    v_exp_f32 v80, v80
    v_mfma_f32_32x32x16_bf16 v[60:75], v[92:95], v[20:23], 0
    buffer_load_dwordx4 v[116:119], v3, s[4:7], s11 offen offset:2560
    v_exp_f32 v81, v81
    v_exp_f32 v82, v82
    v_exp_f32 v83, v83
    v_mfma_f32_32x32x8_bf16 v[60:75], v[96:97], v[48:49], v[60:75]
    v_exp_f32 v84, v84
    v_exp_f32 v85, v85
    v_exp_f32 v86, v86
    v_exp_f32 v87, v87
    v_exp_f32 v88, v88
    v_exp_f32 v89, v89
    v_smfmac_f32_32x32x32_bf16 a[16:31], v[104:107], v[76:83], v2
    v_exp_f32 v90, v90
    v_exp_f32 v91, v91
    v_exp_f32 v60, v60
    v_exp_f32 v61, v61
    v_smfmac_f32_32x32x32_bf16 a[16:31], v[108:111], v[84:91], v2
    v_exp_f32 v62, v62
    v_exp_f32 v63, v63
    v_exp_f32 v64, v64
    v_mfma_f32_32x32x16_bf16 v[76:91], v[92:95], v[24:27], 0
    v_exp_f32 v65, v65
    v_exp_f32 v66, v66
    v_exp_f32 v67, v67
    v_mfma_f32_32x32x8_bf16 v[76:91], v[96:97], v[50:51], v[76:91]
    v_exp_f32 v68, v68
    v_exp_f32 v69, v69
    v_exp_f32 v70, v70
    v_exp_f32 v71, v71
    v_exp_f32 v72, v72
    v_exp_f32 v73, v73
    v_smfmac_f32_32x32x32_bf16 a[32:47], v[104:107], v[60:67], v2
    v_exp_f32 v74, v74
    v_exp_f32 v75, v75
    v_exp_f32 v76, v76
    v_exp_f32 v77, v77
    v_smfmac_f32_32x32x32_bf16 a[32:47], v[108:111], v[68:75], v2
    v_exp_f32 v78, v78
    v_exp_f32 v79, v79
    v_exp_f32 v80, v80
    v_mfma_f32_32x32x16_bf16 v[60:75], v[92:95], v[28:31], 0
    v_exp_f32 v81, v81
    v_exp_f32 v82, v82
    v_exp_f32 v83, v83
    v_mfma_f32_32x32x8_bf16 v[60:75], v[96:97], v[52:53], v[60:75]
    v_exp_f32 v84, v84
    v_exp_f32 v85, v85
    v_exp_f32 v86, v86
    v_exp_f32 v87, v87
    v_exp_f32 v88, v88
    v_exp_f32 v89, v89
    v_smfmac_f32_32x32x32_bf16 a[48:63], v[104:107], v[76:83], v2
    v_exp_f32 v90, v90
    v_exp_f32 v91, v91
    v_exp_f32 v60, v60
    v_exp_f32 v61, v61
    v_smfmac_f32_32x32x32_bf16 a[48:63], v[108:111], v[84:91], v2
    v_exp_f32 v62, v62
    v_exp_f32 v63, v63
    v_exp_f32 v64, v64
    v_mfma_f32_32x32x16_bf16 v[76:91], v[92:95], v[32:35], 0
    v_exp_f32 v65, v65
    v_exp_f32 v66, v66
    v_exp_f32 v67, v67
    v_mfma_f32_32x32x8_bf16 v[76:91], v[96:97], v[54:55], v[76:91]
    v_exp_f32 v68, v68
    v_exp_f32 v69, v69
    v_exp_f32 v70, v70
    v_exp_f32 v71, v71
    v_exp_f32 v72, v72
    v_exp_f32 v73, v73
    v_smfmac_f32_32x32x32_bf16 a[64:79], v[104:107], v[60:67], v2
    v_exp_f32 v74, v74
    v_exp_f32 v75, v75
    v_exp_f32 v76, v76
    v_exp_f32 v77, v77
    v_smfmac_f32_32x32x32_bf16 a[64:79], v[108:111], v[68:75], v2
    v_exp_f32 v78, v78
    v_exp_f32 v79, v79
    v_exp_f32 v80, v80
    v_mfma_f32_32x32x16_bf16 v[60:75], v[92:95], v[36:39], 0
    v_exp_f32 v81, v81
    v_exp_f32 v82, v82
    v_exp_f32 v83, v83
    v_mfma_f32_32x32x8_bf16 v[60:75], v[96:97], v[56:57], v[60:75]
    v_exp_f32 v84, v84
    v_exp_f32 v85, v85
    v_exp_f32 v86, v86
    v_exp_f32 v87, v87
    v_exp_f32 v88, v88
    v_exp_f32 v89, v89
    v_smfmac_f32_32x32x32_bf16 a[80:95], v[104:107], v[76:83], v2
    v_exp_f32 v90, v90
    v_exp_f32 v91, v91
    v_exp_f32 v60, v60
    v_exp_f32 v61, v61
    v_smfmac_f32_32x32x32_bf16 a[80:95], v[108:111], v[84:91], v2
    v_exp_f32 v62, v62
    v_exp_f32 v63, v63
    v_exp_f32 v64, v64
    v_mfma_f32_32x32x16_bf16 v[76:91], v[92:95], v[40:43], 0
    v_exp_f32 v65, v65
    v_exp_f32 v66, v66
    v_exp_f32 v67, v67
    v_mfma_f32_32x32x8_bf16 v[76:91], v[96:97], v[58:59], v[76:91]
    v_exp_f32 v68, v68
    v_exp_f32 v69, v69
    v_exp_f32 v70, v70
    v_exp_f32 v71, v71
    v_exp_f32 v72, v72
    v_exp_f32 v73, v73
    v_smfmac_f32_32x32x32_bf16 a[96:111], v[104:107], v[60:67], v2
    v_exp_f32 v74, v74
    v_exp_f32 v75, v75
    s_waitcnt vmcnt(0)
    v_exp_f32 v76, v76
    v_exp_f32 v77, v77
    v_smfmac_f32_32x32x32_bf16 a[96:111], v[108:111], v[68:75], v2
    v_exp_f32 v78, v78
    v_exp_f32 v79, v79
    v_exp_f32 v80, v80
    v_mfma_f32_32x32x16_bf16 v[60:75], v[98:101], v[12:15], 0
    v_exp_f32 v81, v81
    v_exp_f32 v82, v82
    v_exp_f32 v83, v83
    v_mfma_f32_32x32x8_bf16 v[60:75], v[102:103], v[44:45], v[60:75]
    v_exp_f32 v84, v84
    v_exp_f32 v85, v85
    v_exp_f32 v86, v86
    v_exp_f32 v87, v87
    v_exp_f32 v88, v88
    v_exp_f32 v89, v89
    v_smfmac_f32_32x32x32_bf16 a[112:127], v[104:107], v[76:83], v2
    v_exp_f32 v90, v90
    v_exp_f32 v91, v91
    v_exp_f32 v60, v60
    v_exp_f32 v61, v61
    v_smfmac_f32_32x32x32_bf16 a[112:127], v[108:111], v[84:91], v2
    v_exp_f32 v62, v62
    v_exp_f32 v63, v63
    buffer_load_dwordx2 a[224:225], v11, s[40:43], 0 offen offset:0
    v_exp_f32 v64, v64
    v_mfma_f32_32x32x16_bf16 v[76:91], v[98:101], v[16:19], 0
    buffer_load_dwordx2 a[226:227], v11, s[40:43], 0 offen offset:32
    v_exp_f32 v65, v65
    v_exp_f32 v66, v66
    v_exp_f32 v67, v67
    buffer_load_dwordx2 a[228:229], v11, s[40:43], 0 offen offset:64
    v_mfma_f32_32x32x8_bf16 v[76:91], v[102:103], v[46:47], v[76:91]
    v_exp_f32 v68, v68
    v_exp_f32 v69, v69
    v_exp_f32 v70, v70
    v_exp_f32 v71, v71
    v_exp_f32 v72, v72
    v_exp_f32 v73, v73
    v_smfmac_f32_32x32x32_bf16 a[0:15], v[112:115], v[60:67], v2
    v_exp_f32 v74, v74
    v_exp_f32 v75, v75
    v_exp_f32 v76, v76
    v_exp_f32 v77, v77
    v_smfmac_f32_32x32x32_bf16 a[0:15], v[116:119], v[68:75], v2
    v_exp_f32 v78, v78
    v_exp_f32 v79, v79
    buffer_load_dwordx2 a[230:231], v11, s[40:43], 0 offen offset:96
    v_exp_f32 v80, v80
    v_mfma_f32_32x32x16_bf16 v[60:75], v[98:101], v[20:23], 0
    buffer_load_dwordx2 a[232:233], v11, s[40:43], 0 offen offset:128
    v_exp_f32 v81, v81
    v_exp_f32 v82, v82
    v_exp_f32 v83, v83
    v_mfma_f32_32x32x8_bf16 v[60:75], v[102:103], v[48:49], v[60:75]
    v_exp_f32 v84, v84
    v_exp_f32 v85, v85
    v_exp_f32 v86, v86
    v_exp_f32 v87, v87
    v_exp_f32 v88, v88
    v_exp_f32 v89, v89
    v_smfmac_f32_32x32x32_bf16 a[16:31], v[112:115], v[76:83], v2
    v_exp_f32 v90, v90
    v_exp_f32 v91, v91
    v_exp_f32 v60, v60
    v_exp_f32 v61, v61
    v_smfmac_f32_32x32x32_bf16 a[16:31], v[116:119], v[84:91], v2
    v_exp_f32 v62, v62
    v_exp_f32 v63, v63
    ds_write_b128 v126, a[0:3] offset:0
    v_exp_f32 v64, v64
    v_mfma_f32_32x32x16_bf16 v[76:91], v[98:101], v[24:27], 0
    ds_write_b128 v126, a[4:7] offset:1024
    v_exp_f32 v65, v65
    v_exp_f32 v66, v66
    v_exp_f32 v67, v67
    ds_write_b128 v126, a[8:11] offset:2048
    v_mfma_f32_32x32x8_bf16 v[76:91], v[102:103], v[50:51], v[76:91]
    v_exp_f32 v68, v68
    v_exp_f32 v69, v69
    v_exp_f32 v70, v70
    v_exp_f32 v71, v71
    v_exp_f32 v72, v72
    v_exp_f32 v73, v73
    v_smfmac_f32_32x32x32_bf16 a[32:47], v[112:115], v[60:67], v2
    v_exp_f32 v74, v74
    v_exp_f32 v75, v75
    v_exp_f32 v76, v76
    v_exp_f32 v77, v77
    v_smfmac_f32_32x32x32_bf16 a[32:47], v[116:119], v[68:75], v2
    v_exp_f32 v78, v78
    v_exp_f32 v79, v79
    ds_write_b128 v126, a[16:19] offset:3072
    v_exp_f32 v80, v80
    v_mfma_f32_32x32x16_bf16 v[60:75], v[98:101], v[28:31], 0
    ds_write_b128 v126, a[20:23] offset:4096
    v_exp_f32 v81, v81
    v_exp_f32 v82, v82
    v_exp_f32 v83, v83
    ds_write_b128 v126, a[24:27] offset:5120
    v_mfma_f32_32x32x8_bf16 v[60:75], v[102:103], v[52:53], v[60:75]
    v_exp_f32 v84, v84
    v_exp_f32 v85, v85
    v_exp_f32 v86, v86
    v_exp_f32 v87, v87
    v_exp_f32 v88, v88
    v_exp_f32 v89, v89
    v_smfmac_f32_32x32x32_bf16 a[48:63], v[112:115], v[76:83], v2
    v_exp_f32 v90, v90
    v_exp_f32 v91, v91
    v_exp_f32 v60, v60
    v_exp_f32 v61, v61
    v_smfmac_f32_32x32x32_bf16 a[48:63], v[116:119], v[84:91], v2
    v_exp_f32 v62, v62
    v_exp_f32 v63, v63
    ds_write_b128 v126, a[32:35] offset:6144
    v_exp_f32 v64, v64
    v_mfma_f32_32x32x16_bf16 v[76:91], v[98:101], v[32:35], 0
    ds_write_b128 v126, a[36:39] offset:7168
    v_exp_f32 v65, v65
    v_exp_f32 v66, v66
    v_exp_f32 v67, v67
    ds_write_b128 v126, a[40:43] offset:8192
    v_mfma_f32_32x32x8_bf16 v[76:91], v[102:103], v[54:55], v[76:91]
    v_exp_f32 v68, v68
    v_exp_f32 v69, v69
    v_exp_f32 v70, v70
    v_exp_f32 v71, v71
    v_exp_f32 v72, v72
    v_exp_f32 v73, v73
    v_smfmac_f32_32x32x32_bf16 a[64:79], v[112:115], v[60:67], v2
    v_exp_f32 v74, v74
    v_exp_f32 v75, v75
    v_exp_f32 v76, v76
    v_exp_f32 v77, v77
    v_smfmac_f32_32x32x32_bf16 a[64:79], v[116:119], v[68:75], v2
    v_exp_f32 v78, v78
    v_exp_f32 v79, v79
    ds_write_b128 v126, a[48:51] offset:9216
    v_exp_f32 v80, v80
    v_mfma_f32_32x32x16_bf16 v[60:75], v[98:101], v[36:39], 0
    ds_write_b128 v126, a[52:55] offset:10240
    v_exp_f32 v81, v81
    v_exp_f32 v82, v82
    v_exp_f32 v83, v83
    ds_write_b128 v126, a[56:59] offset:11264
    v_mfma_f32_32x32x8_bf16 v[60:75], v[102:103], v[56:57], v[60:75]
    v_exp_f32 v84, v84
    v_exp_f32 v85, v85
    v_exp_f32 v86, v86
    v_exp_f32 v87, v87
    v_exp_f32 v88, v88
    v_exp_f32 v89, v89
    v_smfmac_f32_32x32x32_bf16 a[80:95], v[112:115], v[76:83], v2
    v_exp_f32 v90, v90
    v_exp_f32 v91, v91
    v_exp_f32 v60, v60
    v_exp_f32 v61, v61
    v_smfmac_f32_32x32x32_bf16 a[80:95], v[116:119], v[84:91], v2
    v_exp_f32 v62, v62
    v_exp_f32 v63, v63
    ds_write_b128 v126, a[64:67] offset:12288
    v_exp_f32 v64, v64
    v_mfma_f32_32x32x16_bf16 v[76:91], v[98:101], v[40:43], 0
    ds_write_b128 v126, a[68:71] offset:13312
    v_exp_f32 v65, v65
    v_exp_f32 v66, v66
    v_exp_f32 v67, v67
    ds_write_b128 v126, a[72:75] offset:14336
    v_mfma_f32_32x32x8_bf16 v[76:91], v[102:103], v[58:59], v[76:91]
    v_exp_f32 v68, v68
    v_exp_f32 v69, v69
    v_exp_f32 v70, v70
    v_exp_f32 v71, v71
    v_exp_f32 v72, v72
    v_exp_f32 v73, v73
    v_smfmac_f32_32x32x32_bf16 a[96:111], v[112:115], v[60:67], v2
    v_exp_f32 v74, v74
    v_exp_f32 v75, v75
    v_exp_f32 v76, v76
    v_exp_f32 v77, v77
    v_smfmac_f32_32x32x32_bf16 a[96:111], v[116:119], v[68:75], v2
    v_exp_f32 v78, v78
    v_exp_f32 v79, v79
    ds_write_b128 v126, a[80:83] offset:15360
    v_exp_f32 v80, v80
    ds_write_b128 v126, a[84:87] offset:16384
    v_exp_f32 v81, v81
    v_exp_f32 v82, v82
    v_exp_f32 v83, v83
    ds_write_b128 v126, a[88:91] offset:17408
    v_exp_f32 v84, v84
    v_exp_f32 v85, v85
    v_exp_f32 v86, v86
    v_exp_f32 v87, v87
    v_exp_f32 v88, v88
    v_exp_f32 v89, v89
    v_smfmac_f32_32x32x32_bf16 a[112:127], v[112:115], v[76:83], v2
    v_exp_f32 v90, v90
    v_exp_f32 v91, v91
    s_nop 1
    v_smfmac_f32_32x32x32_bf16 a[112:127], v[116:119], v[84:91], v2
    ds_write_b128 v126, a[96:99] offset:18432
    ds_write_b128 v126, a[100:103] offset:19456
    ds_write_b128 v126, a[104:107] offset:20480
    s_mul_i32 s16, s10, 6144
    v_add_u32 v5, s16, v3
    v_add_u32 v6, 49152, v5
    s_nop 9
    ds_write_b128 v126, a[112:115] offset:21504
    ds_write_b128 v126, a[116:119] offset:22528
    ds_write_b128 v126, a[120:123] offset:23552
    s_waitcnt lgkmcnt(0)
    s_barrier
    ds_read_b128 v[12:15], v5 offset:0
    ds_read_b128 v[16:19], v5 offset:1024
    ds_read_b128 v[20:23], v5 offset:2048
    ds_read_b128 v[24:27], v5 offset:3072
    ds_read_b128 v[28:31], v5 offset:4096
    ds_read_b128 v[32:35], v5 offset:5120
    ds_read_b128 v[36:39], v5 offset:24576
    ds_read_b128 v[40:43], v5 offset:25600
    ds_read_b128 v[44:47], v5 offset:26624
    ds_read_b128 v[48:51], v5 offset:27648
    ds_read_b128 v[52:55], v5 offset:28672
    ds_read_b128 v[56:59], v5 offset:29696
    ds_read_b128 v[60:63], v6 offset:0
    ds_read_b128 v[64:67], v6 offset:1024
    ds_read_b128 v[68:71], v6 offset:2048
    ds_read_b128 v[72:75], v6 offset:3072
    ds_read_b128 v[76:79], v6 offset:4096
    ds_read_b128 v[80:83], v6 offset:5120
    ds_read_b128 v[84:87], v6 offset:24576
    ds_read_b128 v[88:91], v6 offset:25600
    ds_read_b128 v[92:95], v6 offset:26624
    ds_read_b128 v[96:99], v6 offset:27648
    ds_read_b128 v[100:103], v6 offset:28672
    ds_read_b128 v[104:107], v6 offset:29696
    s_waitcnt lgkmcnt(12)
    v_pk_add_f32 v[12:13], v[12:13], v[36:37]
    v_pk_add_f32 v[14:15], v[14:15], v[38:39]
    v_pk_add_f32 v[16:17], v[16:17], v[40:41]
    v_pk_add_f32 v[18:19], v[18:19], v[42:43]
    v_pk_add_f32 v[20:21], v[20:21], v[44:45]
    v_pk_add_f32 v[22:23], v[22:23], v[46:47]
    v_pk_add_f32 v[24:25], v[24:25], v[48:49]
    v_pk_add_f32 v[26:27], v[26:27], v[50:51]
    v_pk_add_f32 v[28:29], v[28:29], v[52:53]
    v_pk_add_f32 v[30:31], v[30:31], v[54:55]
    v_pk_add_f32 v[32:33], v[32:33], v[56:57]
    v_pk_add_f32 v[34:35], v[34:35], v[58:59]
    s_waitcnt lgkmcnt(0)
    s_barrier
    s_add_u32 m0, s53, 0
    v_pk_add_f32 v[60:61], v[60:61], v[84:85]
    buffer_load_dwordx4 v3, s[4:7], s51 offen lds
    v_pk_add_f32 v[62:63], v[62:63], v[86:87]
    v_pk_add_f32 v[64:65], v[64:65], v[88:89]
    buffer_load_dwordx4 v3, s[4:7], s51 offen offset:1024 lds
    v_pk_add_f32 v[66:67], v[66:67], v[90:91]
    v_pk_add_f32 v[68:69], v[68:69], v[92:93]
    buffer_load_dwordx4 v3, s[4:7], s51 offen offset:2048 lds
    v_pk_add_f32 v[70:71], v[70:71], v[94:95]
    v_pk_add_f32 v[72:73], v[72:73], v[96:97]
    buffer_load_dwordx4 v3, s[4:7], s51 offen offset:3072 lds
    v_pk_add_f32 v[74:75], v[74:75], v[98:99]
    s_add_u32 s60, s51, 4096
    s_add_u32 m0, s53, 4096
    v_pk_add_f32 v[76:77], v[76:77], v[100:101]
    buffer_load_dwordx4 v3, s[4:7], s60 offen lds
    v_pk_add_f32 v[78:79], v[78:79], v[102:103]
    v_pk_add_f32 v[80:81], v[80:81], v[104:105]
    v_pk_add_f32 v[82:83], v[82:83], v[106:107]
    s_add_u32 s51, s51, 20480
    v_pk_add_f32 v[12:13], v[12:13], v[60:61]
    v_pk_add_f32 v[14:15], v[14:15], v[62:63]
    v_pk_add_f32 v[16:17], v[16:17], v[64:65]
    v_pk_add_f32 v[18:19], v[18:19], v[66:67]
    v_pk_add_f32 v[20:21], v[20:21], v[68:69]
    v_pk_add_f32 v[22:23], v[22:23], v[70:71]
    v_pk_add_f32 v[24:25], v[24:25], v[72:73]
    v_pk_add_f32 v[26:27], v[26:27], v[74:75]
    v_pk_add_f32 v[28:29], v[28:29], v[76:77]
    v_pk_add_f32 v[30:31], v[30:31], v[78:79]
    v_pk_add_f32 v[32:33], v[32:33], v[80:81]
    v_pk_add_f32 v[34:35], v[34:35], v[82:83]
    v_mov_b32 v6, v20
    v_mov_b32 v8, v20
    v_mov_b32 v7, v32
    v_mov_b32 v9, v32
    s_nop 0
    v_permlane32_swap_b32 v8, v6
    v_permlane32_swap_b32 v9, v7
    s_nop 0
    v_rcp_f32 v6, v6
    v_rcp_f32 v7, v7
    s_nop 0
    v_mul_f32 v12, v12, v6
    v_mul_f32 v13, v13, v6
    v_mul_f32 v14, v14, v6
    v_mul_f32 v15, v15, v6
    v_mul_f32 v16, v16, v6
    v_mul_f32 v17, v17, v6
    v_mul_f32 v18, v18, v6
    v_mul_f32 v19, v19, v6
    v_mul_f32 v20, v20, v6
    v_mul_f32 v21, v21, v6
    v_mul_f32 v22, v22, v6
    v_mul_f32 v23, v23, v6
    v_cvt_pk_bf16_f32 v12, v12, v13
    v_cvt_pk_bf16_f32 v13, v14, v15
    ds_write_b64 v120, v[12:13]
    v_cvt_pk_bf16_f32 v16, v16, v17
    v_cvt_pk_bf16_f32 v17, v18, v19
    ds_write_b64 v121, v[16:17]
    v_cvt_pk_bf16_f32 v20, v20, v21
    v_cvt_pk_bf16_f32 v21, v22, v23
    ds_write_b64 v122, v[20:21]
    v_mul_f32 v24, v24, v7
    v_mul_f32 v25, v25, v7
    v_mul_f32 v26, v26, v7
    v_mul_f32 v27, v27, v7
    v_mul_f32 v28, v28, v7
    v_mul_f32 v29, v29, v7
    v_mul_f32 v30, v30, v7
    v_mul_f32 v31, v31, v7
    v_mul_f32 v32, v32, v7
    v_mul_f32 v33, v33, v7
    v_mul_f32 v34, v34, v7
    v_mul_f32 v35, v35, v7
    v_cvt_pk_bf16_f32 v24, v24, v25
    v_cvt_pk_bf16_f32 v25, v26, v27
    ds_write_b64 v123, v[24:25]
    v_cvt_pk_bf16_f32 v28, v28, v29
    v_cvt_pk_bf16_f32 v29, v30, v31
    ds_write_b64 v124, v[28:29]
    v_cvt_pk_bf16_f32 v32, v32, v33
    v_cvt_pk_bf16_f32 v33, v34, v35
    ds_write_b64 v125, v[32:33]
    s_lshl_b32 s61, s10, 10
    s_add_u32 s61, s61, 81920
    v_add_u32 v5, s61, v3
    s_waitcnt lgkmcnt(0)
    s_barrier
    ds_read_b128 v[52:55], v5 offset:0
    ds_read_b128 v[56:59], v5 offset:4096
    ds_read_b128 v[60:63], v5 offset:8192
    s_lshl_b32 s16, s8, 1
    s_mul_i32 s16, s16, 75776
    s_mul_i32 s17, s9, 5
    s_add_u32 s17, s17, 54
    s_lshl_b32 s17, s17, 10
    s_add_u32 s16, s16, s17
    s_add_u32 s16, s16, 2883584
    s_add_u32 s17, s10, 0
    s_cmp_ge_u32 s17, 5
    s_cselect_b32 s18, 70656, 0
    s_lshl_b32 s19, s17, 10
    s_add_u32 s18, s18, s19
    s_add_u32 s20, s16, s18
    s_add_u32 s17, s10, 4
    s_cmp_ge_u32 s17, 5
    s_cselect_b32 s18, 70656, 0
    s_lshl_b32 s19, s17, 10
    s_add_u32 s18, s18, s19
    s_add_u32 s21, s16, s18
    s_add_u32 s17, s10, 8
    s_cmp_ge_u32 s17, 5
    s_cselect_b32 s18, 70656, 0
    s_lshl_b32 s19, s17, 10
    s_add_u32 s18, s18, s19
    s_add_u32 s22, s16, s18
    s_cmp_ge_u32 s17, 10
    s_cselect_b32 s22, 2147418112, s22
    s_waitcnt lgkmcnt(0)
    buffer_store_dwordx4 v[52:55], v3, s[4:7], s20 offen sc1
    buffer_store_dwordx4 v[56:59], v3, s[4:7], s21 offen sc1
    buffer_store_dwordx4 v[60:63], v3, s[4:7], s22 offen sc1
    s_mul_i32 s61, s58, 10240
    v_add_u32 v5, s61, v3
    v_add_u32 v92, 98304, v5
    v_add_u32 v93, 118784, v5
    v_add_u32 v94, 139264, v5
    v_add_u32 v95, 0, v5
    v_add_u32 v96, 20480, v5
    v_add_u32 v97, 40960, v5
    v_add_u32 v98, 61440, v5
    v_and_b32 v100, 7, v1
    v_lshlrev_b32 v100, 2, v100
    s_lshl_b32 s61, s49, 2
    s_cmp_eq_u32 s10, 0
    s_cselect_b32 s61, s61, 2147418112
    v_mov_b32 v102, 2147418112
    v_mov_b32 v103, s61
    v_cmp_eq_u32 vcc, 0, v1
    s_mul_i32 s61, s10, 5120
    v_add_u32 v104, s61, v3
    v_cndmask_b32 v102, v102, v103, vcc
    s_xor_b32 s61, s10, 1
    s_mul_i32 s61, s61, 5120
    v_add_u32 v105, s61, v3
    v_mov_b32 v103, 1
    s_mul_i32 s61, s10, 5120
    s_add_u32 s61, s61, 61440
    v_add_u32 v126, s61, v3
    s_xor_b32 s61, s10, 1
    s_mul_i32 s61, s61, 5120
    s_add_u32 s61, s61, 61440
    v_add_u32 v127, s61, v3
    s_waitcnt vmcnt(8) lgkmcnt(0)
    s_barrier
    ds_read_b128 v[12:15], v92 offset:0
    s_add_u32 m0, s53, 20480
    s_nop 0
    buffer_load_dwordx4 v3, s[4:7], s51 offen lds
    ds_read_b128 v[16:19], v92 offset:1024
    ds_read_b128 v[20:23], v92 offset:2048
    ds_read_b128 v[24:27], v92 offset:3072
    buffer_load_dwordx4 v3, s[4:7], s51 offen offset:1024 lds
    ds_read_b128 v[28:31], v92 offset:4096
    ds_read_b128 v[32:35], v92 offset:5120
    ds_read_b128 v[36:39], v92 offset:6144
    buffer_load_dwordx4 v3, s[4:7], s51 offen offset:2048 lds
    ds_read_b128 v[40:43], v92 offset:7168
    ds_read_b128 v[44:47], v92 offset:8192
    ds_read_b128 v[48:51], v92 offset:9216
    buffer_load_dwordx4 v3, s[4:7], s51 offen offset:3072 lds
    s_add_u32 s60, s51, 4096
    s_add_u32 m0, s53, 24576
    s_nop 0
    buffer_load_dwordx4 v3, s[4:7], s60 offen lds
    s_add_u32 s51, s51, 20480
    s_add_u32 m0, s53, 40960
    s_nop 0
    buffer_load_dwordx4 v3, s[4:7], s51 offen lds
    s_waitcnt lgkmcnt(0)
    s_barrier
    v_mfma_f32_16x16x32_bf16 a[0:3], v[12:15], v[128:131], 0
    ds_read_b128 v[52:55], v93 offset:0
    v_mfma_f32_16x16x32_bf16 a[20:23], v[12:15], v[136:139], 0
    buffer_load_dwordx4 v3, s[4:7], s51 offen offset:1024 lds
    ds_read_b128 v[56:59], v93 offset:1024
    v_mfma_f32_16x16x32_bf16 a[4:7], v[16:19], v[128:131], 0
    ds_read_b128 v[60:63], v93 offset:2048
    v_mfma_f32_16x16x32_bf16 a[24:27], v[16:19], v[136:139], 0
    ds_read_b128 v[64:67], v93 offset:3072
    v_mfma_f32_16x16x32_bf16 a[8:11], v[20:23], v[128:131], 0
    buffer_load_dwordx4 v3, s[4:7], s51 offen offset:2048 lds
    ds_read_b128 v[68:71], v93 offset:4096
    v_mfma_f32_16x16x32_bf16 a[28:31], v[20:23], v[136:139], 0
    ds_read_b128 v[72:75], v93 offset:5120
    v_mfma_f32_16x16x32_bf16 a[12:15], v[24:27], v[128:131], 0
    ds_read_b128 v[76:79], v93 offset:6144
    v_mfma_f32_16x16x32_bf16 a[32:35], v[24:27], v[136:139], 0
    buffer_load_dwordx4 v3, s[4:7], s51 offen offset:3072 lds
    ds_read_b128 v[80:83], v93 offset:7168
    v_mfma_f32_16x16x32_bf16 a[16:19], v[28:31], v[128:131], 0
    ds_read_b128 v[84:87], v93 offset:8192
    v_mfma_f32_16x16x32_bf16 a[36:39], v[28:31], v[136:139], 0
    ds_read_b128 v[88:91], v93 offset:9216
    s_add_u32 s60, s51, 4096
    s_add_u32 m0, s53, 45056
    v_mfma_f32_16x16x32_bf16 a[0:3], v[32:35], v[132:135], a[0:3]
    buffer_load_dwordx4 v3, s[4:7], s60 offen lds
    s_add_u32 s51, s51, 20480
    v_mfma_f32_16x16x32_bf16 a[20:23], v[32:35], v[140:143], a[20:23]
    v_mfma_f32_16x16x32_bf16 a[4:7], v[36:39], v[132:135], a[4:7]
    s_add_u32 m0, s53, 61440
    v_mfma_f32_16x16x32_bf16 a[24:27], v[36:39], v[140:143], a[24:27]
    buffer_load_dwordx4 v3, s[4:7], s51 offen lds
    v_mfma_f32_16x16x32_bf16 a[8:11], v[40:43], v[132:135], a[8:11]
    v_mfma_f32_16x16x32_bf16 a[28:31], v[40:43], v[140:143], a[28:31]
    v_mfma_f32_16x16x32_bf16 a[12:15], v[44:47], v[132:135], a[12:15]
    buffer_load_dwordx4 v3, s[4:7], s51 offen offset:1024 lds
    v_mfma_f32_16x16x32_bf16 a[32:35], v[44:47], v[140:143], a[32:35]
    v_mfma_f32_16x16x32_bf16 a[16:19], v[48:51], v[132:135], a[16:19]
    v_mfma_f32_16x16x32_bf16 a[36:39], v[48:51], v[140:143], a[36:39]
    s_waitcnt lgkmcnt(0)
    s_barrier
    v_mfma_f32_16x16x32_bf16 a[0:3], v[52:55], v[144:147], a[0:3]
    ds_read_b128 v[12:15], v94 offset:0
    v_mfma_f32_16x16x32_bf16 a[20:23], v[52:55], v[152:155], a[20:23]
    buffer_load_dwordx4 v3, s[4:7], s51 offen offset:2048 lds
    ds_read_b128 v[16:19], v94 offset:1024
    v_mfma_f32_16x16x32_bf16 a[4:7], v[56:59], v[144:147], a[4:7]
    ds_read_b128 v[20:23], v94 offset:2048
    v_mfma_f32_16x16x32_bf16 a[24:27], v[56:59], v[152:155], a[24:27]
    ds_read_b128 v[24:27], v94 offset:3072
    v_mfma_f32_16x16x32_bf16 a[8:11], v[60:63], v[144:147], a[8:11]
    buffer_load_dwordx4 v3, s[4:7], s51 offen offset:3072 lds
    ds_read_b128 v[28:31], v94 offset:4096
    v_mfma_f32_16x16x32_bf16 a[28:31], v[60:63], v[152:155], a[28:31]
    ds_read_b128 v[32:35], v94 offset:5120
    v_mfma_f32_16x16x32_bf16 a[12:15], v[64:67], v[144:147], a[12:15]
    ds_read_b128 v[36:39], v94 offset:6144
    s_add_u32 s60, s51, 4096
    s_add_u32 m0, s53, 65536
    v_mfma_f32_16x16x32_bf16 a[32:35], v[64:67], v[152:155], a[32:35]
    buffer_load_dwordx4 v3, s[4:7], s60 offen lds
    s_add_u32 s51, s51, 20480
    ds_read_b128 v[40:43], v94 offset:7168
    v_mfma_f32_16x16x32_bf16 a[16:19], v[68:71], v[144:147], a[16:19]
    ds_read_b128 v[44:47], v94 offset:8192
    v_mfma_f32_16x16x32_bf16 a[36:39], v[68:71], v[152:155], a[36:39]
    ds_read_b128 v[48:51], v94 offset:9216
    s_add_u32 m0, s53, 98304
    v_mfma_f32_16x16x32_bf16 a[0:3], v[72:75], v[148:151], a[0:3]
    buffer_load_dwordx4 v3, s[4:7], s51 offen lds
    v_mfma_f32_16x16x32_bf16 a[20:23], v[72:75], v[156:159], a[20:23]
    v_mfma_f32_16x16x32_bf16 a[4:7], v[76:79], v[148:151], a[4:7]
    v_mfma_f32_16x16x32_bf16 a[24:27], v[76:79], v[156:159], a[24:27]
    buffer_load_dwordx4 v3, s[4:7], s51 offen offset:1024 lds
    v_mfma_f32_16x16x32_bf16 a[8:11], v[80:83], v[148:151], a[8:11]
    v_mfma_f32_16x16x32_bf16 a[28:31], v[80:83], v[156:159], a[28:31]
    v_mfma_f32_16x16x32_bf16 a[12:15], v[84:87], v[148:151], a[12:15]
    buffer_load_dwordx4 v3, s[4:7], s51 offen offset:2048 lds
    v_mfma_f32_16x16x32_bf16 a[32:35], v[84:87], v[156:159], a[32:35]
    v_mfma_f32_16x16x32_bf16 a[16:19], v[88:91], v[148:151], a[16:19]
    v_mfma_f32_16x16x32_bf16 a[36:39], v[88:91], v[156:159], a[36:39]
    s_waitcnt vmcnt(18) lgkmcnt(0)
    s_barrier
    buffer_store_dword v103, v102, s[4:7], s55 offen sc1
    v_mfma_f32_16x16x32_bf16 a[0:3], v[12:15], v[160:163], a[0:3]
    ds_read_b128 v[52:55], v95 offset:0
    v_mfma_f32_16x16x32_bf16 a[20:23], v[12:15], v[168:171], a[20:23]
    buffer_load_dwordx4 v3, s[4:7], s51 offen offset:3072 lds
    ds_read_b128 v[56:59], v95 offset:1024
    v_mfma_f32_16x16x32_bf16 a[4:7], v[16:19], v[160:163], a[4:7]
    ds_read_b128 v[60:63], v95 offset:2048
    v_mfma_f32_16x16x32_bf16 a[24:27], v[16:19], v[168:171], a[24:27]
    ds_read_b128 v[64:67], v95 offset:3072
    s_add_u32 s60, s51, 4096
    s_add_u32 m0, s53, 102400
    v_mfma_f32_16x16x32_bf16 a[8:11], v[20:23], v[160:163], a[8:11]
    buffer_load_dwordx4 v3, s[4:7], s60 offen lds
    s_add_u32 s51, s51, 20480
    ds_read_b128 v[68:71], v95 offset:4096
    v_mfma_f32_16x16x32_bf16 a[28:31], v[20:23], v[168:171], a[28:31]
    ds_read_b128 v[72:75], v95 offset:5120
    v_mfma_f32_16x16x32_bf16 a[12:15], v[24:27], v[160:163], a[12:15]
    ds_read_b128 v[76:79], v95 offset:6144
    s_add_u32 m0, s53, 118784
    v_mfma_f32_16x16x32_bf16 a[32:35], v[24:27], v[168:171], a[32:35]
    buffer_load_dwordx4 v3, s[4:7], s51 offen lds
    ds_read_b128 v[80:83], v95 offset:7168
    v_mfma_f32_16x16x32_bf16 a[16:19], v[28:31], v[160:163], a[16:19]
    ds_read_b128 v[84:87], v95 offset:8192
    v_mfma_f32_16x16x32_bf16 a[36:39], v[28:31], v[168:171], a[36:39]
    ds_read_b128 v[88:91], v95 offset:9216
    v_mfma_f32_16x16x32_bf16 a[0:3], v[32:35], v[164:167], a[0:3]
    buffer_load_dwordx4 v3, s[4:7], s51 offen offset:1024 lds
    v_mfma_f32_16x16x32_bf16 a[20:23], v[32:35], v[172:175], a[20:23]
    v_mfma_f32_16x16x32_bf16 a[4:7], v[36:39], v[164:167], a[4:7]
    v_mfma_f32_16x16x32_bf16 a[24:27], v[36:39], v[172:175], a[24:27]
    buffer_load_dwordx4 v3, s[4:7], s51 offen offset:2048 lds
    v_mfma_f32_16x16x32_bf16 a[8:11], v[40:43], v[164:167], a[8:11]
    v_mfma_f32_16x16x32_bf16 a[28:31], v[40:43], v[172:175], a[28:31]
    v_mfma_f32_16x16x32_bf16 a[12:15], v[44:47], v[164:167], a[12:15]
    buffer_load_dwordx4 v3, s[4:7], s51 offen offset:3072 lds
    v_mfma_f32_16x16x32_bf16 a[32:35], v[44:47], v[172:175], a[32:35]
    v_mfma_f32_16x16x32_bf16 a[16:19], v[48:51], v[164:167], a[16:19]
    v_mfma_f32_16x16x32_bf16 a[36:39], v[48:51], v[172:175], a[36:39]
    s_waitcnt vmcnt(20) lgkmcnt(0)
    s_barrier
    v_mfma_f32_16x16x32_bf16 a[0:3], v[52:55], v[176:179], a[0:3]
    ds_read_b128 v[12:15], v96 offset:0
    s_add_u32 s60, s51, 4096
    s_add_u32 m0, s53, 122880
    v_mfma_f32_16x16x32_bf16 a[20:23], v[52:55], v[184:187], a[20:23]
    buffer_load_dwordx4 v3, s[4:7], s60 offen lds
    s_add_u32 s51, s51, 20480
    ds_read_b128 v[16:19], v96 offset:1024
    v_mfma_f32_16x16x32_bf16 a[4:7], v[56:59], v[176:179], a[4:7]
    ds_read_b128 v[20:23], v96 offset:2048
    v_mfma_f32_16x16x32_bf16 a[24:27], v[56:59], v[184:187], a[24:27]
    ds_read_b128 v[24:27], v96 offset:3072
    s_add_u32 m0, s53, 139264
    v_mfma_f32_16x16x32_bf16 a[8:11], v[60:63], v[176:179], a[8:11]
    buffer_load_dwordx4 v3, s[4:7], s51 offen lds
    ds_read_b128 v[28:31], v96 offset:4096
    v_mfma_f32_16x16x32_bf16 a[28:31], v[60:63], v[184:187], a[28:31]
    ds_read_b128 v[32:35], v96 offset:5120
    v_mfma_f32_16x16x32_bf16 a[12:15], v[64:67], v[176:179], a[12:15]
    ds_read_b128 v[36:39], v96 offset:6144
    v_mfma_f32_16x16x32_bf16 a[32:35], v[64:67], v[184:187], a[32:35]
    buffer_load_dwordx4 v3, s[4:7], s51 offen offset:1024 lds
    ds_read_b128 v[40:43], v96 offset:7168
    v_mfma_f32_16x16x32_bf16 a[16:19], v[68:71], v[176:179], a[16:19]
    ds_read_b128 v[44:47], v96 offset:8192
    v_mfma_f32_16x16x32_bf16 a[36:39], v[68:71], v[184:187], a[36:39]
    ds_read_b128 v[48:51], v96 offset:9216
    v_mfma_f32_16x16x32_bf16 a[0:3], v[72:75], v[180:183], a[0:3]
    buffer_load_dwordx4 v3, s[4:7], s51 offen offset:2048 lds
    v_mfma_f32_16x16x32_bf16 a[20:23], v[72:75], v[188:191], a[20:23]
    v_mfma_f32_16x16x32_bf16 a[4:7], v[76:79], v[180:183], a[4:7]
    v_mfma_f32_16x16x32_bf16 a[24:27], v[76:79], v[188:191], a[24:27]
    buffer_load_dwordx4 v3, s[4:7], s51 offen offset:3072 lds
    v_mfma_f32_16x16x32_bf16 a[8:11], v[80:83], v[180:183], a[8:11]
    v_mfma_f32_16x16x32_bf16 a[28:31], v[80:83], v[188:191], a[28:31]
    s_add_u32 s60, s51, 4096
    s_add_u32 m0, s53, 143360
    v_mfma_f32_16x16x32_bf16 a[12:15], v[84:87], v[180:183], a[12:15]
    buffer_load_dwordx4 v3, s[4:7], s60 offen lds
    s_add_u32 s51, s51, 20480
    v_mfma_f32_16x16x32_bf16 a[32:35], v[84:87], v[188:191], a[32:35]
    v_mfma_f32_16x16x32_bf16 a[16:19], v[88:91], v[180:183], a[16:19]
    v_mfma_f32_16x16x32_bf16 a[36:39], v[88:91], v[188:191], a[36:39]
    s_waitcnt vmcnt(21) lgkmcnt(0)
    s_barrier
    v_mfma_f32_16x16x32_bf16 a[0:3], v[12:15], v[192:195], a[0:3]
    ds_read_b128 v[52:55], v97 offset:0
    s_add_u32 m0, s53, 0
    v_mfma_f32_16x16x32_bf16 a[20:23], v[12:15], v[200:203], a[20:23]
    buffer_load_dwordx4 v3, s[4:7], s51 offen lds
    ds_read_b128 v[56:59], v97 offset:1024
    v_mfma_f32_16x16x32_bf16 a[4:7], v[16:19], v[192:195], a[4:7]
    ds_read_b128 v[60:63], v97 offset:2048
    v_mfma_f32_16x16x32_bf16 a[24:27], v[16:19], v[200:203], a[24:27]
    ds_read_b128 v[64:67], v97 offset:3072
    v_mfma_f32_16x16x32_bf16 a[8:11], v[20:23], v[192:195], a[8:11]
    buffer_load_dwordx4 v3, s[4:7], s51 offen offset:1024 lds
    ds_read_b128 v[68:71], v97 offset:4096
    v_mfma_f32_16x16x32_bf16 a[28:31], v[20:23], v[200:203], a[28:31]
    ds_read_b128 v[72:75], v97 offset:5120
    v_mfma_f32_16x16x32_bf16 a[12:15], v[24:27], v[192:195], a[12:15]
    ds_read_b128 v[76:79], v97 offset:6144
    v_mfma_f32_16x16x32_bf16 a[32:35], v[24:27], v[200:203], a[32:35]
    buffer_load_dwordx4 v3, s[4:7], s51 offen offset:2048 lds
    ds_read_b128 v[80:83], v97 offset:7168
    v_mfma_f32_16x16x32_bf16 a[16:19], v[28:31], v[192:195], a[16:19]
    ds_read_b128 v[84:87], v97 offset:8192
    v_mfma_f32_16x16x32_bf16 a[36:39], v[28:31], v[200:203], a[36:39]
    ds_read_b128 v[88:91], v97 offset:9216
    v_mfma_f32_16x16x32_bf16 a[0:3], v[32:35], v[196:199], a[0:3]
    buffer_load_dwordx4 v3, s[4:7], s51 offen offset:3072 lds
    v_mfma_f32_16x16x32_bf16 a[20:23], v[32:35], v[204:207], a[20:23]
    v_mfma_f32_16x16x32_bf16 a[4:7], v[36:39], v[196:199], a[4:7]
    s_add_u32 s60, s51, 4096
    s_add_u32 m0, s53, 4096
    v_mfma_f32_16x16x32_bf16 a[24:27], v[36:39], v[204:207], a[24:27]
    buffer_load_dwordx4 v3, s[4:7], s60 offen lds
    s_add_u32 s51, s51, 20480
    v_mfma_f32_16x16x32_bf16 a[8:11], v[40:43], v[196:199], a[8:11]
    v_mfma_f32_16x16x32_bf16 a[28:31], v[40:43], v[204:207], a[28:31]
    s_add_u32 m0, s53, 20480
    v_mfma_f32_16x16x32_bf16 a[12:15], v[44:47], v[196:199], a[12:15]
    buffer_load_dwordx4 v3, s[4:7], s51 offen lds
    v_mfma_f32_16x16x32_bf16 a[32:35], v[44:47], v[204:207], a[32:35]
    v_mfma_f32_16x16x32_bf16 a[16:19], v[48:51], v[196:199], a[16:19]
    v_mfma_f32_16x16x32_bf16 a[36:39], v[48:51], v[204:207], a[36:39]
    s_waitcnt vmcnt(22) lgkmcnt(0)
    s_barrier
    v_mfma_f32_16x16x32_bf16 a[0:3], v[52:55], v[208:211], a[0:3]
    ds_read_b128 v[12:15], v98 offset:0
    v_mfma_f32_16x16x32_bf16 a[20:23], v[52:55], v[216:219], a[20:23]
    buffer_load_dwordx4 v3, s[4:7], s51 offen offset:1024 lds
    ds_read_b128 v[16:19], v98 offset:1024
    v_mfma_f32_16x16x32_bf16 a[4:7], v[56:59], v[208:211], a[4:7]
    ds_read_b128 v[20:23], v98 offset:2048
    v_mfma_f32_16x16x32_bf16 a[24:27], v[56:59], v[216:219], a[24:27]
    ds_read_b128 v[24:27], v98 offset:3072
    v_mfma_f32_16x16x32_bf16 a[8:11], v[60:63], v[208:211], a[8:11]
    buffer_load_dwordx4 v3, s[4:7], s51 offen offset:2048 lds
    ds_read_b128 v[28:31], v98 offset:4096
    v_mfma_f32_16x16x32_bf16 a[28:31], v[60:63], v[216:219], a[28:31]
    ds_read_b128 v[32:35], v98 offset:5120
    v_mfma_f32_16x16x32_bf16 a[12:15], v[64:67], v[208:211], a[12:15]
    ds_read_b128 v[36:39], v98 offset:6144
    v_mfma_f32_16x16x32_bf16 a[32:35], v[64:67], v[216:219], a[32:35]
    buffer_load_dwordx4 v3, s[4:7], s51 offen offset:3072 lds
    ds_read_b128 v[40:43], v98 offset:7168
    v_mfma_f32_16x16x32_bf16 a[16:19], v[68:71], v[208:211], a[16:19]
    ds_read_b128 v[44:47], v98 offset:8192
    v_mfma_f32_16x16x32_bf16 a[36:39], v[68:71], v[216:219], a[36:39]
    ds_read_b128 v[48:51], v98 offset:9216
    s_add_u32 s60, s51, 4096
    s_add_u32 m0, s53, 24576
    v_mfma_f32_16x16x32_bf16 a[0:3], v[72:75], v[212:215], a[0:3]
    buffer_load_dwordx4 v3, s[4:7], s60 offen lds
    s_add_u32 s51, s51, 20480
    v_mfma_f32_16x16x32_bf16 a[20:23], v[72:75], v[220:223], a[20:23]
    v_mfma_f32_16x16x32_bf16 a[4:7], v[76:79], v[212:215], a[4:7]
    s_add_u32 m0, s53, 40960
    v_mfma_f32_16x16x32_bf16 a[24:27], v[76:79], v[220:223], a[24:27]
    buffer_load_dwordx4 v3, s[4:7], s51 offen lds
    v_mfma_f32_16x16x32_bf16 a[8:11], v[80:83], v[212:215], a[8:11]
    v_mfma_f32_16x16x32_bf16 a[28:31], v[80:83], v[220:223], a[28:31]
    v_mfma_f32_16x16x32_bf16 a[12:15], v[84:87], v[212:215], a[12:15]
    buffer_load_dwordx4 v3, s[4:7], s51 offen offset:1024 lds
    v_mfma_f32_16x16x32_bf16 a[32:35], v[84:87], v[220:223], a[32:35]
    v_mfma_f32_16x16x32_bf16 a[16:19], v[88:91], v[212:215], a[16:19]
    v_mfma_f32_16x16x32_bf16 a[36:39], v[88:91], v[220:223], a[36:39]
    s_waitcnt vmcnt(22) lgkmcnt(0)
    s_barrier
    v_mfma_f32_16x16x32_bf16 a[0:3], v[12:15], v[224:227], a[0:3]
    ds_read_b128 v[52:55], v92 offset:0
    v_mfma_f32_16x16x32_bf16 a[20:23], v[12:15], v[232:235], a[20:23]
    buffer_load_dwordx4 v3, s[4:7], s51 offen offset:2048 lds
    ds_read_b128 v[56:59], v92 offset:1024
    v_mfma_f32_16x16x32_bf16 a[4:7], v[16:19], v[224:227], a[4:7]
    ds_read_b128 v[60:63], v92 offset:2048
    v_mfma_f32_16x16x32_bf16 a[24:27], v[16:19], v[232:235], a[24:27]
    ds_read_b128 v[64:67], v92 offset:3072
    v_mfma_f32_16x16x32_bf16 a[8:11], v[20:23], v[224:227], a[8:11]
    buffer_load_dwordx4 v3, s[4:7], s51 offen offset:3072 lds
    ds_read_b128 v[68:71], v92 offset:4096
    v_mfma_f32_16x16x32_bf16 a[28:31], v[20:23], v[232:235], a[28:31]
    ds_read_b128 v[72:75], v92 offset:5120
    v_mfma_f32_16x16x32_bf16 a[12:15], v[24:27], v[224:227], a[12:15]
    ds_read_b128 v[76:79], v92 offset:6144
    s_add_u32 s60, s51, 4096
    s_add_u32 m0, s53, 45056
    v_mfma_f32_16x16x32_bf16 a[32:35], v[24:27], v[232:235], a[32:35]
    buffer_load_dwordx4 v3, s[4:7], s60 offen lds
    s_add_u32 s51, s51, 20480
    ds_read_b128 v[80:83], v92 offset:7168
    v_mfma_f32_16x16x32_bf16 a[16:19], v[28:31], v[224:227], a[16:19]
    ds_read_b128 v[84:87], v92 offset:8192
    v_mfma_f32_16x16x32_bf16 a[36:39], v[28:31], v[232:235], a[36:39]
    ds_read_b128 v[88:91], v92 offset:9216
    s_add_u32 m0, s53, 61440
    v_mfma_f32_16x16x32_bf16 a[0:3], v[32:35], v[228:231], a[0:3]
    buffer_load_dwordx4 v3, s[4:7], s51 offen lds
    v_mfma_f32_16x16x32_bf16 a[20:23], v[32:35], v[236:239], a[20:23]
    v_mfma_f32_16x16x32_bf16 a[4:7], v[36:39], v[228:231], a[4:7]
    v_mfma_f32_16x16x32_bf16 a[24:27], v[36:39], v[236:239], a[24:27]
    buffer_load_dwordx4 v3, s[4:7], s51 offen offset:1024 lds
    v_mfma_f32_16x16x32_bf16 a[8:11], v[40:43], v[228:231], a[8:11]
    v_mfma_f32_16x16x32_bf16 a[28:31], v[40:43], v[236:239], a[28:31]
    v_mfma_f32_16x16x32_bf16 a[12:15], v[44:47], v[228:231], a[12:15]
    buffer_load_dwordx4 v3, s[4:7], s51 offen offset:2048 lds
    v_mfma_f32_16x16x32_bf16 a[32:35], v[44:47], v[236:239], a[32:35]
    v_mfma_f32_16x16x32_bf16 a[16:19], v[48:51], v[228:231], a[16:19]
    v_mfma_f32_16x16x32_bf16 a[36:39], v[48:51], v[236:239], a[36:39]
    s_waitcnt vmcnt(23) lgkmcnt(0)
    s_barrier
    v_mfma_f32_16x16x32_bf16 a[0:3], v[52:55], v[240:243], a[0:3]
    ds_read_b128 v[12:15], v93 offset:0
    v_mfma_f32_16x16x32_bf16 a[20:23], v[52:55], v[248:251], a[20:23]
    buffer_load_dwordx4 v3, s[4:7], s51 offen offset:3072 lds
    ds_read_b128 v[16:19], v93 offset:1024
    v_mfma_f32_16x16x32_bf16 a[4:7], v[56:59], v[240:243], a[4:7]
    ds_read_b128 v[20:23], v93 offset:2048
    v_mfma_f32_16x16x32_bf16 a[24:27], v[56:59], v[248:251], a[24:27]
    ds_read_b128 v[24:27], v93 offset:3072
    s_add_u32 s60, s51, 4096
    s_add_u32 m0, s53, 65536
    v_mfma_f32_16x16x32_bf16 a[8:11], v[60:63], v[240:243], a[8:11]
    buffer_load_dwordx4 v3, s[4:7], s60 offen lds
    s_add_u32 s51, s51, 20480
    ds_read_b128 v[28:31], v93 offset:4096
    v_mfma_f32_16x16x32_bf16 a[28:31], v[60:63], v[248:251], a[28:31]
    ds_read_b128 v[32:35], v93 offset:5120
    v_mfma_f32_16x16x32_bf16 a[12:15], v[64:67], v[240:243], a[12:15]
    ds_read_b128 v[36:39], v93 offset:6144
    s_sub_u32 s51, s51, 10240
    s_add_u32 m0, s53, 98304
    v_mfma_f32_16x16x32_bf16 a[32:35], v[64:67], v[248:251], a[32:35]
    buffer_load_dwordx4 v3, s[4:7], s51 offen lds
    ds_read_b128 v[40:43], v93 offset:7168
    v_mfma_f32_16x16x32_bf16 a[16:19], v[68:71], v[240:243], a[16:19]
    ds_read_b128 v[44:47], v93 offset:8192
    v_mfma_f32_16x16x32_bf16 a[36:39], v[68:71], v[248:251], a[36:39]
    ds_read_b128 v[48:51], v93 offset:9216
    v_mfma_f32_16x16x32_bf16 a[0:3], v[72:75], v[244:247], a[0:3]
    buffer_load_dwordx4 v3, s[4:7], s51 offen offset:1024 lds
    v_mfma_f32_16x16x32_bf16 a[20:23], v[72:75], v[252:255], a[20:23]
    v_mfma_f32_16x16x32_bf16 a[4:7], v[76:79], v[244:247], a[4:7]
    v_mfma_f32_16x16x32_bf16 a[24:27], v[76:79], v[252:255], a[24:27]
    buffer_load_dwordx4 v3, s[4:7], s51 offen offset:2048 lds
    v_mfma_f32_16x16x32_bf16 a[8:11], v[80:83], v[244:247], a[8:11]
    v_mfma_f32_16x16x32_bf16 a[28:31], v[80:83], v[252:255], a[28:31]
    v_mfma_f32_16x16x32_bf16 a[12:15], v[84:87], v[244:247], a[12:15]
    buffer_load_dwordx4 v3, s[4:7], s51 offen offset:3072 lds
    v_mfma_f32_16x16x32_bf16 a[32:35], v[84:87], v[252:255], a[32:35]
    v_mfma_f32_16x16x32_bf16 a[16:19], v[88:91], v[244:247], a[16:19]
    v_mfma_f32_16x16x32_bf16 a[36:39], v[88:91], v[252:255], a[36:39]
    s_waitcnt vmcnt(24) lgkmcnt(0)
    s_barrier
    v_mfma_f32_16x16x32_bf16 a[0:3], v[12:15], a[128:131], a[0:3]
    ds_read_b128 v[52:55], v94 offset:0
    s_add_u32 s60, s51, 4096
    s_add_u32 m0, s53, 102400
    v_mfma_f32_16x16x32_bf16 a[20:23], v[12:15], a[136:139], a[20:23]
    buffer_load_dwordx4 v3, s[4:7], s60 offen lds
    s_add_u32 s51, s51, 20480
    ds_read_b128 v[56:59], v94 offset:1024
    v_mfma_f32_16x16x32_bf16 a[4:7], v[16:19], a[128:131], a[4:7]
    ds_read_b128 v[60:63], v94 offset:2048
    v_mfma_f32_16x16x32_bf16 a[24:27], v[16:19], a[136:139], a[24:27]
    ds_read_b128 v[64:67], v94 offset:3072
    s_add_u32 m0, s53, 118784
    v_mfma_f32_16x16x32_bf16 a[8:11], v[20:23], a[128:131], a[8:11]
    buffer_load_dwordx4 v3, s[4:7], s51 offen lds
    ds_read_b128 v[68:71], v94 offset:4096
    v_mfma_f32_16x16x32_bf16 a[28:31], v[20:23], a[136:139], a[28:31]
    ds_read_b128 v[72:75], v94 offset:5120
    v_mfma_f32_16x16x32_bf16 a[12:15], v[24:27], a[128:131], a[12:15]
    ds_read_b128 v[76:79], v94 offset:6144
    v_mfma_f32_16x16x32_bf16 a[32:35], v[24:27], a[136:139], a[32:35]
    buffer_load_dwordx4 v3, s[4:7], s51 offen offset:1024 lds
    ds_read_b128 v[80:83], v94 offset:7168
    v_mfma_f32_16x16x32_bf16 a[16:19], v[28:31], a[128:131], a[16:19]
    ds_read_b128 v[84:87], v94 offset:8192
    v_mfma_f32_16x16x32_bf16 a[36:39], v[28:31], a[136:139], a[36:39]
    ds_read_b128 v[88:91], v94 offset:9216
    v_mfma_f32_16x16x32_bf16 a[0:3], v[32:35], a[132:135], a[0:3]
    buffer_load_dwordx4 v3, s[4:7], s51 offen offset:2048 lds
    v_mfma_f32_16x16x32_bf16 a[20:23], v[32:35], a[140:143], a[20:23]
    v_mfma_f32_16x16x32_bf16 a[4:7], v[36:39], a[132:135], a[4:7]
    v_mfma_f32_16x16x32_bf16 a[24:27], v[36:39], a[140:143], a[24:27]
    buffer_load_dwordx4 v3, s[4:7], s51 offen offset:3072 lds
    v_mfma_f32_16x16x32_bf16 a[8:11], v[40:43], a[132:135], a[8:11]
    v_mfma_f32_16x16x32_bf16 a[28:31], v[40:43], a[140:143], a[28:31]
    s_add_u32 s60, s51, 4096
    s_add_u32 m0, s53, 122880
    v_mfma_f32_16x16x32_bf16 a[12:15], v[44:47], a[132:135], a[12:15]
    buffer_load_dwordx4 v3, s[4:7], s60 offen lds
    s_add_u32 s51, s51, 20480
    v_mfma_f32_16x16x32_bf16 a[32:35], v[44:47], a[140:143], a[32:35]
    v_mfma_f32_16x16x32_bf16 a[16:19], v[48:51], a[132:135], a[16:19]
    v_mfma_f32_16x16x32_bf16 a[36:39], v[48:51], a[140:143], a[36:39]
    s_waitcnt vmcnt(25) lgkmcnt(0)
    s_barrier
    v_mfma_f32_16x16x32_bf16 a[0:3], v[52:55], a[144:147], a[0:3]
    ds_read_b128 v[12:15], v95 offset:0
    s_add_u32 m0, s53, 139264
    v_mfma_f32_16x16x32_bf16 a[20:23], v[52:55], a[152:155], a[20:23]
    buffer_load_dwordx4 v3, s[4:7], s51 offen lds
    ds_read_b128 v[16:19], v95 offset:1024
    v_mfma_f32_16x16x32_bf16 a[4:7], v[56:59], a[144:147], a[4:7]
    ds_read_b128 v[20:23], v95 offset:2048
    v_mfma_f32_16x16x32_bf16 a[24:27], v[56:59], a[152:155], a[24:27]
    ds_read_b128 v[24:27], v95 offset:3072
    v_mfma_f32_16x16x32_bf16 a[8:11], v[60:63], a[144:147], a[8:11]
    buffer_load_dwordx4 v3, s[4:7], s51 offen offset:1024 lds
    ds_read_b128 v[28:31], v95 offset:4096
    v_mfma_f32_16x16x32_bf16 a[28:31], v[60:63], a[152:155], a[28:31]
    ds_read_b128 v[32:35], v95 offset:5120
    v_mfma_f32_16x16x32_bf16 a[12:15], v[64:67], a[144:147], a[12:15]
    ds_read_b128 v[36:39], v95 offset:6144
    v_mfma_f32_16x16x32_bf16 a[32:35], v[64:67], a[152:155], a[32:35]
    ds_read_b128 v[40:43], v95 offset:7168
    v_mfma_f32_16x16x32_bf16 a[16:19], v[68:71], a[144:147], a[16:19]
    buffer_load_dwordx4 v3, s[4:7], s51 offen offset:2048 lds
    ds_read_b128 v[44:47], v95 offset:8192
    v_mfma_f32_16x16x32_bf16 a[36:39], v[68:71], a[152:155], a[36:39]
    ds_read_b128 v[48:51], v95 offset:9216
    v_mfma_f32_16x16x32_bf16 a[0:3], v[72:75], a[148:151], a[0:3]
    v_mfma_f32_16x16x32_bf16 a[20:23], v[72:75], a[156:159], a[20:23]
    v_mfma_f32_16x16x32_bf16 a[4:7], v[76:79], a[148:151], a[4:7]
    buffer_load_dwordx4 v3, s[4:7], s51 offen offset:3072 lds
    v_mfma_f32_16x16x32_bf16 a[24:27], v[76:79], a[156:159], a[24:27]
    v_mfma_f32_16x16x32_bf16 a[8:11], v[80:83], a[148:151], a[8:11]
    v_mfma_f32_16x16x32_bf16 a[28:31], v[80:83], a[156:159], a[28:31]
    s_add_u32 s60, s51, 4096
    s_add_u32 m0, s53, 143360
    v_mfma_f32_16x16x32_bf16 a[12:15], v[84:87], a[148:151], a[12:15]
    buffer_load_dwordx4 v3, s[4:7], s60 offen lds
    s_add_u32 s51, s51, 20480
    v_mfma_f32_16x16x32_bf16 a[32:35], v[84:87], a[156:159], a[32:35]
    v_mfma_f32_16x16x32_bf16 a[16:19], v[88:91], a[148:151], a[16:19]
    v_mfma_f32_16x16x32_bf16 a[36:39], v[88:91], a[156:159], a[36:39]
    s_waitcnt vmcnt(25) lgkmcnt(0)
    s_barrier
    buffer_load_dword v101, v100, s[4:7], s55 offen sc1
    v_mfma_f32_16x16x32_bf16 a[0:3], v[12:15], a[160:163], a[0:3]
    ds_read_b128 v[52:55], v96 offset:0
    s_add_u32 m0, s53, 0
    v_mfma_f32_16x16x32_bf16 a[20:23], v[12:15], a[168:171], a[20:23]
    buffer_load_dwordx4 v3, s[4:7], s51 offen lds
    ds_read_b128 v[56:59], v96 offset:1024
    v_mfma_f32_16x16x32_bf16 a[4:7], v[16:19], a[160:163], a[4:7]
    ds_read_b128 v[60:63], v96 offset:2048
    v_mfma_f32_16x16x32_bf16 a[24:27], v[16:19], a[168:171], a[24:27]
    ds_read_b128 v[64:67], v96 offset:3072
    v_mfma_f32_16x16x32_bf16 a[8:11], v[20:23], a[160:163], a[8:11]
    buffer_load_dwordx4 v3, s[4:7], s51 offen offset:1024 lds
    ds_read_b128 v[68:71], v96 offset:4096
    v_mfma_f32_16x16x32_bf16 a[28:31], v[20:23], a[168:171], a[28:31]
    ds_read_b128 v[72:75], v96 offset:5120
    v_mfma_f32_16x16x32_bf16 a[12:15], v[24:27], a[160:163], a[12:15]
    ds_read_b128 v[76:79], v96 offset:6144
    v_mfma_f32_16x16x32_bf16 a[32:35], v[24:27], a[168:171], a[32:35]
    ds_read_b128 v[80:83], v96 offset:7168
    v_mfma_f32_16x16x32_bf16 a[16:19], v[28:31], a[160:163], a[16:19]
    buffer_load_dwordx4 v3, s[4:7], s51 offen offset:2048 lds
    ds_read_b128 v[84:87], v96 offset:8192
    v_mfma_f32_16x16x32_bf16 a[36:39], v[28:31], a[168:171], a[36:39]
    ds_read_b128 v[88:91], v96 offset:9216
    v_mfma_f32_16x16x32_bf16 a[0:3], v[32:35], a[164:167], a[0:3]
    v_mfma_f32_16x16x32_bf16 a[20:23], v[32:35], a[172:175], a[20:23]
    v_mfma_f32_16x16x32_bf16 a[4:7], v[36:39], a[164:167], a[4:7]
    buffer_load_dwordx4 v3, s[4:7], s51 offen offset:3072 lds
    v_mfma_f32_16x16x32_bf16 a[24:27], v[36:39], a[172:175], a[24:27]
    v_mfma_f32_16x16x32_bf16 a[8:11], v[40:43], a[164:167], a[8:11]
    v_mfma_f32_16x16x32_bf16 a[28:31], v[40:43], a[172:175], a[28:31]
    s_add_u32 s60, s51, 4096
    s_add_u32 m0, s53, 4096
    v_mfma_f32_16x16x32_bf16 a[12:15], v[44:47], a[164:167], a[12:15]
    buffer_load_dwordx4 v3, s[4:7], s60 offen lds
    s_add_u32 s51, s51, 20480
    v_mfma_f32_16x16x32_bf16 a[32:35], v[44:47], a[172:175], a[32:35]
    v_mfma_f32_16x16x32_bf16 a[16:19], v[48:51], a[164:167], a[16:19]
    v_mfma_f32_16x16x32_bf16 a[36:39], v[48:51], a[172:175], a[36:39]
    s_waitcnt vmcnt(5) lgkmcnt(0)
    s_barrier
    v_cmp_eq_u32 vcc, 1, v101
    s_nop 3
    s_cmp_eq_u64 vcc, exec
    s_cbranch_scc0 K2_SPIN
K2_SPUN:
    v_mfma_f32_16x16x32_bf16 a[0:3], v[52:55], a[176:179], a[0:3]
    ds_read_b128 v[12:15], v97 offset:0
    v_mfma_f32_16x16x32_bf16 a[20:23], v[52:55], a[184:187], a[20:23]
    buffer_load_dwordx4 v[128:131], v3, s[4:7], s14 offen offset:0 sc1
    ds_read_b128 v[16:19], v97 offset:1024
    v_mfma_f32_16x16x32_bf16 a[4:7], v[56:59], a[176:179], a[4:7]
    ds_read_b128 v[20:23], v97 offset:2048
    v_mfma_f32_16x16x32_bf16 a[24:27], v[56:59], a[184:187], a[24:27]
    ds_read_b128 v[24:27], v97 offset:3072
    v_mfma_f32_16x16x32_bf16 a[8:11], v[60:63], a[176:179], a[8:11]
    buffer_load_dwordx4 v[132:135], v3, s[4:7], s14 offen offset:1024 sc1
    s_add_u32 s14, s14, 4096
    ds_read_b128 v[28:31], v97 offset:4096
    v_mfma_f32_16x16x32_bf16 a[28:31], v[60:63], a[184:187], a[28:31]
    ds_read_b128 v[32:35], v97 offset:5120
    v_mfma_f32_16x16x32_bf16 a[12:15], v[64:67], a[176:179], a[12:15]
    ds_read_b128 v[36:39], v97 offset:6144
    v_mfma_f32_16x16x32_bf16 a[32:35], v[64:67], a[184:187], a[32:35]
    buffer_load_dwordx4 v[136:139], v3, s[4:7], s15 offen offset:0 sc1
    ds_read_b128 v[40:43], v97 offset:7168
    v_mfma_f32_16x16x32_bf16 a[16:19], v[68:71], a[176:179], a[16:19]
    ds_read_b128 v[44:47], v97 offset:8192
    v_mfma_f32_16x16x32_bf16 a[36:39], v[68:71], a[184:187], a[36:39]
    ds_read_b128 v[48:51], v97 offset:9216
    v_mfma_f32_16x16x32_bf16 a[0:3], v[72:75], a[180:183], a[0:3]
    buffer_load_dwordx4 v[140:143], v3, s[4:7], s15 offen offset:1024 sc1
    s_add_u32 s15, s15, 4096
    v_mfma_f32_16x16x32_bf16 a[20:23], v[72:75], a[188:191], a[20:23]
    v_mfma_f32_16x16x32_bf16 a[4:7], v[76:79], a[180:183], a[4:7]
    s_add_u32 m0, s53, 20480
    v_mfma_f32_16x16x32_bf16 a[24:27], v[76:79], a[188:191], a[24:27]
    buffer_load_dwordx4 v3, s[4:7], s51 offen lds
    v_mfma_f32_16x16x32_bf16 a[8:11], v[80:83], a[180:183], a[8:11]
    v_mfma_f32_16x16x32_bf16 a[28:31], v[80:83], a[188:191], a[28:31]
    v_mfma_f32_16x16x32_bf16 a[12:15], v[84:87], a[180:183], a[12:15]
    buffer_load_dwordx4 v3, s[4:7], s51 offen offset:1024 lds
    v_mfma_f32_16x16x32_bf16 a[32:35], v[84:87], a[188:191], a[32:35]
    v_mfma_f32_16x16x32_bf16 a[16:19], v[88:91], a[180:183], a[16:19]
    v_mfma_f32_16x16x32_bf16 a[36:39], v[88:91], a[188:191], a[36:39]
    s_waitcnt lgkmcnt(0)
    s_barrier
    v_mfma_f32_16x16x32_bf16 a[0:3], v[12:15], a[192:195], a[0:3]
    ds_read_b128 v[52:55], v98 offset:0
    v_mfma_f32_16x16x32_bf16 a[20:23], v[12:15], a[200:203], a[20:23]
    buffer_load_dwordx4 v[144:147], v3, s[4:7], s14 offen offset:0 sc1
    ds_read_b128 v[56:59], v98 offset:1024
    v_mfma_f32_16x16x32_bf16 a[4:7], v[16:19], a[192:195], a[4:7]
    ds_read_b128 v[60:63], v98 offset:2048
    v_mfma_f32_16x16x32_bf16 a[24:27], v[16:19], a[200:203], a[24:27]
    ds_read_b128 v[64:67], v98 offset:3072
    v_mfma_f32_16x16x32_bf16 a[8:11], v[20:23], a[192:195], a[8:11]
    buffer_load_dwordx4 v[148:151], v3, s[4:7], s14 offen offset:1024 sc1
    s_add_u32 s14, s14, 4096
    ds_read_b128 v[68:71], v98 offset:4096
    v_mfma_f32_16x16x32_bf16 a[28:31], v[20:23], a[200:203], a[28:31]
    ds_read_b128 v[72:75], v98 offset:5120
    v_mfma_f32_16x16x32_bf16 a[12:15], v[24:27], a[192:195], a[12:15]
    ds_read_b128 v[76:79], v98 offset:6144
    v_mfma_f32_16x16x32_bf16 a[32:35], v[24:27], a[200:203], a[32:35]
    buffer_load_dwordx4 v[152:155], v3, s[4:7], s15 offen offset:0 sc1
    ds_read_b128 v[80:83], v98 offset:7168
    v_mfma_f32_16x16x32_bf16 a[16:19], v[28:31], a[192:195], a[16:19]
    ds_read_b128 v[84:87], v98 offset:8192
    v_mfma_f32_16x16x32_bf16 a[36:39], v[28:31], a[200:203], a[36:39]
    ds_read_b128 v[88:91], v98 offset:9216
    v_mfma_f32_16x16x32_bf16 a[0:3], v[32:35], a[196:199], a[0:3]
    buffer_load_dwordx4 v[156:159], v3, s[4:7], s15 offen offset:1024 sc1
    s_add_u32 s15, s15, 4096
    v_mfma_f32_16x16x32_bf16 a[20:23], v[32:35], a[204:207], a[20:23]
    v_mfma_f32_16x16x32_bf16 a[4:7], v[36:39], a[196:199], a[4:7]
    v_mfma_f32_16x16x32_bf16 a[24:27], v[36:39], a[204:207], a[24:27]
    buffer_load_dwordx4 v3, s[4:7], s51 offen offset:2048 lds
    v_mfma_f32_16x16x32_bf16 a[8:11], v[40:43], a[196:199], a[8:11]
    v_mfma_f32_16x16x32_bf16 a[28:31], v[40:43], a[204:207], a[28:31]
    v_mfma_f32_16x16x32_bf16 a[12:15], v[44:47], a[196:199], a[12:15]
    buffer_load_dwordx4 v3, s[4:7], s51 offen offset:3072 lds
    v_mfma_f32_16x16x32_bf16 a[32:35], v[44:47], a[204:207], a[32:35]
    v_mfma_f32_16x16x32_bf16 a[16:19], v[48:51], a[196:199], a[16:19]
    v_mfma_f32_16x16x32_bf16 a[36:39], v[48:51], a[204:207], a[36:39]
    s_waitcnt lgkmcnt(0)
    s_barrier
    v_mfma_f32_16x16x32_bf16 a[0:3], v[52:55], a[208:211], a[0:3]
    ds_read_b128 v[12:15], v92 offset:0
    v_mfma_f32_16x16x32_bf16 a[20:23], v[52:55], a[216:219], a[20:23]
    buffer_load_dwordx4 v[160:163], v3, s[4:7], s14 offen offset:0 sc1
    ds_read_b128 v[16:19], v92 offset:1024
    v_mfma_f32_16x16x32_bf16 a[4:7], v[56:59], a[208:211], a[4:7]
    ds_read_b128 v[20:23], v92 offset:2048
    v_mfma_f32_16x16x32_bf16 a[24:27], v[56:59], a[216:219], a[24:27]
    ds_read_b128 v[24:27], v92 offset:3072
    v_mfma_f32_16x16x32_bf16 a[8:11], v[60:63], a[208:211], a[8:11]
    buffer_load_dwordx4 v[164:167], v3, s[4:7], s14 offen offset:1024 sc1
    s_add_u32 s14, s14, 4096
    ds_read_b128 v[28:31], v92 offset:4096
    v_mfma_f32_16x16x32_bf16 a[28:31], v[60:63], a[216:219], a[28:31]
    ds_read_b128 v[32:35], v92 offset:5120
    v_mfma_f32_16x16x32_bf16 a[12:15], v[64:67], a[208:211], a[12:15]
    ds_read_b128 v[36:39], v92 offset:6144
    v_mfma_f32_16x16x32_bf16 a[32:35], v[64:67], a[216:219], a[32:35]
    ds_read_b128 v[40:43], v92 offset:7168
    v_mfma_f32_16x16x32_bf16 a[16:19], v[68:71], a[208:211], a[16:19]
    buffer_load_dwordx4 v[168:171], v3, s[4:7], s15 offen offset:0 sc1
    ds_read_b128 v[44:47], v92 offset:8192
    v_mfma_f32_16x16x32_bf16 a[36:39], v[68:71], a[216:219], a[36:39]
    ds_read_b128 v[48:51], v92 offset:9216
    v_mfma_f32_16x16x32_bf16 a[0:3], v[72:75], a[212:215], a[0:3]
    v_mfma_f32_16x16x32_bf16 a[20:23], v[72:75], a[220:223], a[20:23]
    v_mfma_f32_16x16x32_bf16 a[4:7], v[76:79], a[212:215], a[4:7]
    buffer_load_dwordx4 v[172:175], v3, s[4:7], s15 offen offset:1024 sc1
    s_add_u32 s15, s15, 4096
    v_mfma_f32_16x16x32_bf16 a[24:27], v[76:79], a[220:223], a[24:27]
    v_mfma_f32_16x16x32_bf16 a[8:11], v[80:83], a[212:215], a[8:11]
    v_mfma_f32_16x16x32_bf16 a[28:31], v[80:83], a[220:223], a[28:31]
    s_add_u32 s60, s51, 4096
    s_add_u32 m0, s53, 24576
    v_mfma_f32_16x16x32_bf16 a[12:15], v[84:87], a[212:215], a[12:15]
    buffer_load_dwordx4 v3, s[4:7], s60 offen lds
    s_add_u32 s51, s51, 20480
    v_mfma_f32_16x16x32_bf16 a[32:35], v[84:87], a[220:223], a[32:35]
    v_mfma_f32_16x16x32_bf16 a[16:19], v[88:91], a[212:215], a[16:19]
    v_mfma_f32_16x16x32_bf16 a[36:39], v[88:91], a[220:223], a[36:39]
    s_waitcnt vmcnt(13) lgkmcnt(0)
    s_barrier
    v_mfma_f32_16x16x32_bf16 a[40:43], v[12:15], v[128:131], 0
    ds_read_b128 v[52:55], v93 offset:0
    ds_write_b128 v126, a[20:23] offset:0
    ds_write_b128 v126, a[24:27] offset:1024
    v_mfma_f32_16x16x32_bf16 a[60:63], v[12:15], v[136:139], 0
    buffer_load_dwordx4 v[176:179], v3, s[4:7], s14 offen offset:0 sc1
    ds_read_b128 v[56:59], v93 offset:1024
    ds_write_b128 v126, a[28:31] offset:2048
    ds_write_b128 v126, a[32:35] offset:3072
    v_mfma_f32_16x16x32_bf16 a[44:47], v[16:19], v[128:131], 0
    ds_read_b128 v[60:63], v93 offset:2048
    ds_write_b128 v126, a[36:39] offset:4096
    v_accvgpr_read_b32 v208, a0
    v_mfma_f32_16x16x32_bf16 a[64:67], v[16:19], v[136:139], 0
    ds_read_b128 v[64:67], v93 offset:3072
    v_accvgpr_read_b32 v209, a1
    v_accvgpr_read_b32 v210, a2
    v_mfma_f32_16x16x32_bf16 a[48:51], v[20:23], v[128:131], 0
    ds_read_b128 v[68:71], v93 offset:4096
    v_accvgpr_read_b32 v211, a3
    v_accvgpr_read_b32 v212, a4
    v_mfma_f32_16x16x32_bf16 a[68:71], v[20:23], v[136:139], 0
    buffer_load_dwordx4 v[180:183], v3, s[4:7], s14 offen offset:1024 sc1
    s_add_u32 s14, s14, 4096
    ds_read_b128 v[72:75], v93 offset:5120
    v_accvgpr_read_b32 v213, a5
    v_accvgpr_read_b32 v214, a6
    v_mfma_f32_16x16x32_bf16 a[52:55], v[24:27], v[128:131], 0
    ds_read_b128 v[76:79], v93 offset:6144
    v_accvgpr_read_b32 v215, a7
    v_accvgpr_read_b32 v216, a8
    v_mfma_f32_16x16x32_bf16 a[72:75], v[24:27], v[136:139], 0
    ds_read_b128 v[80:83], v93 offset:7168
    v_accvgpr_read_b32 v217, a9
    v_accvgpr_read_b32 v218, a10
    v_mfma_f32_16x16x32_bf16 a[56:59], v[28:31], v[128:131], 0
    ds_read_b128 v[84:87], v93 offset:8192
    v_accvgpr_read_b32 v219, a11
    v_accvgpr_read_b32 v220, a12
    v_mfma_f32_16x16x32_bf16 a[76:79], v[28:31], v[136:139], 0
    ds_read_b128 v[88:91], v93 offset:9216
    v_accvgpr_read_b32 v221, a13
    v_accvgpr_read_b32 v222, a14
    v_mfma_f32_16x16x32_bf16 a[40:43], v[32:35], v[132:135], a[40:43]
    buffer_load_dwordx4 v[184:187], v3, s[4:7], s15 offen offset:0 sc1
    v_accvgpr_read_b32 v223, a15
    v_accvgpr_read_b32 v224, a16
    v_mfma_f32_16x16x32_bf16 a[60:63], v[32:35], v[140:143], a[60:63]
    v_accvgpr_read_b32 v225, a17
    v_accvgpr_read_b32 v226, a18
    v_mfma_f32_16x16x32_bf16 a[44:47], v[36:39], v[132:135], a[44:47]
    v_accvgpr_read_b32 v227, a19
    v_mfma_f32_16x16x32_bf16 a[64:67], v[36:39], v[140:143], a[64:67]
    v_mfma_f32_16x16x32_bf16 a[48:51], v[40:43], v[132:135], a[48:51]
    v_mfma_f32_16x16x32_bf16 a[68:71], v[40:43], v[140:143], a[68:71]
    buffer_load_dwordx4 v[188:191], v3, s[4:7], s15 offen offset:1024 sc1
    s_add_u32 s15, s15, 4096
    v_mfma_f32_16x16x32_bf16 a[52:55], v[44:47], v[132:135], a[52:55]
    v_mfma_f32_16x16x32_bf16 a[72:75], v[44:47], v[140:143], a[72:75]
    v_mfma_f32_16x16x32_bf16 a[56:59], v[48:51], v[132:135], a[56:59]
    v_mfma_f32_16x16x32_bf16 a[76:79], v[48:51], v[140:143], a[76:79]
    s_waitcnt vmcnt(11) lgkmcnt(0)
    s_barrier
    v_mfma_f32_16x16x32_bf16 a[40:43], v[52:55], v[144:147], a[40:43]
    ds_read_b128 v[12:15], v94 offset:0
    ds_read_b128 v[228:231], v127 offset:0
    ds_read_b128 v[232:235], v127 offset:1024
    v_mfma_f32_16x16x32_bf16 a[60:63], v[52:55], v[152:155], a[60:63]
    buffer_load_dwordx4 v[192:195], v3, s[4:7], s14 offen offset:0 sc1
    ds_read_b128 v[16:19], v94 offset:1024
    ds_read_b128 v[236:239], v127 offset:2048
    ds_read_b128 v[240:243], v127 offset:3072
    v_mfma_f32_16x16x32_bf16 a[44:47], v[56:59], v[144:147], a[44:47]
    ds_read_b128 v[20:23], v94 offset:2048
    ds_read_b128 v[244:247], v127 offset:4096
    v_mfma_f32_16x16x32_bf16 a[64:67], v[56:59], v[152:155], a[64:67]
    ds_read_b128 v[24:27], v94 offset:3072
    v_mfma_f32_16x16x32_bf16 a[48:51], v[60:63], v[144:147], a[48:51]
    ds_read_b128 v[28:31], v94 offset:4096
    v_mfma_f32_16x16x32_bf16 a[68:71], v[60:63], v[152:155], a[68:71]
    buffer_load_dwordx4 v[196:199], v3, s[4:7], s14 offen offset:1024 sc1
    s_add_u32 s14, s14, 4096
    ds_read_b128 v[32:35], v94 offset:5120
    v_mfma_f32_16x16x32_bf16 a[52:55], v[64:67], v[144:147], a[52:55]
    ds_read_b128 v[36:39], v94 offset:6144
    v_mfma_f32_16x16x32_bf16 a[72:75], v[64:67], v[152:155], a[72:75]
    ds_read_b128 v[40:43], v94 offset:7168
    v_mfma_f32_16x16x32_bf16 a[56:59], v[68:71], v[144:147], a[56:59]
    ds_read_b128 v[44:47], v94 offset:8192
    v_mfma_f32_16x16x32_bf16 a[76:79], v[68:71], v[152:155], a[76:79]
    ds_read_b128 v[48:51], v94 offset:9216
    v_mfma_f32_16x16x32_bf16 a[40:43], v[72:75], v[148:151], a[40:43]
    buffer_load_dwordx4 v[200:203], v3, s[4:7], s15 offen offset:0 sc1
    v_mfma_f32_16x16x32_bf16 a[60:63], v[72:75], v[156:159], a[60:63]
    v_mfma_f32_16x16x32_bf16 a[44:47], v[76:79], v[148:151], a[44:47]
    v_mfma_f32_16x16x32_bf16 a[64:67], v[76:79], v[156:159], a[64:67]
    v_mfma_f32_16x16x32_bf16 a[48:51], v[80:83], v[148:151], a[48:51]
    v_mfma_f32_16x16x32_bf16 a[68:71], v[80:83], v[156:159], a[68:71]
    buffer_load_dwordx4 v[204:207], v3, s[4:7], s15 offen offset:1024 sc1
    s_add_u32 s15, s15, 4096
    v_mfma_f32_16x16x32_bf16 a[52:55], v[84:87], v[148:151], a[52:55]
    v_mfma_f32_16x16x32_bf16 a[72:75], v[84:87], v[156:159], a[72:75]
    v_mfma_f32_16x16x32_bf16 a[56:59], v[88:91], v[148:151], a[56:59]
    v_mfma_f32_16x16x32_bf16 a[76:79], v[88:91], v[156:159], a[76:79]
    s_waitcnt vmcnt(9) lgkmcnt(0)
    s_barrier
    v_mfma_f32_16x16x32_bf16 a[40:43], v[12:15], v[160:163], a[40:43]
    ds_read_b128 v[52:55], v95 offset:0
    v_pk_add_f32 v[208:209], v[208:209], v[228:229]
    v_pk_add_f32 v[210:211], v[210:211], v[230:231]
    v_mfma_f32_16x16x32_bf16 a[60:63], v[12:15], v[168:171], a[60:63]
    ds_read_b128 v[56:59], v95 offset:1024
    v_pk_add_f32 v[212:213], v[212:213], v[232:233]
    v_pk_add_f32 v[214:215], v[214:215], v[234:235]
    v_mfma_f32_16x16x32_bf16 a[44:47], v[16:19], v[160:163], a[44:47]
    ds_read_b128 v[60:63], v95 offset:2048
    v_pk_add_f32 v[216:217], v[216:217], v[236:237]
    v_pk_add_f32 v[218:219], v[218:219], v[238:239]
    v_mfma_f32_16x16x32_bf16 a[64:67], v[16:19], v[168:171], a[64:67]
    ds_read_b128 v[64:67], v95 offset:3072
    v_pk_add_f32 v[220:221], v[220:221], v[240:241]
    v_pk_add_f32 v[222:223], v[222:223], v[242:243]
    v_mfma_f32_16x16x32_bf16 a[48:51], v[20:23], v[160:163], a[48:51]
    ds_read_b128 v[68:71], v95 offset:4096
    v_pk_add_f32 v[224:225], v[224:225], v[244:245]
    v_pk_add_f32 v[226:227], v[226:227], v[246:247]
    v_mfma_f32_16x16x32_bf16 a[68:71], v[20:23], v[168:171], a[68:71]
    ds_read_b128 v[72:75], v95 offset:5120
    v_mul_f32 v106, 0xbfb8aa3b, v208
    v_mul_f32 v107, 0xbfb8aa3b, v209
    v_mfma_f32_16x16x32_bf16 a[52:55], v[24:27], v[160:163], a[52:55]
    ds_read_b128 v[76:79], v95 offset:6144
    v_mul_f32 v108, 0xbfb8aa3b, v210
    v_mul_f32 v109, 0xbfb8aa3b, v211
    v_mfma_f32_16x16x32_bf16 a[72:75], v[24:27], v[168:171], a[72:75]
    ds_read_b128 v[80:83], v95 offset:7168
    v_mul_f32 v110, 0xbfb8aa3b, v212
    v_mul_f32 v111, 0xbfb8aa3b, v213
    v_mfma_f32_16x16x32_bf16 a[56:59], v[28:31], v[160:163], a[56:59]
    ds_read_b128 v[84:87], v95 offset:8192
    v_mul_f32 v112, 0xbfb8aa3b, v214
    v_mul_f32 v113, 0xbfb8aa3b, v215
    v_mfma_f32_16x16x32_bf16 a[76:79], v[28:31], v[168:171], a[76:79]
    ds_read_b128 v[88:91], v95 offset:9216
    v_mul_f32 v114, 0xbfb8aa3b, v216
    v_mul_f32 v115, 0xbfb8aa3b, v217
    v_mfma_f32_16x16x32_bf16 a[40:43], v[32:35], v[164:167], a[40:43]
    v_mul_f32 v116, 0xbfb8aa3b, v218
    v_mul_f32 v117, 0xbfb8aa3b, v219
    v_mfma_f32_16x16x32_bf16 a[60:63], v[32:35], v[172:175], a[60:63]
    v_mul_f32 v118, 0xbfb8aa3b, v220
    v_mul_f32 v119, 0xbfb8aa3b, v221
    v_mfma_f32_16x16x32_bf16 a[44:47], v[36:39], v[164:167], a[44:47]
    v_mul_f32 v120, 0xbfb8aa3b, v222
    v_mul_f32 v121, 0xbfb8aa3b, v223
    v_mfma_f32_16x16x32_bf16 a[64:67], v[36:39], v[172:175], a[64:67]
    v_mul_f32 v122, 0xbfb8aa3b, v224
    v_mul_f32 v123, 0xbfb8aa3b, v225
    v_mfma_f32_16x16x32_bf16 a[48:51], v[40:43], v[164:167], a[48:51]
    v_mul_f32 v124, 0xbfb8aa3b, v226
    v_mul_f32 v125, 0xbfb8aa3b, v227
    v_mfma_f32_16x16x32_bf16 a[68:71], v[40:43], v[172:175], a[68:71]
    v_mfma_f32_16x16x32_bf16 a[52:55], v[44:47], v[164:167], a[52:55]
    v_mfma_f32_16x16x32_bf16 a[72:75], v[44:47], v[172:175], a[72:75]
    v_mfma_f32_16x16x32_bf16 a[56:59], v[48:51], v[164:167], a[56:59]
    v_mfma_f32_16x16x32_bf16 a[76:79], v[48:51], v[172:175], a[76:79]
    s_waitcnt vmcnt(4) lgkmcnt(0)
    s_barrier
    v_mfma_f32_16x16x32_bf16 a[40:43], v[52:55], v[176:179], a[40:43]
    ds_read_b128 v[12:15], v96 offset:0
    v_exp_f32 v106, v106
    v_exp_f32 v107, v107
    v_mfma_f32_16x16x32_bf16 a[60:63], v[52:55], v[184:187], a[60:63]
    ds_read_b128 v[16:19], v96 offset:1024
    v_exp_f32 v108, v108
    v_exp_f32 v109, v109
    v_mfma_f32_16x16x32_bf16 a[44:47], v[56:59], v[176:179], a[44:47]
    ds_read_b128 v[20:23], v96 offset:2048
    v_exp_f32 v110, v110
    v_exp_f32 v111, v111
    v_mfma_f32_16x16x32_bf16 a[64:67], v[56:59], v[184:187], a[64:67]
    ds_read_b128 v[24:27], v96 offset:3072
    v_exp_f32 v112, v112
    v_exp_f32 v113, v113
    v_mfma_f32_16x16x32_bf16 a[48:51], v[60:63], v[176:179], a[48:51]
    ds_read_b128 v[28:31], v96 offset:4096
    v_exp_f32 v114, v114
    v_exp_f32 v115, v115
    v_mfma_f32_16x16x32_bf16 a[68:71], v[60:63], v[184:187], a[68:71]
    ds_read_b128 v[32:35], v96 offset:5120
    v_exp_f32 v116, v116
    v_exp_f32 v117, v117
    v_mfma_f32_16x16x32_bf16 a[52:55], v[64:67], v[176:179], a[52:55]
    ds_read_b128 v[36:39], v96 offset:6144
    v_exp_f32 v118, v118
    v_exp_f32 v119, v119
    v_mfma_f32_16x16x32_bf16 a[72:75], v[64:67], v[184:187], a[72:75]
    ds_read_b128 v[40:43], v96 offset:7168
    v_exp_f32 v120, v120
    v_exp_f32 v121, v121
    v_mfma_f32_16x16x32_bf16 a[56:59], v[68:71], v[176:179], a[56:59]
    ds_read_b128 v[44:47], v96 offset:8192
    v_exp_f32 v122, v122
    v_exp_f32 v123, v123
    v_mfma_f32_16x16x32_bf16 a[76:79], v[68:71], v[184:187], a[76:79]
    ds_read_b128 v[48:51], v96 offset:9216
    v_exp_f32 v124, v124
    v_exp_f32 v125, v125
    v_mfma_f32_16x16x32_bf16 a[40:43], v[72:75], v[180:183], a[40:43]
    v_add_f32 v106, 1.0, v106
    v_add_f32 v107, 1.0, v107
    v_mfma_f32_16x16x32_bf16 a[60:63], v[72:75], v[188:191], a[60:63]
    v_add_f32 v108, 1.0, v108
    v_add_f32 v109, 1.0, v109
    v_mfma_f32_16x16x32_bf16 a[44:47], v[76:79], v[180:183], a[44:47]
    v_add_f32 v110, 1.0, v110
    v_add_f32 v111, 1.0, v111
    v_mfma_f32_16x16x32_bf16 a[64:67], v[76:79], v[188:191], a[64:67]
    v_add_f32 v112, 1.0, v112
    v_add_f32 v113, 1.0, v113
    v_mfma_f32_16x16x32_bf16 a[48:51], v[80:83], v[180:183], a[48:51]
    v_add_f32 v114, 1.0, v114
    v_add_f32 v115, 1.0, v115
    v_mfma_f32_16x16x32_bf16 a[68:71], v[80:83], v[188:191], a[68:71]
    v_add_f32 v116, 1.0, v116
    v_add_f32 v117, 1.0, v117
    v_mfma_f32_16x16x32_bf16 a[52:55], v[84:87], v[180:183], a[52:55]
    v_add_f32 v118, 1.0, v118
    v_add_f32 v119, 1.0, v119
    v_mfma_f32_16x16x32_bf16 a[72:75], v[84:87], v[188:191], a[72:75]
    v_add_f32 v120, 1.0, v120
    v_add_f32 v121, 1.0, v121
    v_mfma_f32_16x16x32_bf16 a[56:59], v[88:91], v[180:183], a[56:59]
    v_add_f32 v122, 1.0, v122
    v_add_f32 v123, 1.0, v123
    v_mfma_f32_16x16x32_bf16 a[76:79], v[88:91], v[188:191], a[76:79]
    v_add_f32 v124, 1.0, v124
    v_add_f32 v125, 1.0, v125
    s_waitcnt vmcnt(0) lgkmcnt(0)
    v_mfma_f32_16x16x32_bf16 a[40:43], v[12:15], v[192:195], a[40:43]
    v_rcp_f32 v106, v106
    v_rcp_f32 v107, v107
    v_mfma_f32_16x16x32_bf16 a[60:63], v[12:15], v[200:203], a[60:63]
    v_rcp_f32 v108, v108
    v_rcp_f32 v109, v109
    v_mfma_f32_16x16x32_bf16 a[44:47], v[16:19], v[192:195], a[44:47]
    v_rcp_f32 v110, v110
    v_rcp_f32 v111, v111
    v_mfma_f32_16x16x32_bf16 a[64:67], v[16:19], v[200:203], a[64:67]
    v_rcp_f32 v112, v112
    v_rcp_f32 v113, v113
    v_mfma_f32_16x16x32_bf16 a[48:51], v[20:23], v[192:195], a[48:51]
    v_rcp_f32 v114, v114
    v_rcp_f32 v115, v115
    v_mfma_f32_16x16x32_bf16 a[68:71], v[20:23], v[200:203], a[68:71]
    v_rcp_f32 v116, v116
    v_rcp_f32 v117, v117
    v_mfma_f32_16x16x32_bf16 a[52:55], v[24:27], v[192:195], a[52:55]
    v_rcp_f32 v118, v118
    v_rcp_f32 v119, v119
    v_mfma_f32_16x16x32_bf16 a[72:75], v[24:27], v[200:203], a[72:75]
    v_rcp_f32 v120, v120
    v_rcp_f32 v121, v121
    v_mfma_f32_16x16x32_bf16 a[56:59], v[28:31], v[192:195], a[56:59]
    v_rcp_f32 v122, v122
    v_rcp_f32 v123, v123
    v_mfma_f32_16x16x32_bf16 a[76:79], v[28:31], v[200:203], a[76:79]
    v_rcp_f32 v124, v124
    v_rcp_f32 v125, v125
    v_mfma_f32_16x16x32_bf16 a[40:43], v[32:35], v[196:199], a[40:43]
    v_mul_f32 v106, v106, v208
    v_mul_f32 v107, v107, v209
    v_mfma_f32_16x16x32_bf16 a[60:63], v[32:35], v[204:207], a[60:63]
    v_mul_f32 v108, v108, v210
    v_mul_f32 v109, v109, v211
    v_mfma_f32_16x16x32_bf16 a[44:47], v[36:39], v[196:199], a[44:47]
    v_mul_f32 v110, v110, v212
    v_mul_f32 v111, v111, v213
    v_mfma_f32_16x16x32_bf16 a[64:67], v[36:39], v[204:207], a[64:67]
    v_mul_f32 v112, v112, v214
    v_mul_f32 v113, v113, v215
    v_mfma_f32_16x16x32_bf16 a[48:51], v[40:43], v[196:199], a[48:51]
    v_mul_f32 v114, v114, v216
    v_mul_f32 v115, v115, v217
    v_mfma_f32_16x16x32_bf16 a[68:71], v[40:43], v[204:207], a[68:71]
    v_mul_f32 v116, v116, v218
    v_mul_f32 v117, v117, v219
    v_mfma_f32_16x16x32_bf16 a[52:55], v[44:47], v[196:199], a[52:55]
    v_mul_f32 v118, v118, v220
    v_mul_f32 v119, v119, v221
    v_mfma_f32_16x16x32_bf16 a[72:75], v[44:47], v[204:207], a[72:75]
    v_mul_f32 v120, v120, v222
    v_mul_f32 v121, v121, v223
    v_mfma_f32_16x16x32_bf16 a[56:59], v[48:51], v[196:199], a[56:59]
    v_mul_f32 v122, v122, v224
    v_mul_f32 v123, v123, v225
    v_mfma_f32_16x16x32_bf16 a[76:79], v[48:51], v[204:207], a[76:79]
    v_mul_f32 v124, v124, v226
    v_mul_f32 v125, v125, v227
    s_barrier
    s_nop 7
    ds_write_b128 v104, a[60:63] offset:0
    ds_write_b128 v104, a[64:67] offset:1024
    ds_write_b128 v104, a[68:71] offset:2048
    ds_write_b128 v104, a[72:75] offset:3072
    ds_write_b128 v104, a[76:79] offset:4096
    v_accvgpr_read_b32 v53, a224
    v_accvgpr_read_b32 v55, a225
    v_accvgpr_read_b32 v57, a226
    v_accvgpr_read_b32 v59, a227
    v_accvgpr_read_b32 v61, a228
    v_accvgpr_read_b32 v63, a229
    v_accvgpr_read_b32 v65, a230
    v_accvgpr_read_b32 v67, a231
    v_accvgpr_read_b32 v69, a232
    v_accvgpr_read_b32 v71, a233
    v_accvgpr_read_b32 v72, a40
    v_accvgpr_read_b32 v73, a41
    v_accvgpr_read_b32 v74, a42
    v_accvgpr_read_b32 v75, a43
    v_accvgpr_read_b32 v76, a44
    v_accvgpr_read_b32 v77, a45
    v_accvgpr_read_b32 v78, a46
    v_accvgpr_read_b32 v79, a47
    v_accvgpr_read_b32 v80, a48
    v_accvgpr_read_b32 v81, a49
    v_accvgpr_read_b32 v82, a50
    v_accvgpr_read_b32 v83, a51
    v_accvgpr_read_b32 v84, a52
    v_accvgpr_read_b32 v85, a53
    v_accvgpr_read_b32 v86, a54
    v_accvgpr_read_b32 v87, a55
    v_accvgpr_read_b32 v88, a56
    v_accvgpr_read_b32 v89, a57
    v_accvgpr_read_b32 v90, a58
    v_accvgpr_read_b32 v91, a59
    s_waitcnt lgkmcnt(0)
    s_barrier
    ds_read_b128 v[148:151], v105 offset:0
    ds_read_b128 v[152:155], v105 offset:1024
    ds_read_b128 v[156:159], v105 offset:2048
    ds_read_b128 v[160:163], v105 offset:3072
    ds_read_b128 v[164:167], v105 offset:4096
    v_lshlrev_b32 v52, 16, v53
    v_and_b32 v53, 0xffff0000, v53
    v_lshlrev_b32 v54, 16, v55
    v_and_b32 v55, 0xffff0000, v55
    v_lshlrev_b32 v56, 16, v57
    v_and_b32 v57, 0xffff0000, v57
    v_lshlrev_b32 v58, 16, v59
    v_and_b32 v59, 0xffff0000, v59
    v_lshlrev_b32 v60, 16, v61
    v_and_b32 v61, 0xffff0000, v61
    v_lshlrev_b32 v62, 16, v63
    v_and_b32 v63, 0xffff0000, v63
    v_lshlrev_b32 v64, 16, v65
    v_and_b32 v65, 0xffff0000, v65
    v_lshlrev_b32 v66, 16, v67
    v_and_b32 v67, 0xffff0000, v67
    v_lshlrev_b32 v68, 16, v69
    v_and_b32 v69, 0xffff0000, v69
    v_lshlrev_b32 v70, 16, v71
    v_and_b32 v71, 0xffff0000, v71
    s_waitcnt lgkmcnt(0)
    v_pk_add_f32 v[72:73], v[72:73], v[148:149]
    v_pk_add_f32 v[74:75], v[74:75], v[150:151]
    v_pk_add_f32 v[76:77], v[76:77], v[152:153]
    v_pk_add_f32 v[78:79], v[78:79], v[154:155]
    v_pk_add_f32 v[80:81], v[80:81], v[156:157]
    v_pk_add_f32 v[82:83], v[82:83], v[158:159]
    v_pk_add_f32 v[84:85], v[84:85], v[160:161]
    v_pk_add_f32 v[86:87], v[86:87], v[162:163]
    v_pk_add_f32 v[88:89], v[88:89], v[164:165]
    v_pk_add_f32 v[90:91], v[90:91], v[166:167]
    s_mul_i32 s61, s10, 2560
    s_add_u32 s61, s61, 40960
    v_and_b32 v148, 15, v1
    v_mul_u32_u24 v148, 160, v148
    v_lshrrev_b32 v149, 4, v1
    v_lshl_add_u32 v148, v149, 3, v148
    v_add_u32 v148, s61, v148
    v_add_u32 v149, s61, v3
    v_fmac_f32 v52, v106, v72
    v_fmac_f32 v53, v107, v73
    v_fmac_f32 v54, v108, v74
    v_fmac_f32 v55, v109, v75
    v_cvt_pk_bf16_f32 v52, v52, v53
    v_cvt_pk_bf16_f32 v53, v54, v55
    ds_write_b64 v148, v[52:53] offset:0
    v_fmac_f32 v56, v110, v76
    v_fmac_f32 v57, v111, v77
    v_fmac_f32 v58, v112, v78
    v_fmac_f32 v59, v113, v79
    v_cvt_pk_bf16_f32 v56, v56, v57
    v_cvt_pk_bf16_f32 v57, v58, v59
    ds_write_b64 v148, v[56:57] offset:32
    v_fmac_f32 v60, v114, v80
    v_fmac_f32 v61, v115, v81
    v_fmac_f32 v62, v116, v82
    v_fmac_f32 v63, v117, v83
    v_cvt_pk_bf16_f32 v60, v60, v61
    v_cvt_pk_bf16_f32 v61, v62, v63
    ds_write_b64 v148, v[60:61] offset:64
    v_fmac_f32 v64, v118, v84
    v_fmac_f32 v65, v119, v85
    v_fmac_f32 v66, v120, v86
    v_fmac_f32 v67, v121, v87
    v_cvt_pk_bf16_f32 v64, v64, v65
    v_cvt_pk_bf16_f32 v65, v66, v67
    ds_write_b64 v148, v[64:65] offset:96
    v_fmac_f32 v68, v122, v88
    v_fmac_f32 v69, v123, v89
    v_fmac_f32 v70, v124, v90
    v_fmac_f32 v71, v125, v91
    v_cvt_pk_bf16_f32 v68, v68, v69
    v_cvt_pk_bf16_f32 v69, v70, v71
    ds_write_b64 v148, v[68:69] offset:128
    s_lshl_b32 s62, s50, 4
    s_mul_i32 s62, s62, 1280
    s_mul_i32 s63, s49, 160
    s_add_u32 s62, s62, s63
    v_add_u32 v150, 0, v1
    v_mul_u32_u24 v151, 6554, v150
    v_lshrrev_b32 v151, 16, v151
    v_mul_u32_u24 v152, 10, v151
    v_sub_u32 v152, v150, v152
    v_mul_u32_u24 v151, 1280, v151
    v_lshl_add_u32 v154, v152, 4, v151
    v_add_u32 v150, 64, v1
    v_mul_u32_u24 v151, 6554, v150
    v_lshrrev_b32 v151, 16, v151
    v_mul_u32_u24 v152, 10, v151
    v_sub_u32 v152, v150, v152
    v_mul_u32_u24 v151, 1280, v151
    v_lshl_add_u32 v155, v152, 4, v151
    v_add_u32 v150, 128, v1
    v_mul_u32_u24 v151, 6554, v150
    v_lshrrev_b32 v151, 16, v151
    v_mul_u32_u24 v152, 10, v151
    v_sub_u32 v152, v150, v152
    v_mul_u32_u24 v151, 1280, v151
    v_lshl_add_u32 v156, v152, 4, v151
    v_cmp_gt_u32 vcc, 32, v1
    v_mov_b32 v150, 2147418112
    s_waitcnt lgkmcnt(0)
    v_cndmask_b32 v156, v150, v156, vcc
    ds_read_b128 v[72:75], v149 offset:0
    ds_read_b128 v[76:79], v149 offset:1024
    ds_read_b128 v[80:83], v149 offset:2048
    s_waitcnt lgkmcnt(2)
    buffer_store_dwordx4 v[72:75], v154, s[44:47], s62 offen
    s_waitcnt lgkmcnt(1)
    buffer_store_dwordx4 v[76:79], v155, s[44:47], s62 offen
    s_waitcnt lgkmcnt(0)
    buffer_store_dwordx4 v[80:83], v156, s[44:47], s62 offen
K2_END:
    s_endpgm
K2_SPIN:
    s_mov_b32 s62, 0x40000
K2_SPIN_LOOP:
    buffer_load_dword v101, v100, s[4:7], s55 offen sc1
    s_waitcnt vmcnt(0)
    v_cmp_eq_u32 vcc, 1, v101
    s_nop 3
    s_cmp_eq_u64 vcc, exec
    s_cbranch_scc1 K2_SPUN
    s_sub_u32 s62, s62, 1
    s_cmp_lg_u32 s62, 0
    s_cbranch_scc1 K2_SPIN_LOOP
    s_branch K2_SPUN
K2_FALLBACK:
    s_waitcnt vmcnt(0)
    v_mov_b32 v120, 0xff800000
    v_mov_b32 v121, 0xff800000
    v_mov_b32 v122, 0xff800000
    v_mov_b32 v123, 0xff800000
    v_mov_b32 v124, 0xff800000
    v_mov_b32 v125, 0xff800000
    v_mov_b32 v126, 0xff800000
    v_mov_b32 v127, 0xff800000
    s_mov_b32 s12, 16
    s_mov_b32 s22, s11
K2_FB_LOOP:
    buffer_load_dwordx4 v[92:95], v3, s[4:7], s11 offen
    buffer_load_dwordx2 v[96:97], v4, s[4:7], s11 offen offset:1024
    s_waitcnt vmcnt(0)
    v_mfma_f32_32x32x16_bf16 v[60:75], v[92:95], v[12:15], 0
    v_mfma_f32_32x32x8_bf16 v[60:75], v[96:97], v[44:45], v[60:75]
    s_nop 13
    v_max3_f32 v120, v60, v61, v120
    v_max3_f32 v120, v62, v63, v120
    v_max3_f32 v120, v64, v65, v120
    v_max3_f32 v120, v66, v67, v120
    v_max3_f32 v120, v68, v69, v120
    v_max3_f32 v120, v70, v71, v120
    v_max3_f32 v120, v72, v73, v120
    v_max3_f32 v120, v74, v75, v120
    s_nop 1
    v_mfma_f32_32x32x16_bf16 v[60:75], v[92:95], v[16:19], 0
    v_mfma_f32_32x32x8_bf16 v[60:75], v[96:97], v[46:47], v[60:75]
    s_nop 13
    v_max3_f32 v121, v60, v61, v121
    v_max3_f32 v121, v62, v63, v121
    v_max3_f32 v121, v64, v65, v121
    v_max3_f32 v121, v66, v67, v121
    v_max3_f32 v121, v68, v69, v121
    v_max3_f32 v121, v70, v71, v121
    v_max3_f32 v121, v72, v73, v121
    v_max3_f32 v121, v74, v75, v121
    s_nop 1
    v_mfma_f32_32x32x16_bf16 v[60:75], v[92:95], v[20:23], 0
    v_mfma_f32_32x32x8_bf16 v[60:75], v[96:97], v[48:49], v[60:75]
    s_nop 13
    v_max3_f32 v122, v60, v61, v122
    v_max3_f32 v122, v62, v63, v122
    v_max3_f32 v122, v64, v65, v122
    v_max3_f32 v122, v66, v67, v122
    v_max3_f32 v122, v68, v69, v122
    v_max3_f32 v122, v70, v71, v122
    v_max3_f32 v122, v72, v73, v122
    v_max3_f32 v122, v74, v75, v122
    s_nop 1
    v_mfma_f32_32x32x16_bf16 v[60:75], v[92:95], v[24:27], 0
    v_mfma_f32_32x32x8_bf16 v[60:75], v[96:97], v[50:51], v[60:75]
    s_nop 13
    v_max3_f32 v123, v60, v61, v123
    v_max3_f32 v123, v62, v63, v123
    v_max3_f32 v123, v64, v65, v123
    v_max3_f32 v123, v66, v67, v123
    v_max3_f32 v123, v68, v69, v123
    v_max3_f32 v123, v70, v71, v123
    v_max3_f32 v123, v72, v73, v123
    v_max3_f32 v123, v74, v75, v123
    s_nop 1
    v_mfma_f32_32x32x16_bf16 v[60:75], v[92:95], v[28:31], 0
    v_mfma_f32_32x32x8_bf16 v[60:75], v[96:97], v[52:53], v[60:75]
    s_nop 13
    v_max3_f32 v124, v60, v61, v124
    v_max3_f32 v124, v62, v63, v124
    v_max3_f32 v124, v64, v65, v124
    v_max3_f32 v124, v66, v67, v124
    v_max3_f32 v124, v68, v69, v124
    v_max3_f32 v124, v70, v71, v124
    v_max3_f32 v124, v72, v73, v124
    v_max3_f32 v124, v74, v75, v124
    s_nop 1
    v_mfma_f32_32x32x16_bf16 v[60:75], v[92:95], v[32:35], 0
    v_mfma_f32_32x32x8_bf16 v[60:75], v[96:97], v[54:55], v[60:75]
    s_nop 13
    v_max3_f32 v125, v60, v61, v125
    v_max3_f32 v125, v62, v63, v125
    v_max3_f32 v125, v64, v65, v125
    v_max3_f32 v125, v66, v67, v125
    v_max3_f32 v125, v68, v69, v125
    v_max3_f32 v125, v70, v71, v125
    v_max3_f32 v125, v72, v73, v125
    v_max3_f32 v125, v74, v75, v125
    s_nop 1
    v_mfma_f32_32x32x16_bf16 v[60:75], v[92:95], v[36:39], 0
    v_mfma_f32_32x32x8_bf16 v[60:75], v[96:97], v[56:57], v[60:75]
    s_nop 13
    v_max3_f32 v126, v60, v61, v126
    v_max3_f32 v126, v62, v63, v126
    v_max3_f32 v126, v64, v65, v126
    v_max3_f32 v126, v66, v67, v126
    v_max3_f32 v126, v68, v69, v126
    v_max3_f32 v126, v70, v71, v126
    v_max3_f32 v126, v72, v73, v126
    v_max3_f32 v126, v74, v75, v126
    s_nop 1
    v_mfma_f32_32x32x16_bf16 v[60:75], v[92:95], v[40:43], 0
    v_mfma_f32_32x32x8_bf16 v[60:75], v[96:97], v[58:59], v[60:75]
    s_nop 13
    v_max3_f32 v127, v60, v61, v127
    v_max3_f32 v127, v62, v63, v127
    v_max3_f32 v127, v64, v65, v127
    v_max3_f32 v127, v66, v67, v127
    v_max3_f32 v127, v68, v69, v127
    v_max3_f32 v127, v70, v71, v127
    v_max3_f32 v127, v72, v73, v127
    v_max3_f32 v127, v74, v75, v127
    s_nop 1
    s_add_u32 s11, s11, 3584
    s_sub_u32 s12, s12, 1
    s_cmp_lg_u32 s12, 0
    s_cbranch_scc1 K2_FB_LOOP
    s_mov_b32 s11, s22
    buffer_load_dwordx4 v[92:95], v3, s[4:7], s11 offen
    buffer_load_dwordx2 v[96:97], v4, s[4:7], s11 offen offset:1024
    s_lshl_b32 s16, s10, 11
    v_lshlrev_b32 v5, 2, v1
    v_add_u32 v6, s16, v5
    v_mov_b32 v7, v120
    s_nop 1
    v_permlane32_swap_b32 v7, v120
    s_nop 0
    v_max_f32 v120, v120, v7
    ds_write_b32 v6, v120 offset:0
    v_mov_b32 v7, v121
    s_nop 1
    v_permlane32_swap_b32 v7, v121
    s_nop 0
    v_max_f32 v121, v121, v7
    ds_write_b32 v6, v121 offset:256
    v_mov_b32 v7, v122
    s_nop 1
    v_permlane32_swap_b32 v7, v122
    s_nop 0
    v_max_f32 v122, v122, v7
    ds_write_b32 v6, v122 offset:512
    v_mov_b32 v7, v123
    s_nop 1
    v_permlane32_swap_b32 v7, v123
    s_nop 0
    v_max_f32 v123, v123, v7
    ds_write_b32 v6, v123 offset:768
    v_mov_b32 v7, v124
    s_nop 1
    v_permlane32_swap_b32 v7, v124
    s_nop 0
    v_max_f32 v124, v124, v7
    ds_write_b32 v6, v124 offset:1024
    v_mov_b32 v7, v125
    s_nop 1
    v_permlane32_swap_b32 v7, v125
    s_nop 0
    v_max_f32 v125, v125, v7
    ds_write_b32 v6, v125 offset:1280
    v_mov_b32 v7, v126
    s_nop 1
    v_permlane32_swap_b32 v7, v126
    s_nop 0
    v_max_f32 v126, v126, v7
    ds_write_b32 v6, v126 offset:1536
    v_mov_b32 v7, v127
    s_nop 1
    v_permlane32_swap_b32 v7, v127
    s_nop 0
    v_max_f32 v127, v127, v7
    ds_write_b32 v6, v127 offset:1792
    s_waitcnt lgkmcnt(0)
    s_barrier
    v_cmp_gt_u32 vcc, 32, v1
    ds_read_b32 v60, v5 offset:0
    ds_read_b32 v61, v5 offset:2048
    ds_read_b32 v62, v5 offset:4096
    ds_read_b32 v63, v5 offset:6144
    s_waitcnt lgkmcnt(0)
    v_max3_f32 v60, v60, v61, v62
    v_max_f32 v60, v60, v63
    v_sub_f32 v60, 0, v60
    v_cvt_pk_bf16_f32 v64, v60, v60
    v_and_b32 v65, 0xffff0000, v64
    v_sub_f32 v66, v60, v65
    v_cvt_pk_bf16_f32 v67, v66, v66
    v_and_b32 v68, 0xffff0000, v67
    v_sub_f32 v69, v66, v68
    v_cvt_pk_bf16_f32 v69, v69, 0
    v_lshrrev_b32 v65, 16, v65
    v_or_b32 v65, v65, v68
    v_cndmask_b32 v44, v65, v44, vcc
    v_cndmask_b32 v45, v69, v45, vcc
    ds_read_b32 v60, v5 offset:256
    ds_read_b32 v61, v5 offset:2304
    ds_read_b32 v62, v5 offset:4352
    ds_read_b32 v63, v5 offset:6400
    s_waitcnt lgkmcnt(0)
    v_max3_f32 v60, v60, v61, v62
    v_max_f32 v60, v60, v63
    v_sub_f32 v60, 0, v60
    v_cvt_pk_bf16_f32 v64, v60, v60
    v_and_b32 v65, 0xffff0000, v64
    v_sub_f32 v66, v60, v65
    v_cvt_pk_bf16_f32 v67, v66, v66
    v_and_b32 v68, 0xffff0000, v67
    v_sub_f32 v69, v66, v68
    v_cvt_pk_bf16_f32 v69, v69, 0
    v_lshrrev_b32 v65, 16, v65
    v_or_b32 v65, v65, v68
    v_cndmask_b32 v46, v65, v46, vcc
    v_cndmask_b32 v47, v69, v47, vcc
    ds_read_b32 v60, v5 offset:512
    ds_read_b32 v61, v5 offset:2560
    ds_read_b32 v62, v5 offset:4608
    ds_read_b32 v63, v5 offset:6656
    s_waitcnt lgkmcnt(0)
    v_max3_f32 v60, v60, v61, v62
    v_max_f32 v60, v60, v63
    v_sub_f32 v60, 0, v60
    v_cvt_pk_bf16_f32 v64, v60, v60
    v_and_b32 v65, 0xffff0000, v64
    v_sub_f32 v66, v60, v65
    v_cvt_pk_bf16_f32 v67, v66, v66
    v_and_b32 v68, 0xffff0000, v67
    v_sub_f32 v69, v66, v68
    v_cvt_pk_bf16_f32 v69, v69, 0
    v_lshrrev_b32 v65, 16, v65
    v_or_b32 v65, v65, v68
    v_cndmask_b32 v48, v65, v48, vcc
    v_cndmask_b32 v49, v69, v49, vcc
    ds_read_b32 v60, v5 offset:768
    ds_read_b32 v61, v5 offset:2816
    ds_read_b32 v62, v5 offset:4864
    ds_read_b32 v63, v5 offset:6912
    s_waitcnt lgkmcnt(0)
    v_max3_f32 v60, v60, v61, v62
    v_max_f32 v60, v60, v63
    v_sub_f32 v60, 0, v60
    v_cvt_pk_bf16_f32 v64, v60, v60
    v_and_b32 v65, 0xffff0000, v64
    v_sub_f32 v66, v60, v65
    v_cvt_pk_bf16_f32 v67, v66, v66
    v_and_b32 v68, 0xffff0000, v67
    v_sub_f32 v69, v66, v68
    v_cvt_pk_bf16_f32 v69, v69, 0
    v_lshrrev_b32 v65, 16, v65
    v_or_b32 v65, v65, v68
    v_cndmask_b32 v50, v65, v50, vcc
    v_cndmask_b32 v51, v69, v51, vcc
    ds_read_b32 v60, v5 offset:1024
    ds_read_b32 v61, v5 offset:3072
    ds_read_b32 v62, v5 offset:5120
    ds_read_b32 v63, v5 offset:7168
    s_waitcnt lgkmcnt(0)
    v_max3_f32 v60, v60, v61, v62
    v_max_f32 v60, v60, v63
    v_sub_f32 v60, 0, v60
    v_cvt_pk_bf16_f32 v64, v60, v60
    v_and_b32 v65, 0xffff0000, v64
    v_sub_f32 v66, v60, v65
    v_cvt_pk_bf16_f32 v67, v66, v66
    v_and_b32 v68, 0xffff0000, v67
    v_sub_f32 v69, v66, v68
    v_cvt_pk_bf16_f32 v69, v69, 0
    v_lshrrev_b32 v65, 16, v65
    v_or_b32 v65, v65, v68
    v_cndmask_b32 v52, v65, v52, vcc
    v_cndmask_b32 v53, v69, v53, vcc
    ds_read_b32 v60, v5 offset:1280
    ds_read_b32 v61, v5 offset:3328
    ds_read_b32 v62, v5 offset:5376
    ds_read_b32 v63, v5 offset:7424
    s_waitcnt lgkmcnt(0)
    v_max3_f32 v60, v60, v61, v62
    v_max_f32 v60, v60, v63
    v_sub_f32 v60, 0, v60
    v_cvt_pk_bf16_f32 v64, v60, v60
    v_and_b32 v65, 0xffff0000, v64
    v_sub_f32 v66, v60, v65
    v_cvt_pk_bf16_f32 v67, v66, v66
    v_and_b32 v68, 0xffff0000, v67
    v_sub_f32 v69, v66, v68
    v_cvt_pk_bf16_f32 v69, v69, 0
    v_lshrrev_b32 v65, 16, v65
    v_or_b32 v65, v65, v68
    v_cndmask_b32 v54, v65, v54, vcc
    v_cndmask_b32 v55, v69, v55, vcc
    ds_read_b32 v60, v5 offset:1536
    ds_read_b32 v61, v5 offset:3584
    ds_read_b32 v62, v5 offset:5632
    ds_read_b32 v63, v5 offset:7680
    s_waitcnt lgkmcnt(0)
    v_max3_f32 v60, v60, v61, v62
    v_max_f32 v60, v60, v63
    v_sub_f32 v60, 0, v60
    v_cvt_pk_bf16_f32 v64, v60, v60
    v_and_b32 v65, 0xffff0000, v64
    v_sub_f32 v66, v60, v65
    v_cvt_pk_bf16_f32 v67, v66, v66
    v_and_b32 v68, 0xffff0000, v67
    v_sub_f32 v69, v66, v68
    v_cvt_pk_bf16_f32 v69, v69, 0
    v_lshrrev_b32 v65, 16, v65
    v_or_b32 v65, v65, v68
    v_cndmask_b32 v56, v65, v56, vcc
    v_cndmask_b32 v57, v69, v57, vcc
    ds_read_b32 v60, v5 offset:1792
    ds_read_b32 v61, v5 offset:3840
    ds_read_b32 v62, v5 offset:5888
    ds_read_b32 v63, v5 offset:7936
    s_waitcnt lgkmcnt(0)
    v_max3_f32 v60, v60, v61, v62
    v_max_f32 v60, v60, v63
    v_sub_f32 v60, 0, v60
    v_cvt_pk_bf16_f32 v64, v60, v60
    v_and_b32 v65, 0xffff0000, v64
    v_sub_f32 v66, v60, v65
    v_cvt_pk_bf16_f32 v67, v66, v66
    v_and_b32 v68, 0xffff0000, v67
    v_sub_f32 v69, v66, v68
    v_cvt_pk_bf16_f32 v69, v69, 0
    v_lshrrev_b32 v65, 16, v65
    v_or_b32 v65, v65, v68
    v_cndmask_b32 v58, v65, v58, vcc
    v_cndmask_b32 v59, v69, v59, vcc
    s_barrier
    v_and_b32 v6, 31, v1
    v_lshrrev_b32 v7, 5, v1
    v_lshrrev_b32 v8, 4, v6
    v_mul_u32_u24 v8, 5120, v8
    v_and_b32 v9, 15, v6
    v_lshl_add_u32 v8, v9, 4, v8
    v_add_u32 v8, 81920, v8
    s_mul_i32 s18, s10, 10
    v_cmp_gt_u32 vcc, 32, v1
    v_mov_b32 v11, 92160
    v_lshl_add_u32 v11, v6, 3, v11
    s_add_u32 s19, s18, 0
    v_add_u32 v9, s19, v7
    v_lshrrev_b32 v10, 3, v9
    v_lshl_add_u32 v120, v10, 10, v8
    v_and_b32 v10, 3, v9
    v_lshl_add_u32 v120, v10, 8, v120
    v_bfe_u32 v10, v9, 2, 1
    v_lshl_add_u32 v120, v10, 3, v120
    s_add_u32 s19, s18, 2
    v_add_u32 v9, s19, v7
    v_lshrrev_b32 v10, 3, v9
    v_lshl_add_u32 v121, v10, 10, v8
    v_and_b32 v10, 3, v9
    v_lshl_add_u32 v121, v10, 8, v121
    v_bfe_u32 v10, v9, 2, 1
    v_lshl_add_u32 v121, v10, 3, v121
    s_add_u32 s19, s18, 4
    v_add_u32 v9, s19, v7
    v_lshrrev_b32 v10, 3, v9
    v_lshl_add_u32 v122, v10, 10, v8
    v_and_b32 v10, 3, v9
    v_lshl_add_u32 v122, v10, 8, v122
    v_bfe_u32 v10, v9, 2, 1
    v_lshl_add_u32 v122, v10, 3, v122
    v_cndmask_b32 v122, v11, v122, vcc
    s_add_u32 s19, s18, 5
    v_add_u32 v9, s19, v7
    v_lshrrev_b32 v10, 3, v9
    v_lshl_add_u32 v123, v10, 10, v8
    v_and_b32 v10, 3, v9
    v_lshl_add_u32 v123, v10, 8, v123
    v_bfe_u32 v10, v9, 2, 1
    v_lshl_add_u32 v123, v10, 3, v123
    s_add_u32 s19, s18, 7
    v_add_u32 v9, s19, v7
    v_lshrrev_b32 v10, 3, v9
    v_lshl_add_u32 v124, v10, 10, v8
    v_and_b32 v10, 3, v9
    v_lshl_add_u32 v124, v10, 8, v124
    v_bfe_u32 v10, v9, 2, 1
    v_lshl_add_u32 v124, v10, 3, v124
    s_add_u32 s19, s18, 9
    v_add_u32 v9, s19, v7
    v_lshrrev_b32 v10, 3, v9
    v_lshl_add_u32 v125, v10, 10, v8
    v_and_b32 v10, 3, v9
    v_lshl_add_u32 v125, v10, 8, v125
    v_bfe_u32 v10, v9, 2, 1
    v_lshl_add_u32 v125, v10, 3, v125
    v_cndmask_b32 v125, v11, v125, vcc
    s_mul_i32 s16, s10, 24576
    v_add_u32 v126, s16, v3
    v_and_b32 v5, 15, v1
    s_lshl_b32 s17, s50, 4
    v_add_u32 v5, s17, v5
    v_mul_u32_u24 v5, 1280, v5
    v_lshrrev_b32 v6, 4, v1
    v_lshl_add_u32 v5, v6, 3, v5
    s_mul_i32 s17, s49, 160
    v_add_u32 v11, s17, v5
    v_cmp_gt_u32 vcc, 47, v1
    v_lshlrev_b32 v10, 7, v1
    v_mov_b32 v5, 2147418112
    v_cndmask_b32 v10, v5, v10, vcc
    s_waitcnt vmcnt(0)
    s_branch K2_JOIN
.section .rodata,"a"
.p2align 6
.amdhsa_kernel k1_proj_kernel
  .amdhsa_next_free_vgpr 240
  .amdhsa_next_free_sgpr 102
  .amdhsa_accum_offset 240
  .amdhsa_group_segment_fixed_size 0
  .amdhsa_kernarg_size 88
  .amdhsa_user_sgpr_count 2
  .amdhsa_user_sgpr_kernarg_segment_ptr 1
  .amdhsa_system_sgpr_workgroup_id_x 1
  .amdhsa_float_denorm_mode_32 3
.end_amdhsa_kernel
.p2align 6
.amdhsa_kernel k2_attn_out_kernel
  .amdhsa_next_free_vgpr 512
  .amdhsa_next_free_sgpr 102
  .amdhsa_accum_offset 256
  .amdhsa_group_segment_fixed_size 0
  .amdhsa_kernarg_size 88
  .amdhsa_user_sgpr_count 2
  .amdhsa_user_sgpr_kernarg_segment_ptr 1
  .amdhsa_system_sgpr_workgroup_id_x 1
  .amdhsa_float_denorm_mode_32 3
.end_amdhsa_kernel
```
